```python
import torch

def _softmax(x, axis=-1):
    return torch.softmax(x, dim=axis)
def _gelu(x):
    return torch.nn.functional.gelu(x, approximate="tanh")
def _silu(x):
    return torch.nn.functional.silu(x)
def _sigmoid(x):
    return torch.sigmoid(x)
def _layernorm(x, axis=-1, eps=1e-5):
    m = x.mean(dim=axis, keepdim=True)
    v = x.var(dim=axis, keepdim=True, unbiased=False)
    return (x - m) / torch.sqrt(v + eps)
def _scatter_add(tgt, idx, src, axis=0):
    return tgt.clone().index_add_(axis, idx, src)
def _segment_sum(src, seg, n):
    out = torch.zeros((n,) + src.shape[1:], dtype=src.dtype)
    return out.index_add_(0, seg, src)
def _pad(x, pw):
    flat = tuple(v for pair in reversed(pw) for v in pair)
    return torch.nn.functional.pad(x, flat)

kernel_name = 'interleave_layers__sliding_block__mixer_channel_mlp__prompt'

def setup_inputs():

    _w = (lambda a: (lambda t: t.to(torch.bfloat16) if t.is_floating_point() else t)(torch.as_tensor(a)))
    def _A_setup():
        B, S, D = 1, 2048, 640
        return {
            "x": _w((lambda *s: torch.randn(*s, dtype=torch.bfloat16) * 0.05)(B, S, D)),
            "wqkv": _w((lambda *s: torch.randn(*s, dtype=torch.bfloat16) * 0.05)(D, 3 * D)),
            "wo": _w((lambda *s: torch.randn(*s, dtype=torch.bfloat16) * 0.05)(D, D)),
        }
    _A_in = _A_setup()

    def _B_setup():
        B, S, D, F = 1, 2048, 640, 1728
        return {
            "x": _w((lambda *s: torch.randn(*s, dtype=torch.bfloat16) * 0.05)(B, S, D)),
            "w1": _w((lambda *s: torch.randn(*s, dtype=torch.bfloat16) * 1.6)(D, F) * (D ** -0.5)),
            "b1": _w((lambda *s: torch.randn(*s, dtype=torch.bfloat16) * 1.6)(F)),
            "w2": _w((lambda *s: torch.randn(*s, dtype=torch.bfloat16) * 0.4)(F, D) * (F ** -0.5)),
            "b2": _w((lambda *s: torch.randn(*s, dtype=torch.bfloat16) * 0.4)(D)),
        }
    _B_in = _B_setup()

    return {
        "A_x": _A_in["x"],
        "A_wqkv": _A_in["wqkv"],
        "A_wo": _A_in["wo"],
        "B_x": _B_in["x"],
        "B_w1": _B_in["w1"],
        "B_b1": _B_in["b1"],
        "B_w2": _B_in["w2"],
        "B_b2": _B_in["b2"],
    }

def reference(A_x, A_wqkv, A_wo, B_x, B_w1, B_b1, B_w2, B_b2):
    def _A_ref(x, wqkv, wo):
        B, S, D = x.shape
        H = 32; Dh = D // H; W = 256
        qkv = (lambda x, *d: x.permute(*d))((x @ wqkv).reshape(B, S, 3, H, Dh), 2, 0, 3, 1, 4)
        q, k, v = qkv[0], qkv[1], qkv[2]
        scores = torch.einsum("bhqd,bhkd->bhqk", q, k) * (Dh ** -0.5)
        idx = torch.arange(S)
        mask = (idx[:, None] - idx[None, :] >= 0) & (idx[:, None] - idx[None, :] < W)
        scores = torch.where(mask[None, None], scores, -1e9)
        p = _softmax(scores, axis=-1)
        o = torch.einsum("bhqk,bhkd->bhqd", p, v)
        return (lambda x, *d: x.permute(*d))(o, 0, 2, 1, 3).reshape(B, S, D) @ wo

    def _B_ref(x, w1, b1, w2, b2):
        y = _layernorm(x, axis=-1)
        h = _gelu(torch.einsum("bsd,df->bsf", y, w1) + b1)
        return torch.einsum("bsf,fd->bsd", h, w2) + b2

    x = A_x
    x = x + _A_ref(_layernorm(x, axis=-1), A_wqkv, A_wo)
    x = x + _B_ref(_layernorm(x, axis=-1), B_w1, B_b1, B_w2, B_b2)
    x = x + _A_ref(_layernorm(x, axis=-1), A_wqkv, A_wo)
    x = x + _B_ref(_layernorm(x, axis=-1), B_w1, B_b1, B_w2, B_b2)
    return x
```

```asm
; @launch grid=(256,1,1) block=(512,1,1) lds=163840
.amdgcn_target "amdgcn-amd-amdhsa--gfx950"
.text
.globl interleave_layers__sliding_block__mixer_channel_mlp__prompt_kernel
.p2align 8
.type interleave_layers__sliding_block__mixer_channel_mlp__prompt_kernel,@function
interleave_layers__sliding_block__mixer_channel_mlp__prompt_kernel:

  s_cmp_ge_u32 s2, 256
  s_cbranch_scc1 L_end
  s_load_dwordx8 s[40:47], s[0:1], 0
  s_load_dwordx8 s[48:55], s[0:1], 32
  s_load_dwordx4 s[56:59], s[0:1], 64
  s_load_dwordx2 s[60:61], s[0:1], 80
  s_and_b32 s62, s2, 7
  s_lshr_b32 s63, s2, 3
  v_lshrrev_b32 v1, 6, v0
  s_mov_b32 s96, 0
  s_mov_b32 s97, 0
  v_readfirstlane_b32 s22, v1
  s_nop 3
  s_cmp_ge_u32 s22, 4
  s_cbranch_scc1 L_loader

  s_mov_b32 s64, 0xffffffff
  s_mov_b32 s65, 0xfffffff0
  s_mov_b32 s66, 0xfffffffe
  s_mov_b32 s67, 0xffffffe0
  s_mov_b32 s68, 0xfffffffc
  s_mov_b32 s69, 0xffffffc0
  s_mov_b32 s70, 0xfffffff8
  s_mov_b32 s71, 0xffffff80
  s_mov_b32 s72, 0xffffff00
  s_mov_b32 s73, 0xfffff000
  s_mov_b32 s74, 0xfffffe00
  s_mov_b32 s75, 0xffffe000
  s_mov_b32 s76, 0xfffffc00
  s_mov_b32 s77, 0xffffc000
  s_mov_b32 s78, 0xfffff800
  s_mov_b32 s79, 0xffff8000
  s_mov_b32 s80, 0xffff0000
  s_mov_b32 s81, 0xfff00000
  s_mov_b32 s82, 0xfffe0000
  s_mov_b32 s83, 0xffe00000
  s_mov_b32 s84, 0xfffc0000
  s_mov_b32 s85, 0xffc00000
  s_mov_b32 s86, 0xfff80000
  s_mov_b32 s87, 0xff800000
  s_mov_b32 s88, 0xff000000
  s_mov_b32 s89, 0xf0000000
  s_mov_b32 s90, 0xfe000000
  s_mov_b32 s91, 0xe0000000
  s_mov_b32 s92, 0xfc000000
  s_mov_b32 s93, 0xc0000000
  s_mov_b32 s94, 0xf8000000
  s_mov_b32 s95, 0x80000000

  s_and_b32 s30, s63, 1
  s_lshl_b32 s20, s62, 1
  s_add_u32 s20, s20, s30
  s_lshr_b32 s21, s63, 1
  s_cmp_ge_u32 s63, 30
  s_cselect_b32 s21, 15, s21

  v_and_b32 v2, 63, v0
  v_and_b32 v3, 31, v2
  v_lshrrev_b32 v4, 5, v2
  s_and_b32 s23, s22, 1
  s_lshr_b32 s24, s22, 1
  v_and_b32 v5, 15, v2
  v_lshrrev_b32 v6, 2, v5
  v_and_b32 v7, 3, v5
  v_lshl_add_u32 v8, v4, 3, v6
  v_lshlrev_b32 v8, 8, v8
  v_lshl_add_u32 v8, v7, 3, v8
  v_bfe_u32 v9, v2, 4, 1
  v_lshl_add_u32 v8, v9, 5, v8
  s_lshl_b32 s30, s24, 1

  s_xor_b32 s32, s23, 0
  s_add_u32 s32, s32, s30
  v_xor_b32 v9, s32, v6
  v_lshl_add_u32 v12, v9, 6, v8

  s_xor_b32 s32, s23, 1
  s_add_u32 s32, s32, s30
  v_xor_b32 v9, s32, v6
  v_lshl_add_u32 v13, v9, 6, v8

  v_lshrrev_b32 v5, 4, v3
  v_lshlrev_b32 v5, 11, v5
  v_and_b32 v6, 15, v3
  v_lshl_add_u32 v5, v6, 4, v5
  v_lshl_add_u32 v5, v4, 8, v5
  s_lshl_b32 s30, s23, 13
  v_add_u32 v10, s30, v5

  s_waitcnt lgkmcnt(0)
  s_mov_b32 s46, 1
  s_mov_b32 s47, 0

  s_cmp_eq_u32 s22, 2
  s_cbranch_scc0 L_nocpf
  s_getpc_b64 s[16:17]
L_pc0:
  s_sub_u32 s16, s16, L_pc0-interleave_layers__sliding_block__mixer_channel_mlp__prompt_kernel
  s_subb_u32 s17, s17, 0
  s_mov_b32 s18, L_code_end-interleave_layers__sliding_block__mixer_channel_mlp__prompt_kernel
  s_mov_b32 s19, 0x00020000
  v_lshlrev_b32 v6, 4, v2
  s_lshl_b32 s30, s63, 11
  buffer_load_dwordx4 v[32:35], v6, s[16:19], s30 offen
  buffer_load_dwordx4 v[32:35], v6, s[16:19], s30 offen offset:1024
L_nocpf:

  s_cmp_eq_u32 s22, 3
  s_cbranch_scc0 L_init_c_done
  v_mov_b32 v6, 0
  s_mov_b64 exec, 1
  s_cmp_eq_u32 s2, 0
  s_cbranch_scc0 L_init_c_rd
  s_memrealtime s[30:31]
  s_waitcnt lgkmcnt(0)
  s_or_b32 s30, s30, 0x80000000
  v_mov_b32 v8, s30
  v_mov_b32 v9, 0
  global_atomic_cmpswap v7, v6, v[8:9], s[58:59] sc0 sc1
  s_waitcnt vmcnt(0)
  v_readfirstlane_b32 s31, v7
  s_nop 3
  s_cmp_eq_u32 s31, 0
  s_cselect_b32 s30, s30, s31
  s_branch L_init_c_got
L_init_c_rd:
  s_mov_b32 s31, 400000
L_init_c_poll:
  global_load_dword v7, v6, s[58:59] sc1
  s_waitcnt vmcnt(0)
  v_readfirstlane_b32 s30, v7
  s_nop 3
  s_cmp_lg_u32 s30, 0
  s_cbranch_scc1 L_init_c_got
  s_sleep 1
  s_sub_u32 s31, s31, 1
  s_cmp_eq_u32 s31, 0
  s_cbranch_scc0 L_init_c_poll
  s_mov_b32 s30, 1
L_init_c_got:
  v_mov_b32 v7, s30
  v_mov_b32 v6, 160020
  ds_write_b32 v6, v7
  s_getreg_b32 s31, hwreg(HW_REG_XCC_ID)
  s_and_b32 s31, s31, 15
  s_add_u32 s31, s31, 1
  s_xor_b32 s31, s31, s30
  v_mov_b32 v7, s31
  s_lshl_b32 s30, s62, 7
  s_lshl_b32 s31, s63, 2
  s_add_u32 s30, s30, s31
  s_add_u32 s30, s30, 0x06f00000
  v_mov_b32 v6, s30
  global_store_dword v6, v7, s[60:61] sc1
  s_mov_b64 exec, -1
  s_waitcnt lgkmcnt(0)
L_init_c_done:

  s_cmp_eq_u32 s22, 1
  s_cbranch_scc0 L_nob1
  s_lshr_b32 s30, s63, 1
  s_lshl_b32 s30, s30, 8
  v_lshlrev_b32 v6, 2, v2

  s_add_u32 s16, s50, 0x00000000
  s_addc_u32 s17, s51, 0
  s_mov_b32 s18, 0x00000d80
  s_mov_b32 s19, 0x00020000

  buffer_load_dword v8, v6, s[16:19], s30 offen
  v_lshlrev_b32 v6, 3, v2
  v_add_u32 v6, 163328, v6
  s_waitcnt vmcnt(0)
  v_and_b32 v9, 0xffff0000, v8
  v_lshlrev_b32 v8, 16, v8
  ds_write_b64 v6, v[8:9]
  s_waitcnt lgkmcnt(0)
L_nob1:

  v_mov_b32 v5, 160000
  v_mov_b32 v6, 0
  ds_write_b32 v5, v6

  s_add_u32 s16, s42, 0x00000000
  s_addc_u32 s17, s43, 0
  s_mov_b32 s18, 0x00258000
  s_mov_b32 s19, 0x00020000
  s_add_u32 s12, s40, 0x00000000
  s_addc_u32 s13, s41, 0
  s_mov_b32 s14, 0x00280000
  s_mov_b32 s15, 0x00020000

  v_lshlrev_b32 v6, 4, v2
  s_lshl_b32 s30, s2, 10
  v_add_u32 v6, s30, v6
  v_lshrrev_b32 v7, 3, v2
  s_lshl_b32 s30, s2, 3
  v_add_u32 v7, s30, v7
  v_mul_u32_u24 v7, 1280, v7
  v_and_b32 v8, 7, v2
  v_lshl_add_u32 v7, v8, 4, v7
  s_add_u32 s32, s22, 4
  s_mul_i32 s30, s32, 245760
  s_lshl_b32 s31, s32, 7

  buffer_load_dwordx4 v[32:35], v6, s[16:19], s30 offen
  buffer_load_dwordx4 v[32:35], v7, s[12:15], s31 offen
  s_add_u32 s30, s30, 983040
  s_add_u32 s31, s31, 512
  buffer_load_dwordx4 v[32:35], v6, s[16:19], s30 offen
  buffer_load_dwordx4 v[32:35], v7, s[12:15], s31 offen
L_c_layer:

  s_cmp_eq_u32 s21, 15
  s_cbranch_scc1 L_c1_idle
  s_cmp_eq_u32 s96, 0
  s_cbranch_scc0 L_c1_lean

  v_lshrrev_b32 v5, 1, v3
  v_and_b32 v5, 7, v5
  v_xor_b32 v6, v4, v5
  v_lshlrev_b32 v6, 4, v6
  v_lshl_add_u32 v6, v3, 7, v6
  s_lshl_b32 s30, s23, 13
  v_add_u32 v10, s30, v6
  v_xor_b32 v11, 32, v10

  v_and_b32 v5, 15, v2
  v_bfe_u32 v6, v2, 4, 1
  v_cmp_eq_u32 vcc, v5, v6
  v_mov_b32 v7, 0x3f803f80
  v_mov_b32 v9, 0
  v_cndmask_b32 v200, v9, v7, vcc
  v_cndmask_b32 v201, v9, v7, vcc
  v_cndmask_b32 v202, v9, v7, vcc
  v_cndmask_b32 v203, v9, v7, vcc
  v_mov_b32 v128, 0
  v_mov_b32 v129, 0
  v_mov_b32 v130, 0
  v_mov_b32 v131, 0

  s_mov_b32 s26, 81920
  s_mov_b32 s27, 0
  v_add_u32 v16, s26, v10
  v_add_u32 v17, s26, v11
  v_add_u32 v18, s27, v12
  v_add_u32 v19, s27, v13
  v_xor_b32 v20, 64, v16
  v_xor_b32 v21, 64, v17
  s_barrier
  ds_read_b64_tr_b16 v[136:137], v18 offset:0
  ds_read_b64_tr_b16 v[138:139], v18 offset:1024
  ds_read_b64_tr_b16 v[144:145], v19 offset:0
  ds_read_b64_tr_b16 v[146:147], v19 offset:1024
  ds_read_b128 v[152:155], v16 offset:0
  ds_read_b128 v[160:163], v16 offset:4096
  ds_read_b64_tr_b16 v[140:141], v18 offset:4096
  ds_read_b64_tr_b16 v[142:143], v18 offset:5120
  ds_read_b64_tr_b16 v[148:149], v19 offset:4096
  ds_read_b64_tr_b16 v[150:151], v19 offset:5120
  ds_read_b128 v[156:159], v17 offset:0
  ds_read_b128 v[164:167], v17 offset:4096
  s_waitcnt lgkmcnt(0)
  ds_read_b64_tr_b16 v[168:169], v18 offset:8192
  ds_read_b64_tr_b16 v[170:171], v18 offset:9216
  v_mfma_f32_16x16x32_bf16 v[128:131], v[136:139], v[200:203], v[128:131]
  ds_read_b64_tr_b16 v[176:177], v19 offset:8192
  ds_read_b64_tr_b16 v[178:179], v19 offset:9216
  v_mfma_f32_32x32x16_bf16 v[64:79], v[136:139], v[152:155], 0
  ds_read_b128 v[184:187], v20 offset:0
  ds_read_b128 v[192:195], v20 offset:4096
  v_mfma_f32_32x32x16_bf16 v[80:95], v[136:139], v[160:163], 0
  ds_read_b64_tr_b16 v[172:173], v18 offset:12288
  ds_read_b64_tr_b16 v[174:175], v18 offset:13312
  v_mfma_f32_32x32x16_bf16 v[96:111], v[144:147], v[152:155], 0
  ds_read_b64_tr_b16 v[180:181], v19 offset:12288
  ds_read_b64_tr_b16 v[182:183], v19 offset:13312
  v_mfma_f32_32x32x16_bf16 v[112:127], v[144:147], v[160:163], 0
  ds_read_b128 v[188:191], v21 offset:0
  ds_read_b128 v[196:199], v21 offset:4096
  v_mfma_f32_16x16x32_bf16 v[128:131], v[140:143], v[200:203], v[128:131]
  v_mfma_f32_32x32x16_bf16 v[64:79], v[140:143], v[156:159], v[64:79]
  v_mfma_f32_32x32x16_bf16 v[80:95], v[140:143], v[164:167], v[80:95]
  v_mfma_f32_32x32x16_bf16 v[96:111], v[148:151], v[156:159], v[96:111]
  v_mfma_f32_32x32x16_bf16 v[112:127], v[148:151], v[164:167], v[112:127]
  s_add_u32 s26, s26, 16384
  s_cmp_eq_u32 s26, 131072
  s_cselect_b32 s26, 81920, s26
  s_add_u32 s27, s27, 16384
  s_cmp_eq_u32 s27, 81920
  s_cselect_b32 s27, 0, s27
  v_add_u32 v16, s26, v10
  v_add_u32 v17, s26, v11
  v_add_u32 v18, s27, v12
  v_add_u32 v19, s27, v13
  v_xor_b32 v20, 64, v16
  v_xor_b32 v21, 64, v17
  s_mov_b32 s25, 1
  s_waitcnt lgkmcnt(0)
L_qkv_aloop:
  s_barrier
  ds_read_b64_tr_b16 v[136:137], v18 offset:0
  ds_read_b64_tr_b16 v[138:139], v18 offset:1024
  v_mfma_f32_16x16x32_bf16 v[128:131], v[168:171], v[200:203], v[128:131]
  ds_read_b64_tr_b16 v[144:145], v19 offset:0
  ds_read_b64_tr_b16 v[146:147], v19 offset:1024
  v_mfma_f32_32x32x16_bf16 v[64:79], v[168:171], v[184:187], v[64:79]
  ds_read_b128 v[152:155], v16 offset:0
  ds_read_b128 v[160:163], v16 offset:4096
  v_mfma_f32_32x32x16_bf16 v[80:95], v[168:171], v[192:195], v[80:95]
  ds_read_b64_tr_b16 v[140:141], v18 offset:4096
  ds_read_b64_tr_b16 v[142:143], v18 offset:5120
  v_mfma_f32_32x32x16_bf16 v[96:111], v[176:179], v[184:187], v[96:111]
  ds_read_b64_tr_b16 v[148:149], v19 offset:4096
  ds_read_b64_tr_b16 v[150:151], v19 offset:5120
  v_mfma_f32_32x32x16_bf16 v[112:127], v[176:179], v[192:195], v[112:127]
  ds_read_b128 v[156:159], v17 offset:0
  ds_read_b128 v[164:167], v17 offset:4096
  v_mfma_f32_16x16x32_bf16 v[128:131], v[172:175], v[200:203], v[128:131]
  v_mfma_f32_32x32x16_bf16 v[64:79], v[172:175], v[188:191], v[64:79]
  v_mfma_f32_32x32x16_bf16 v[80:95], v[172:175], v[196:199], v[80:95]
  v_mfma_f32_32x32x16_bf16 v[96:111], v[180:183], v[188:191], v[96:111]
  v_mfma_f32_32x32x16_bf16 v[112:127], v[180:183], v[196:199], v[112:127]
  s_waitcnt lgkmcnt(0)
  ds_read_b64_tr_b16 v[168:169], v18 offset:8192
  ds_read_b64_tr_b16 v[170:171], v18 offset:9216
  v_mfma_f32_16x16x32_bf16 v[128:131], v[136:139], v[200:203], v[128:131]
  ds_read_b64_tr_b16 v[176:177], v19 offset:8192
  ds_read_b64_tr_b16 v[178:179], v19 offset:9216
  v_mfma_f32_32x32x16_bf16 v[64:79], v[136:139], v[152:155], v[64:79]
  ds_read_b128 v[184:187], v20 offset:0
  ds_read_b128 v[192:195], v20 offset:4096
  v_mfma_f32_32x32x16_bf16 v[80:95], v[136:139], v[160:163], v[80:95]
  ds_read_b64_tr_b16 v[172:173], v18 offset:12288
  ds_read_b64_tr_b16 v[174:175], v18 offset:13312
  v_mfma_f32_32x32x16_bf16 v[96:111], v[144:147], v[152:155], v[96:111]
  ds_read_b64_tr_b16 v[180:181], v19 offset:12288
  ds_read_b64_tr_b16 v[182:183], v19 offset:13312
  v_mfma_f32_32x32x16_bf16 v[112:127], v[144:147], v[160:163], v[112:127]
  ds_read_b128 v[188:191], v21 offset:0
  ds_read_b128 v[196:199], v21 offset:4096
  v_mfma_f32_16x16x32_bf16 v[128:131], v[140:143], v[200:203], v[128:131]
  v_mfma_f32_32x32x16_bf16 v[64:79], v[140:143], v[156:159], v[64:79]
  v_mfma_f32_32x32x16_bf16 v[80:95], v[140:143], v[164:167], v[80:95]
  v_mfma_f32_32x32x16_bf16 v[96:111], v[148:151], v[156:159], v[96:111]
  v_mfma_f32_32x32x16_bf16 v[112:127], v[148:151], v[164:167], v[112:127]
  s_add_u32 s26, s26, 16384
  s_cmp_eq_u32 s26, 131072
  s_cselect_b32 s26, 81920, s26
  s_add_u32 s27, s27, 16384
  s_cmp_eq_u32 s27, 81920
  s_cselect_b32 s27, 0, s27
  v_add_u32 v16, s26, v10
  v_add_u32 v17, s26, v11
  v_add_u32 v18, s27, v12
  v_add_u32 v19, s27, v13
  v_xor_b32 v20, 64, v16
  v_xor_b32 v21, 64, v17
  s_add_u32 s25, s25, 1
  s_cmp_lt_u32 s25, 10
  s_waitcnt lgkmcnt(0)
  s_cbranch_scc1 L_qkv_aloop
  v_mfma_f32_16x16x32_bf16 v[128:131], v[168:171], v[200:203], v[128:131]
  v_mfma_f32_16x16x32_bf16 v[128:131], v[172:175], v[200:203], v[128:131]
  v_mfma_f32_32x32x16_bf16 v[64:79], v[168:171], v[184:187], v[64:79]
  v_mfma_f32_32x32x16_bf16 v[80:95], v[168:171], v[192:195], v[80:95]
  v_mfma_f32_32x32x16_bf16 v[96:111], v[176:179], v[184:187], v[96:111]
  v_mfma_f32_32x32x16_bf16 v[112:127], v[176:179], v[192:195], v[112:127]
  v_mfma_f32_32x32x16_bf16 v[64:79], v[172:175], v[188:191], v[64:79]
  v_mfma_f32_32x32x16_bf16 v[80:95], v[172:175], v[196:199], v[80:95]
  v_mfma_f32_32x32x16_bf16 v[96:111], v[180:183], v[188:191], v[96:111]
  v_mfma_f32_32x32x16_bf16 v[112:127], v[180:183], v[196:199], v[112:127]

  s_lshl_b32 s30, s24, 1
  s_add_u32 s30, s30, s23
  s_lshl_b32 s30, s30, 7
  s_add_u32 s30, s30, 162304
  v_and_b32 v5, 15, v2
  v_lshrrev_b32 v6, 4, v2
  v_lshlrev_b32 v6, 4, v6
  v_lshl_add_u32 v6, v5, 6, v6
  v_add_u32 v6, s30, v6
  v_cmp_gt_u32 vcc, 2, v5
  s_nop 1
  s_and_saveexec_b64 s[34:35], vcc
  ds_write_b128 v6, v[128:131]
  s_mov_b64 exec, s[34:35]
  s_waitcnt lgkmcnt(0)
  s_barrier

  v_mov_b32 v6, 160016
  ds_read_b64 v[6:7], v6
  s_waitcnt lgkmcnt(0)
  v_readfirstlane_b32 s46, v6
  v_readfirstlane_b32 s101, v7
  s_nop 3
  s_lshr_b32 s97, s46, 1
  s_and_b32 s46, s46, 1

  s_lshl_b32 s30, s23, 9
  s_add_u32 s30, s30, 161280
  v_lshl_add_u32 v5, v3, 3, s30
  ds_read_b64 v[38:39], v5
  ds_read_b64 v[40:41], v5 offset:256
  s_lshl_b32 s30, s24, 8
  s_add_u32 s30, s30, 162304
  v_lshl_add_u32 v6, v4, 4, s30
  s_lshl_b32 s31, s23, 7

  s_xor_b32 s32, s31, 0
  v_add_u32 v7, s32, v6
  ds_read_b128 v[224:227], v7 offset:0
  ds_read_b128 v[228:231], v7 offset:32
  ds_read_b128 v[232:235], v7 offset:64
  ds_read_b128 v[236:239], v7 offset:96
  s_xor_b32 s32, s31, 128
  v_add_u32 v7, s32, v6
  ds_read_b128 v[240:243], v7 offset:0
  ds_read_b128 v[244:247], v7 offset:32
  ds_read_b128 v[248:251], v7 offset:64
  ds_read_b128 v[252:255], v7 offset:96
  s_add_u32 s12, s60, 0x00000000
  s_addc_u32 s13, s61, 0
  s_mov_b32 s14, 0x00780000
  s_mov_b32 s15, 0x00020000
  s_cmp_eq_u32 s96, 0
  s_cselect_b32 s35, 1, s46
  s_add_u32 s16, s60, 0x00d80000
  s_addc_u32 s17, s61, 0
  s_add_u32 s16, s16, s47
  s_addc_u32 s17, s17, 0
  s_mov_b32 s18, 0x00780000
  s_mov_b32 s19, 0x00020000

  s_lshl_b32 s30, s20, 7
  s_lshl_b32 s32, s23, 6
  s_add_u32 s30, s30, s32
  v_add_u32 v8, s30, v3
  v_lshlrev_b32 v8, 4, v8
  v_lshl_add_u32 v8, v4, 15, v8
  s_lshl_b32 s30, s21, 4
  s_lshl_b32 s32, s24, 3
  s_add_u32 s30, s30, s32
  s_lshl_b32 s36, s30, 15
  v_add_u32 v46, s36, v8
  s_lshl_b32 s38, s23, 17
  s_cmp_lt_u32 s21, 5
  s_cselect_b32 s37, 0x3ea52b5c, 0x3f800000

  s_branch L_c1_epi
L_c1_lean:
  s_mov_b32 s26, 81920
  s_mov_b32 s27, 0
  v_add_u32 v16, s26, v10
  v_add_u32 v18, s27, v12
  v_add_u32 v19, s27, v13
  s_barrier
  ds_read_b64_tr_b16 v[136:137], v18 offset:0
  ds_read_b64_tr_b16 v[138:139], v18 offset:1024
  ds_read_b64_tr_b16 v[144:145], v19 offset:0
  ds_read_b64_tr_b16 v[146:147], v19 offset:1024
  ds_read_b128 v[152:155], v16 offset:0
  ds_read_b128 v[160:163], v16 offset:4096
  ds_read_b64_tr_b16 v[140:141], v18 offset:4096
  ds_read_b64_tr_b16 v[142:143], v18 offset:5120
  ds_read_b64_tr_b16 v[148:149], v19 offset:4096
  ds_read_b64_tr_b16 v[150:151], v19 offset:5120
  ds_read_b128 v[156:159], v16 offset:512
  ds_read_b128 v[164:167], v16 offset:4608
  s_waitcnt lgkmcnt(0)
  ds_read_b64_tr_b16 v[168:169], v18 offset:8192
  ds_read_b64_tr_b16 v[170:171], v18 offset:9216
  v_mfma_f32_32x32x16_bf16 v[64:79], v[136:139], v[152:155], 0
  ds_read_b64_tr_b16 v[176:177], v19 offset:8192
  ds_read_b64_tr_b16 v[178:179], v19 offset:9216
  ds_read_b128 v[184:187], v16 offset:1024
  v_mfma_f32_32x32x16_bf16 v[80:95], v[136:139], v[160:163], 0
  ds_read_b128 v[192:195], v16 offset:5120
  ds_read_b64_tr_b16 v[172:173], v18 offset:12288
  ds_read_b64_tr_b16 v[174:175], v18 offset:13312
  v_mfma_f32_32x32x16_bf16 v[96:111], v[144:147], v[152:155], 0
  ds_read_b64_tr_b16 v[180:181], v19 offset:12288
  ds_read_b64_tr_b16 v[182:183], v19 offset:13312
  ds_read_b128 v[188:191], v16 offset:1536
  v_mfma_f32_32x32x16_bf16 v[112:127], v[144:147], v[160:163], 0
  ds_read_b128 v[196:199], v16 offset:5632
  v_mfma_f32_32x32x16_bf16 v[64:79], v[140:143], v[156:159], v[64:79]
  v_mfma_f32_32x32x16_bf16 v[80:95], v[140:143], v[164:167], v[80:95]
  v_mfma_f32_32x32x16_bf16 v[96:111], v[148:151], v[156:159], v[96:111]
  v_mfma_f32_32x32x16_bf16 v[112:127], v[148:151], v[164:167], v[112:127]
  s_add_u32 s26, s26, 16384
  s_cmp_eq_u32 s26, 131072
  s_cselect_b32 s26, 81920, s26
  s_add_u32 s27, s27, 16384
  s_cmp_eq_u32 s27, 81920
  s_cselect_b32 s27, 0, s27
  v_add_u32 v16, s26, v10
  v_add_u32 v18, s27, v12
  v_add_u32 v19, s27, v13
  s_mov_b32 s25, 1
  s_waitcnt lgkmcnt(0)
L_qkv_bloop:
  s_barrier
  ds_read_b64_tr_b16 v[136:137], v18 offset:0
  ds_read_b64_tr_b16 v[138:139], v18 offset:1024
  v_mfma_f32_32x32x16_bf16 v[64:79], v[168:171], v[184:187], v[64:79]
  ds_read_b64_tr_b16 v[144:145], v19 offset:0
  ds_read_b64_tr_b16 v[146:147], v19 offset:1024
  ds_read_b128 v[152:155], v16 offset:0
  v_mfma_f32_32x32x16_bf16 v[80:95], v[168:171], v[192:195], v[80:95]
  ds_read_b128 v[160:163], v16 offset:4096
  ds_read_b64_tr_b16 v[140:141], v18 offset:4096
  ds_read_b64_tr_b16 v[142:143], v18 offset:5120
  v_mfma_f32_32x32x16_bf16 v[96:111], v[176:179], v[184:187], v[96:111]
  ds_read_b64_tr_b16 v[148:149], v19 offset:4096
  ds_read_b64_tr_b16 v[150:151], v19 offset:5120
  ds_read_b128 v[156:159], v16 offset:512
  v_mfma_f32_32x32x16_bf16 v[112:127], v[176:179], v[192:195], v[112:127]
  ds_read_b128 v[164:167], v16 offset:4608
  v_mfma_f32_32x32x16_bf16 v[64:79], v[172:175], v[188:191], v[64:79]
  v_mfma_f32_32x32x16_bf16 v[80:95], v[172:175], v[196:199], v[80:95]
  v_mfma_f32_32x32x16_bf16 v[96:111], v[180:183], v[188:191], v[96:111]
  v_mfma_f32_32x32x16_bf16 v[112:127], v[180:183], v[196:199], v[112:127]
  s_waitcnt lgkmcnt(0)
  ds_read_b64_tr_b16 v[168:169], v18 offset:8192
  ds_read_b64_tr_b16 v[170:171], v18 offset:9216
  v_mfma_f32_32x32x16_bf16 v[64:79], v[136:139], v[152:155], v[64:79]
  ds_read_b64_tr_b16 v[176:177], v19 offset:8192
  ds_read_b64_tr_b16 v[178:179], v19 offset:9216
  ds_read_b128 v[184:187], v16 offset:1024
  v_mfma_f32_32x32x16_bf16 v[80:95], v[136:139], v[160:163], v[80:95]
  ds_read_b128 v[192:195], v16 offset:5120
  ds_read_b64_tr_b16 v[172:173], v18 offset:12288
  ds_read_b64_tr_b16 v[174:175], v18 offset:13312
  v_mfma_f32_32x32x16_bf16 v[96:111], v[144:147], v[152:155], v[96:111]
  ds_read_b64_tr_b16 v[180:181], v19 offset:12288
  ds_read_b64_tr_b16 v[182:183], v19 offset:13312
  ds_read_b128 v[188:191], v16 offset:1536
  v_mfma_f32_32x32x16_bf16 v[112:127], v[144:147], v[160:163], v[112:127]
  ds_read_b128 v[196:199], v16 offset:5632
  v_mfma_f32_32x32x16_bf16 v[64:79], v[140:143], v[156:159], v[64:79]
  v_mfma_f32_32x32x16_bf16 v[80:95], v[140:143], v[164:167], v[80:95]
  v_mfma_f32_32x32x16_bf16 v[96:111], v[148:151], v[156:159], v[96:111]
  v_mfma_f32_32x32x16_bf16 v[112:127], v[148:151], v[164:167], v[112:127]
  s_add_u32 s26, s26, 16384
  s_cmp_eq_u32 s26, 131072
  s_cselect_b32 s26, 81920, s26
  s_add_u32 s27, s27, 16384
  s_cmp_eq_u32 s27, 81920
  s_cselect_b32 s27, 0, s27
  v_add_u32 v16, s26, v10
  v_add_u32 v18, s27, v12
  v_add_u32 v19, s27, v13
  s_add_u32 s25, s25, 1
  s_cmp_lt_u32 s25, 10
  s_waitcnt lgkmcnt(0)
  s_cbranch_scc1 L_qkv_bloop
  s_barrier

  s_lshl_b32 s30, s23, 9
  s_add_u32 s30, s30, 161280
  v_lshl_add_u32 v5, v3, 3, s30
  ds_read_b64 v[38:39], v5
  ds_read_b64 v[40:41], v5 offset:256
  s_lshl_b32 s30, s24, 8
  s_add_u32 s30, s30, 162304
  v_lshl_add_u32 v6, v4, 4, s30
  s_lshl_b32 s31, s23, 7

  s_xor_b32 s32, s31, 0
  v_add_u32 v7, s32, v6
  ds_read_b128 v[224:227], v7 offset:0
  ds_read_b128 v[228:231], v7 offset:32
  ds_read_b128 v[232:235], v7 offset:64
  ds_read_b128 v[236:239], v7 offset:96
  s_xor_b32 s32, s31, 128
  v_add_u32 v7, s32, v6
  ds_read_b128 v[240:243], v7 offset:0
  ds_read_b128 v[244:247], v7 offset:32
  ds_read_b128 v[248:251], v7 offset:64
  ds_read_b128 v[252:255], v7 offset:96
  s_add_u32 s12, s60, 0x00000000
  s_addc_u32 s13, s61, 0
  s_mov_b32 s14, 0x00780000
  s_mov_b32 s15, 0x00020000
  s_cmp_eq_u32 s96, 0
  s_cselect_b32 s35, 1, s46
  s_add_u32 s16, s60, 0x00d80000
  s_addc_u32 s17, s61, 0
  s_add_u32 s16, s16, s47
  s_addc_u32 s17, s17, 0
  s_mov_b32 s18, 0x00780000
  s_mov_b32 s19, 0x00020000

  s_lshl_b32 s30, s20, 7
  s_lshl_b32 s32, s23, 6
  s_add_u32 s30, s30, s32
  v_add_u32 v8, s30, v3
  v_lshlrev_b32 v8, 4, v8
  v_lshl_add_u32 v8, v4, 15, v8
  s_lshl_b32 s30, s21, 4
  s_lshl_b32 s32, s24, 3
  s_add_u32 s30, s30, s32
  s_lshl_b32 s36, s30, 15
  v_add_u32 v46, s36, v8
  s_lshl_b32 s38, s23, 17
  s_cmp_lt_u32 s21, 5
  s_cselect_b32 s37, 0x3ea52b5c, 0x3f800000

  v_mfma_f32_32x32x16_bf16 v[64:79], v[168:171], v[184:187], v[64:79]
  v_mfma_f32_32x32x16_bf16 v[80:95], v[168:171], v[192:195], v[80:95]
  v_mfma_f32_32x32x16_bf16 v[96:111], v[176:179], v[184:187], v[96:111]
  v_mfma_f32_32x32x16_bf16 v[112:127], v[176:179], v[192:195], v[112:127]
  v_mfma_f32_32x32x16_bf16 v[64:79], v[172:175], v[188:191], v[64:79]
  v_mfma_f32_32x32x16_bf16 v[80:95], v[172:175], v[196:199], v[80:95]
  v_mfma_f32_32x32x16_bf16 v[96:111], v[180:183], v[188:191], v[96:111]
  v_mfma_f32_32x32x16_bf16 v[112:127], v[180:183], v[196:199], v[112:127]
L_c1_epi:
  s_waitcnt lgkmcnt(0)
  v_mul_f32 v39, s37, v39
  v_mul_f32 v41, s37, v41
  s_nop 7
  v_pk_fma_f32 v[64:65], v[224:225], v[38:39], v[64:65] op_sel_hi:[1,0,1] neg_lo:[0,1,0] neg_hi:[0,1,0]
  v_pk_fma_f32 v[66:67], v[226:227], v[38:39], v[66:67] op_sel_hi:[1,0,1] neg_lo:[0,1,0] neg_hi:[0,1,0]
  v_pk_fma_f32 v[68:69], v[228:229], v[38:39], v[68:69] op_sel_hi:[1,0,1] neg_lo:[0,1,0] neg_hi:[0,1,0]
  v_pk_fma_f32 v[70:71], v[230:231], v[38:39], v[70:71] op_sel_hi:[1,0,1] neg_lo:[0,1,0] neg_hi:[0,1,0]
  v_pk_fma_f32 v[72:73], v[232:233], v[38:39], v[72:73] op_sel_hi:[1,0,1] neg_lo:[0,1,0] neg_hi:[0,1,0]
  v_pk_fma_f32 v[74:75], v[234:235], v[38:39], v[74:75] op_sel_hi:[1,0,1] neg_lo:[0,1,0] neg_hi:[0,1,0]
  v_pk_fma_f32 v[76:77], v[236:237], v[38:39], v[76:77] op_sel_hi:[1,0,1] neg_lo:[0,1,0] neg_hi:[0,1,0]
  v_pk_fma_f32 v[78:79], v[238:239], v[38:39], v[78:79] op_sel_hi:[1,0,1] neg_lo:[0,1,0] neg_hi:[0,1,0]
  v_pk_mul_f32 v[64:65], v[64:65], v[38:39] op_sel:[0,1] op_sel_hi:[1,1]
  v_pk_mul_f32 v[66:67], v[66:67], v[38:39] op_sel:[0,1] op_sel_hi:[1,1]
  v_pk_mul_f32 v[68:69], v[68:69], v[38:39] op_sel:[0,1] op_sel_hi:[1,1]
  v_pk_mul_f32 v[70:71], v[70:71], v[38:39] op_sel:[0,1] op_sel_hi:[1,1]
  v_pk_mul_f32 v[72:73], v[72:73], v[38:39] op_sel:[0,1] op_sel_hi:[1,1]
  v_pk_mul_f32 v[74:75], v[74:75], v[38:39] op_sel:[0,1] op_sel_hi:[1,1]
  v_pk_mul_f32 v[76:77], v[76:77], v[38:39] op_sel:[0,1] op_sel_hi:[1,1]
  v_pk_mul_f32 v[78:79], v[78:79], v[38:39] op_sel:[0,1] op_sel_hi:[1,1]
  v_cvt_pk_bf16_f32 v64, v64, v65
  v_cvt_pk_bf16_f32 v65, v66, v67
  v_cvt_pk_bf16_f32 v66, v68, v69
  v_cvt_pk_bf16_f32 v67, v70, v71
  v_cvt_pk_bf16_f32 v68, v72, v73
  v_cvt_pk_bf16_f32 v69, v74, v75
  v_cvt_pk_bf16_f32 v70, v76, v77
  v_cvt_pk_bf16_f32 v71, v78, v79
  s_xor_b32 s32, s38, 0
  s_add_u32 s32, s32, 0
  s_add_u32 s33, s32, 65536
  v_permlane32_swap_b32 v64, v66
  v_permlane32_swap_b32 v65, v67
  v_permlane32_swap_b32 v68, v70
  v_permlane32_swap_b32 v69, v71
  s_cmp_lt_u32 s21, 5
  s_cbranch_scc1 L_nokv_1
  buffer_store_dwordx4 v[64:67], v46, s[16:19], s32 offen sc1
  buffer_store_dwordx4 v[68:71], v46, s[16:19], s33 offen sc1
  s_branch L_kv_2
L_nokv_1:
  s_cmp_eq_u32 s35, 0
  s_cbranch_scc0 L_slow_1
  buffer_store_dwordx4 v[64:67], v46, s[12:15], s32 offen
  buffer_store_dwordx4 v[68:71], v46, s[12:15], s33 offen
L_back_1:
L_kv_2:
  v_pk_fma_f32 v[96:97], v[240:241], v[38:39], v[96:97] op_sel_hi:[1,0,1] neg_lo:[0,1,0] neg_hi:[0,1,0]
  v_pk_fma_f32 v[98:99], v[242:243], v[38:39], v[98:99] op_sel_hi:[1,0,1] neg_lo:[0,1,0] neg_hi:[0,1,0]
  v_pk_fma_f32 v[100:101], v[244:245], v[38:39], v[100:101] op_sel_hi:[1,0,1] neg_lo:[0,1,0] neg_hi:[0,1,0]
  v_pk_fma_f32 v[102:103], v[246:247], v[38:39], v[102:103] op_sel_hi:[1,0,1] neg_lo:[0,1,0] neg_hi:[0,1,0]
  v_pk_fma_f32 v[104:105], v[248:249], v[38:39], v[104:105] op_sel_hi:[1,0,1] neg_lo:[0,1,0] neg_hi:[0,1,0]
  v_pk_fma_f32 v[106:107], v[250:251], v[38:39], v[106:107] op_sel_hi:[1,0,1] neg_lo:[0,1,0] neg_hi:[0,1,0]
  v_pk_fma_f32 v[108:109], v[252:253], v[38:39], v[108:109] op_sel_hi:[1,0,1] neg_lo:[0,1,0] neg_hi:[0,1,0]
  v_pk_fma_f32 v[110:111], v[254:255], v[38:39], v[110:111] op_sel_hi:[1,0,1] neg_lo:[0,1,0] neg_hi:[0,1,0]
  v_pk_mul_f32 v[96:97], v[96:97], v[38:39] op_sel:[0,1] op_sel_hi:[1,1]
  v_pk_mul_f32 v[98:99], v[98:99], v[38:39] op_sel:[0,1] op_sel_hi:[1,1]
  v_pk_mul_f32 v[100:101], v[100:101], v[38:39] op_sel:[0,1] op_sel_hi:[1,1]
  v_pk_mul_f32 v[102:103], v[102:103], v[38:39] op_sel:[0,1] op_sel_hi:[1,1]
  v_pk_mul_f32 v[104:105], v[104:105], v[38:39] op_sel:[0,1] op_sel_hi:[1,1]
  v_pk_mul_f32 v[106:107], v[106:107], v[38:39] op_sel:[0,1] op_sel_hi:[1,1]
  v_pk_mul_f32 v[108:109], v[108:109], v[38:39] op_sel:[0,1] op_sel_hi:[1,1]
  v_pk_mul_f32 v[110:111], v[110:111], v[38:39] op_sel:[0,1] op_sel_hi:[1,1]
  v_cvt_pk_bf16_f32 v96, v96, v97
  v_cvt_pk_bf16_f32 v97, v98, v99
  v_cvt_pk_bf16_f32 v98, v100, v101
  v_cvt_pk_bf16_f32 v99, v102, v103
  v_cvt_pk_bf16_f32 v100, v104, v105
  v_cvt_pk_bf16_f32 v101, v106, v107
  v_cvt_pk_bf16_f32 v102, v108, v109
  v_cvt_pk_bf16_f32 v103, v110, v111
  s_xor_b32 s32, s38, 131072
  s_add_u32 s32, s32, 0
  s_add_u32 s33, s32, 65536
  v_permlane32_swap_b32 v96, v98
  v_permlane32_swap_b32 v97, v99
  v_permlane32_swap_b32 v100, v102
  v_permlane32_swap_b32 v101, v103
  s_cmp_lt_u32 s21, 5
  s_cbranch_scc1 L_nokv_3
  buffer_store_dwordx4 v[96:99], v46, s[16:19], s32 offen sc1
  buffer_store_dwordx4 v[100:103], v46, s[16:19], s33 offen sc1
  s_branch L_kv_4
L_nokv_3:
  s_cmp_eq_u32 s35, 0
  s_cbranch_scc0 L_slow_2
  buffer_store_dwordx4 v[96:99], v46, s[12:15], s32 offen
  buffer_store_dwordx4 v[100:103], v46, s[12:15], s33 offen
L_back_2:
L_kv_4:
  v_pk_fma_f32 v[80:81], v[224:225], v[40:41], v[80:81] op_sel_hi:[1,0,1] neg_lo:[0,1,0] neg_hi:[0,1,0]
  v_pk_fma_f32 v[82:83], v[226:227], v[40:41], v[82:83] op_sel_hi:[1,0,1] neg_lo:[0,1,0] neg_hi:[0,1,0]
  v_pk_fma_f32 v[84:85], v[228:229], v[40:41], v[84:85] op_sel_hi:[1,0,1] neg_lo:[0,1,0] neg_hi:[0,1,0]
  v_pk_fma_f32 v[86:87], v[230:231], v[40:41], v[86:87] op_sel_hi:[1,0,1] neg_lo:[0,1,0] neg_hi:[0,1,0]
  v_pk_fma_f32 v[88:89], v[232:233], v[40:41], v[88:89] op_sel_hi:[1,0,1] neg_lo:[0,1,0] neg_hi:[0,1,0]
  v_pk_fma_f32 v[90:91], v[234:235], v[40:41], v[90:91] op_sel_hi:[1,0,1] neg_lo:[0,1,0] neg_hi:[0,1,0]
  v_pk_fma_f32 v[92:93], v[236:237], v[40:41], v[92:93] op_sel_hi:[1,0,1] neg_lo:[0,1,0] neg_hi:[0,1,0]
  v_pk_fma_f32 v[94:95], v[238:239], v[40:41], v[94:95] op_sel_hi:[1,0,1] neg_lo:[0,1,0] neg_hi:[0,1,0]
  v_pk_mul_f32 v[80:81], v[80:81], v[40:41] op_sel:[0,1] op_sel_hi:[1,1]
  v_pk_mul_f32 v[82:83], v[82:83], v[40:41] op_sel:[0,1] op_sel_hi:[1,1]
  v_pk_mul_f32 v[84:85], v[84:85], v[40:41] op_sel:[0,1] op_sel_hi:[1,1]
  v_pk_mul_f32 v[86:87], v[86:87], v[40:41] op_sel:[0,1] op_sel_hi:[1,1]
  v_pk_mul_f32 v[88:89], v[88:89], v[40:41] op_sel:[0,1] op_sel_hi:[1,1]
  v_pk_mul_f32 v[90:91], v[90:91], v[40:41] op_sel:[0,1] op_sel_hi:[1,1]
  v_pk_mul_f32 v[92:93], v[92:93], v[40:41] op_sel:[0,1] op_sel_hi:[1,1]
  v_pk_mul_f32 v[94:95], v[94:95], v[40:41] op_sel:[0,1] op_sel_hi:[1,1]
  v_cvt_pk_bf16_f32 v80, v80, v81
  v_cvt_pk_bf16_f32 v81, v82, v83
  v_cvt_pk_bf16_f32 v82, v84, v85
  v_cvt_pk_bf16_f32 v83, v86, v87
  v_cvt_pk_bf16_f32 v84, v88, v89
  v_cvt_pk_bf16_f32 v85, v90, v91
  v_cvt_pk_bf16_f32 v86, v92, v93
  v_cvt_pk_bf16_f32 v87, v94, v95
  s_xor_b32 s32, s38, 0
  s_add_u32 s32, s32, 512
  s_add_u32 s33, s32, 65536
  v_permlane32_swap_b32 v80, v82
  v_permlane32_swap_b32 v81, v83
  v_permlane32_swap_b32 v84, v86
  v_permlane32_swap_b32 v85, v87
  s_cmp_lt_u32 s21, 5
  s_cbranch_scc1 L_nokv_5
  buffer_store_dwordx4 v[80:83], v46, s[16:19], s32 offen sc1
  buffer_store_dwordx4 v[84:87], v46, s[16:19], s33 offen sc1
  s_branch L_kv_6
L_nokv_5:
  s_cmp_eq_u32 s35, 0
  s_cbranch_scc0 L_slow_3
  buffer_store_dwordx4 v[80:83], v46, s[12:15], s32 offen
  buffer_store_dwordx4 v[84:87], v46, s[12:15], s33 offen
L_back_3:
L_kv_6:
  v_pk_fma_f32 v[112:113], v[240:241], v[40:41], v[112:113] op_sel_hi:[1,0,1] neg_lo:[0,1,0] neg_hi:[0,1,0]
  v_pk_fma_f32 v[114:115], v[242:243], v[40:41], v[114:115] op_sel_hi:[1,0,1] neg_lo:[0,1,0] neg_hi:[0,1,0]
  v_pk_fma_f32 v[116:117], v[244:245], v[40:41], v[116:117] op_sel_hi:[1,0,1] neg_lo:[0,1,0] neg_hi:[0,1,0]
  v_pk_fma_f32 v[118:119], v[246:247], v[40:41], v[118:119] op_sel_hi:[1,0,1] neg_lo:[0,1,0] neg_hi:[0,1,0]
  v_pk_fma_f32 v[120:121], v[248:249], v[40:41], v[120:121] op_sel_hi:[1,0,1] neg_lo:[0,1,0] neg_hi:[0,1,0]
  v_pk_fma_f32 v[122:123], v[250:251], v[40:41], v[122:123] op_sel_hi:[1,0,1] neg_lo:[0,1,0] neg_hi:[0,1,0]
  v_pk_fma_f32 v[124:125], v[252:253], v[40:41], v[124:125] op_sel_hi:[1,0,1] neg_lo:[0,1,0] neg_hi:[0,1,0]
  v_pk_fma_f32 v[126:127], v[254:255], v[40:41], v[126:127] op_sel_hi:[1,0,1] neg_lo:[0,1,0] neg_hi:[0,1,0]
  v_pk_mul_f32 v[112:113], v[112:113], v[40:41] op_sel:[0,1] op_sel_hi:[1,1]
  v_pk_mul_f32 v[114:115], v[114:115], v[40:41] op_sel:[0,1] op_sel_hi:[1,1]
  v_pk_mul_f32 v[116:117], v[116:117], v[40:41] op_sel:[0,1] op_sel_hi:[1,1]
  v_pk_mul_f32 v[118:119], v[118:119], v[40:41] op_sel:[0,1] op_sel_hi:[1,1]
  v_pk_mul_f32 v[120:121], v[120:121], v[40:41] op_sel:[0,1] op_sel_hi:[1,1]
  v_pk_mul_f32 v[122:123], v[122:123], v[40:41] op_sel:[0,1] op_sel_hi:[1,1]
  v_pk_mul_f32 v[124:125], v[124:125], v[40:41] op_sel:[0,1] op_sel_hi:[1,1]
  v_pk_mul_f32 v[126:127], v[126:127], v[40:41] op_sel:[0,1] op_sel_hi:[1,1]
  v_cvt_pk_bf16_f32 v112, v112, v113
  v_cvt_pk_bf16_f32 v113, v114, v115
  v_cvt_pk_bf16_f32 v114, v116, v117
  v_cvt_pk_bf16_f32 v115, v118, v119
  v_cvt_pk_bf16_f32 v116, v120, v121
  v_cvt_pk_bf16_f32 v117, v122, v123
  v_cvt_pk_bf16_f32 v118, v124, v125
  v_cvt_pk_bf16_f32 v119, v126, v127
  s_xor_b32 s32, s38, 131072
  s_add_u32 s32, s32, 512
  s_add_u32 s33, s32, 65536
  v_permlane32_swap_b32 v112, v114
  v_permlane32_swap_b32 v113, v115
  v_permlane32_swap_b32 v116, v118
  v_permlane32_swap_b32 v117, v119
  s_cmp_lt_u32 s21, 5
  s_cbranch_scc1 L_nokv_7
  buffer_store_dwordx4 v[112:115], v46, s[16:19], s32 offen sc1
  buffer_store_dwordx4 v[116:119], v46, s[16:19], s33 offen sc1
  s_branch L_kv_8
L_nokv_7:
  s_cmp_eq_u32 s35, 0
  s_cbranch_scc0 L_slow_4
  buffer_store_dwordx4 v[112:115], v46, s[12:15], s32 offen
  buffer_store_dwordx4 v[116:119], v46, s[12:15], s33 offen
L_back_4:
L_kv_8:
  s_cmp_lt_u32 s21, 5
  s_cbranch_scc1 L_nokv2_9
  s_xor_b32 s32, s38, 0
  s_add_u32 s32, s32, 0
  s_add_u32 s33, s32, 65536
  s_cmp_eq_u32 s35, 0
  s_cbranch_scc0 L_slow_5
  buffer_store_dwordx4 v[64:67], v46, s[12:15], s32 offen
  buffer_store_dwordx4 v[68:71], v46, s[12:15], s33 offen
L_back_5:
  s_xor_b32 s32, s38, 131072
  s_add_u32 s32, s32, 0
  s_add_u32 s33, s32, 65536
  s_cmp_eq_u32 s35, 0
  s_cbranch_scc0 L_slow_6
  buffer_store_dwordx4 v[96:99], v46, s[12:15], s32 offen
  buffer_store_dwordx4 v[100:103], v46, s[12:15], s33 offen
L_back_6:
  s_xor_b32 s32, s38, 0
  s_add_u32 s32, s32, 512
  s_add_u32 s33, s32, 65536
  s_cmp_eq_u32 s35, 0
  s_cbranch_scc0 L_slow_7
  buffer_store_dwordx4 v[80:83], v46, s[12:15], s32 offen
  buffer_store_dwordx4 v[84:87], v46, s[12:15], s33 offen
L_back_7:
  s_xor_b32 s32, s38, 131072
  s_add_u32 s32, s32, 512
  s_add_u32 s33, s32, 65536
  s_cmp_eq_u32 s35, 0
  s_cbranch_scc0 L_slow_8
  buffer_store_dwordx4 v[112:115], v46, s[12:15], s32 offen
  buffer_store_dwordx4 v[116:119], v46, s[12:15], s33 offen
L_back_8:
L_nokv2_9:
  s_branch L_c1_tail
L_c1_idle:
  s_cmp_eq_u32 s96, 0
  s_cbranch_scc0 L_c1_idle2

  v_and_b32 v2, 63, v0
  s_lshl_b32 s30, s20, 7
  s_lshl_b32 s31, s22, 4
  s_add_u32 s30, s30, s31
  v_lshrrev_b32 v5, 3, v2
  v_add_u32 v5, s30, v5
  v_mul_u32_u24 v6, 1280, v5
  v_and_b32 v7, 7, v2
  v_lshl_add_u32 v6, v7, 4, v6

  s_add_u32 s4, s40, 0x00000000
  s_addc_u32 s5, s41, 0
  s_mov_b32 s6, 0x00280000
  s_mov_b32 s7, 0x00020000
  buffer_load_dwordx4 v[64:67], v6, s[4:7], 0 offen offset:0
  buffer_load_dwordx4 v[68:71], v6, s[4:7], 0 offen offset:128
  buffer_load_dwordx4 v[72:75], v6, s[4:7], 0 offen offset:256
  buffer_load_dwordx4 v[76:79], v6, s[4:7], 0 offen offset:384
  buffer_load_dwordx4 v[80:83], v6, s[4:7], 0 offen offset:512
  buffer_load_dwordx4 v[84:87], v6, s[4:7], 0 offen offset:640
  buffer_load_dwordx4 v[88:91], v6, s[4:7], 0 offen offset:768
  buffer_load_dwordx4 v[92:95], v6, s[4:7], 0 offen offset:896
  buffer_load_dwordx4 v[96:99], v6, s[4:7], 0 offen offset:1024
  buffer_load_dwordx4 v[100:103], v6, s[4:7], 0 offen offset:1152
  s_mov_b32 s31, 10240
  buffer_load_dwordx4 v[104:107], v6, s[4:7], s31 offen offset:0
  s_mov_b32 s31, 10240
  buffer_load_dwordx4 v[108:111], v6, s[4:7], s31 offen offset:128
  s_mov_b32 s31, 10240
  buffer_load_dwordx4 v[112:115], v6, s[4:7], s31 offen offset:256
  s_mov_b32 s31, 10240
  buffer_load_dwordx4 v[116:119], v6, s[4:7], s31 offen offset:384
  s_mov_b32 s31, 10240
  buffer_load_dwordx4 v[120:123], v6, s[4:7], s31 offen offset:512
  s_mov_b32 s31, 10240
  buffer_load_dwordx4 v[124:127], v6, s[4:7], s31 offen offset:640
  s_mov_b32 s31, 10240
  buffer_load_dwordx4 v[128:131], v6, s[4:7], s31 offen offset:768
  s_mov_b32 s31, 10240
  buffer_load_dwordx4 v[132:135], v6, s[4:7], s31 offen offset:896
  s_mov_b32 s31, 10240
  buffer_load_dwordx4 v[136:139], v6, s[4:7], s31 offen offset:1024
  s_mov_b32 s31, 10240
  buffer_load_dwordx4 v[140:143], v6, s[4:7], s31 offen offset:1152
  v_mov_b32 v24, 0
  v_mov_b32 v25, 0
  v_mov_b32 v26, 0
  v_mov_b32 v27, 0
  v_mov_b32 v28, 0
  v_mov_b32 v29, 0
  v_mov_b32 v30, 0
  v_mov_b32 v31, 0
  s_waitcnt vmcnt(19)
  v_lshlrev_b32 v40, 16, v64
  v_and_b32 v41, 0xffff0000, v64
  v_pk_add_f32 v[24:25], v[24:25], v[40:41]
  v_pk_fma_f32 v[26:27], v[40:41], v[40:41], v[26:27]
  v_lshlrev_b32 v42, 16, v65
  v_and_b32 v43, 0xffff0000, v65
  v_pk_add_f32 v[24:25], v[24:25], v[42:43]
  v_pk_fma_f32 v[26:27], v[42:43], v[42:43], v[26:27]
  v_lshlrev_b32 v44, 16, v66
  v_and_b32 v45, 0xffff0000, v66
  v_pk_add_f32 v[24:25], v[24:25], v[44:45]
  v_pk_fma_f32 v[26:27], v[44:45], v[44:45], v[26:27]
  v_lshlrev_b32 v46, 16, v67
  v_and_b32 v47, 0xffff0000, v67
  v_pk_add_f32 v[24:25], v[24:25], v[46:47]
  v_pk_fma_f32 v[26:27], v[46:47], v[46:47], v[26:27]
  s_waitcnt vmcnt(18)
  v_lshlrev_b32 v40, 16, v68
  v_and_b32 v41, 0xffff0000, v68
  v_pk_add_f32 v[24:25], v[24:25], v[40:41]
  v_pk_fma_f32 v[26:27], v[40:41], v[40:41], v[26:27]
  v_lshlrev_b32 v42, 16, v69
  v_and_b32 v43, 0xffff0000, v69
  v_pk_add_f32 v[24:25], v[24:25], v[42:43]
  v_pk_fma_f32 v[26:27], v[42:43], v[42:43], v[26:27]
  v_lshlrev_b32 v44, 16, v70
  v_and_b32 v45, 0xffff0000, v70
  v_pk_add_f32 v[24:25], v[24:25], v[44:45]
  v_pk_fma_f32 v[26:27], v[44:45], v[44:45], v[26:27]
  v_lshlrev_b32 v46, 16, v71
  v_and_b32 v47, 0xffff0000, v71
  v_pk_add_f32 v[24:25], v[24:25], v[46:47]
  v_pk_fma_f32 v[26:27], v[46:47], v[46:47], v[26:27]
  s_waitcnt vmcnt(17)
  v_lshlrev_b32 v40, 16, v72
  v_and_b32 v41, 0xffff0000, v72
  v_pk_add_f32 v[24:25], v[24:25], v[40:41]
  v_pk_fma_f32 v[26:27], v[40:41], v[40:41], v[26:27]
  v_lshlrev_b32 v42, 16, v73
  v_and_b32 v43, 0xffff0000, v73
  v_pk_add_f32 v[24:25], v[24:25], v[42:43]
  v_pk_fma_f32 v[26:27], v[42:43], v[42:43], v[26:27]
  v_lshlrev_b32 v44, 16, v74
  v_and_b32 v45, 0xffff0000, v74
  v_pk_add_f32 v[24:25], v[24:25], v[44:45]
  v_pk_fma_f32 v[26:27], v[44:45], v[44:45], v[26:27]
  v_lshlrev_b32 v46, 16, v75
  v_and_b32 v47, 0xffff0000, v75
  v_pk_add_f32 v[24:25], v[24:25], v[46:47]
  v_pk_fma_f32 v[26:27], v[46:47], v[46:47], v[26:27]
  s_waitcnt vmcnt(16)
  v_lshlrev_b32 v40, 16, v76
  v_and_b32 v41, 0xffff0000, v76
  v_pk_add_f32 v[24:25], v[24:25], v[40:41]
  v_pk_fma_f32 v[26:27], v[40:41], v[40:41], v[26:27]
  v_lshlrev_b32 v42, 16, v77
  v_and_b32 v43, 0xffff0000, v77
  v_pk_add_f32 v[24:25], v[24:25], v[42:43]
  v_pk_fma_f32 v[26:27], v[42:43], v[42:43], v[26:27]
  v_lshlrev_b32 v44, 16, v78
  v_and_b32 v45, 0xffff0000, v78
  v_pk_add_f32 v[24:25], v[24:25], v[44:45]
  v_pk_fma_f32 v[26:27], v[44:45], v[44:45], v[26:27]
  v_lshlrev_b32 v46, 16, v79
  v_and_b32 v47, 0xffff0000, v79
  v_pk_add_f32 v[24:25], v[24:25], v[46:47]
  v_pk_fma_f32 v[26:27], v[46:47], v[46:47], v[26:27]
  s_waitcnt vmcnt(15)
  v_lshlrev_b32 v40, 16, v80
  v_and_b32 v41, 0xffff0000, v80
  v_pk_add_f32 v[24:25], v[24:25], v[40:41]
  v_pk_fma_f32 v[26:27], v[40:41], v[40:41], v[26:27]
  v_lshlrev_b32 v42, 16, v81
  v_and_b32 v43, 0xffff0000, v81
  v_pk_add_f32 v[24:25], v[24:25], v[42:43]
  v_pk_fma_f32 v[26:27], v[42:43], v[42:43], v[26:27]
  v_lshlrev_b32 v44, 16, v82
  v_and_b32 v45, 0xffff0000, v82
  v_pk_add_f32 v[24:25], v[24:25], v[44:45]
  v_pk_fma_f32 v[26:27], v[44:45], v[44:45], v[26:27]
  v_lshlrev_b32 v46, 16, v83
  v_and_b32 v47, 0xffff0000, v83
  v_pk_add_f32 v[24:25], v[24:25], v[46:47]
  v_pk_fma_f32 v[26:27], v[46:47], v[46:47], v[26:27]
  s_waitcnt vmcnt(14)
  v_lshlrev_b32 v40, 16, v84
  v_and_b32 v41, 0xffff0000, v84
  v_pk_add_f32 v[24:25], v[24:25], v[40:41]
  v_pk_fma_f32 v[26:27], v[40:41], v[40:41], v[26:27]
  v_lshlrev_b32 v42, 16, v85
  v_and_b32 v43, 0xffff0000, v85
  v_pk_add_f32 v[24:25], v[24:25], v[42:43]
  v_pk_fma_f32 v[26:27], v[42:43], v[42:43], v[26:27]
  v_lshlrev_b32 v44, 16, v86
  v_and_b32 v45, 0xffff0000, v86
  v_pk_add_f32 v[24:25], v[24:25], v[44:45]
  v_pk_fma_f32 v[26:27], v[44:45], v[44:45], v[26:27]
  v_lshlrev_b32 v46, 16, v87
  v_and_b32 v47, 0xffff0000, v87
  v_pk_add_f32 v[24:25], v[24:25], v[46:47]
  v_pk_fma_f32 v[26:27], v[46:47], v[46:47], v[26:27]
  s_waitcnt vmcnt(13)
  v_lshlrev_b32 v40, 16, v88
  v_and_b32 v41, 0xffff0000, v88
  v_pk_add_f32 v[24:25], v[24:25], v[40:41]
  v_pk_fma_f32 v[26:27], v[40:41], v[40:41], v[26:27]
  v_lshlrev_b32 v42, 16, v89
  v_and_b32 v43, 0xffff0000, v89
  v_pk_add_f32 v[24:25], v[24:25], v[42:43]
  v_pk_fma_f32 v[26:27], v[42:43], v[42:43], v[26:27]
  v_lshlrev_b32 v44, 16, v90
  v_and_b32 v45, 0xffff0000, v90
  v_pk_add_f32 v[24:25], v[24:25], v[44:45]
  v_pk_fma_f32 v[26:27], v[44:45], v[44:45], v[26:27]
  v_lshlrev_b32 v46, 16, v91
  v_and_b32 v47, 0xffff0000, v91
  v_pk_add_f32 v[24:25], v[24:25], v[46:47]
  v_pk_fma_f32 v[26:27], v[46:47], v[46:47], v[26:27]
  s_waitcnt vmcnt(12)
  v_lshlrev_b32 v40, 16, v92
  v_and_b32 v41, 0xffff0000, v92
  v_pk_add_f32 v[24:25], v[24:25], v[40:41]
  v_pk_fma_f32 v[26:27], v[40:41], v[40:41], v[26:27]
  v_lshlrev_b32 v42, 16, v93
  v_and_b32 v43, 0xffff0000, v93
  v_pk_add_f32 v[24:25], v[24:25], v[42:43]
  v_pk_fma_f32 v[26:27], v[42:43], v[42:43], v[26:27]
  v_lshlrev_b32 v44, 16, v94
  v_and_b32 v45, 0xffff0000, v94
  v_pk_add_f32 v[24:25], v[24:25], v[44:45]
  v_pk_fma_f32 v[26:27], v[44:45], v[44:45], v[26:27]
  v_lshlrev_b32 v46, 16, v95
  v_and_b32 v47, 0xffff0000, v95
  v_pk_add_f32 v[24:25], v[24:25], v[46:47]
  v_pk_fma_f32 v[26:27], v[46:47], v[46:47], v[26:27]
  s_waitcnt vmcnt(11)
  v_lshlrev_b32 v40, 16, v96
  v_and_b32 v41, 0xffff0000, v96
  v_pk_add_f32 v[24:25], v[24:25], v[40:41]
  v_pk_fma_f32 v[26:27], v[40:41], v[40:41], v[26:27]
  v_lshlrev_b32 v42, 16, v97
  v_and_b32 v43, 0xffff0000, v97
  v_pk_add_f32 v[24:25], v[24:25], v[42:43]
  v_pk_fma_f32 v[26:27], v[42:43], v[42:43], v[26:27]
  v_lshlrev_b32 v44, 16, v98
  v_and_b32 v45, 0xffff0000, v98
  v_pk_add_f32 v[24:25], v[24:25], v[44:45]
  v_pk_fma_f32 v[26:27], v[44:45], v[44:45], v[26:27]
  v_lshlrev_b32 v46, 16, v99
  v_and_b32 v47, 0xffff0000, v99
  v_pk_add_f32 v[24:25], v[24:25], v[46:47]
  v_pk_fma_f32 v[26:27], v[46:47], v[46:47], v[26:27]
  s_waitcnt vmcnt(10)
  v_lshlrev_b32 v40, 16, v100
  v_and_b32 v41, 0xffff0000, v100
  v_pk_add_f32 v[24:25], v[24:25], v[40:41]
  v_pk_fma_f32 v[26:27], v[40:41], v[40:41], v[26:27]
  v_lshlrev_b32 v42, 16, v101
  v_and_b32 v43, 0xffff0000, v101
  v_pk_add_f32 v[24:25], v[24:25], v[42:43]
  v_pk_fma_f32 v[26:27], v[42:43], v[42:43], v[26:27]
  v_lshlrev_b32 v44, 16, v102
  v_and_b32 v45, 0xffff0000, v102
  v_pk_add_f32 v[24:25], v[24:25], v[44:45]
  v_pk_fma_f32 v[26:27], v[44:45], v[44:45], v[26:27]
  v_lshlrev_b32 v46, 16, v103
  v_and_b32 v47, 0xffff0000, v103
  v_pk_add_f32 v[24:25], v[24:25], v[46:47]
  v_pk_fma_f32 v[26:27], v[46:47], v[46:47], v[26:27]
  s_waitcnt vmcnt(9)
  v_lshlrev_b32 v40, 16, v104
  v_and_b32 v41, 0xffff0000, v104
  v_pk_add_f32 v[28:29], v[28:29], v[40:41]
  v_pk_fma_f32 v[30:31], v[40:41], v[40:41], v[30:31]
  v_lshlrev_b32 v42, 16, v105
  v_and_b32 v43, 0xffff0000, v105
  v_pk_add_f32 v[28:29], v[28:29], v[42:43]
  v_pk_fma_f32 v[30:31], v[42:43], v[42:43], v[30:31]
  v_lshlrev_b32 v44, 16, v106
  v_and_b32 v45, 0xffff0000, v106
  v_pk_add_f32 v[28:29], v[28:29], v[44:45]
  v_pk_fma_f32 v[30:31], v[44:45], v[44:45], v[30:31]
  v_lshlrev_b32 v46, 16, v107
  v_and_b32 v47, 0xffff0000, v107
  v_pk_add_f32 v[28:29], v[28:29], v[46:47]
  v_pk_fma_f32 v[30:31], v[46:47], v[46:47], v[30:31]
  s_waitcnt vmcnt(8)
  v_lshlrev_b32 v40, 16, v108
  v_and_b32 v41, 0xffff0000, v108
  v_pk_add_f32 v[28:29], v[28:29], v[40:41]
  v_pk_fma_f32 v[30:31], v[40:41], v[40:41], v[30:31]
  v_lshlrev_b32 v42, 16, v109
  v_and_b32 v43, 0xffff0000, v109
  v_pk_add_f32 v[28:29], v[28:29], v[42:43]
  v_pk_fma_f32 v[30:31], v[42:43], v[42:43], v[30:31]
  v_lshlrev_b32 v44, 16, v110
  v_and_b32 v45, 0xffff0000, v110
  v_pk_add_f32 v[28:29], v[28:29], v[44:45]
  v_pk_fma_f32 v[30:31], v[44:45], v[44:45], v[30:31]
  v_lshlrev_b32 v46, 16, v111
  v_and_b32 v47, 0xffff0000, v111
  v_pk_add_f32 v[28:29], v[28:29], v[46:47]
  v_pk_fma_f32 v[30:31], v[46:47], v[46:47], v[30:31]
  s_waitcnt vmcnt(7)
  v_lshlrev_b32 v40, 16, v112
  v_and_b32 v41, 0xffff0000, v112
  v_pk_add_f32 v[28:29], v[28:29], v[40:41]
  v_pk_fma_f32 v[30:31], v[40:41], v[40:41], v[30:31]
  v_lshlrev_b32 v42, 16, v113
  v_and_b32 v43, 0xffff0000, v113
  v_pk_add_f32 v[28:29], v[28:29], v[42:43]
  v_pk_fma_f32 v[30:31], v[42:43], v[42:43], v[30:31]
  v_lshlrev_b32 v44, 16, v114
  v_and_b32 v45, 0xffff0000, v114
  v_pk_add_f32 v[28:29], v[28:29], v[44:45]
  v_pk_fma_f32 v[30:31], v[44:45], v[44:45], v[30:31]
  v_lshlrev_b32 v46, 16, v115
  v_and_b32 v47, 0xffff0000, v115
  v_pk_add_f32 v[28:29], v[28:29], v[46:47]
  v_pk_fma_f32 v[30:31], v[46:47], v[46:47], v[30:31]
  s_waitcnt vmcnt(6)
  v_lshlrev_b32 v40, 16, v116
  v_and_b32 v41, 0xffff0000, v116
  v_pk_add_f32 v[28:29], v[28:29], v[40:41]
  v_pk_fma_f32 v[30:31], v[40:41], v[40:41], v[30:31]
  v_lshlrev_b32 v42, 16, v117
  v_and_b32 v43, 0xffff0000, v117
  v_pk_add_f32 v[28:29], v[28:29], v[42:43]
  v_pk_fma_f32 v[30:31], v[42:43], v[42:43], v[30:31]
  v_lshlrev_b32 v44, 16, v118
  v_and_b32 v45, 0xffff0000, v118
  v_pk_add_f32 v[28:29], v[28:29], v[44:45]
  v_pk_fma_f32 v[30:31], v[44:45], v[44:45], v[30:31]
  v_lshlrev_b32 v46, 16, v119
  v_and_b32 v47, 0xffff0000, v119
  v_pk_add_f32 v[28:29], v[28:29], v[46:47]
  v_pk_fma_f32 v[30:31], v[46:47], v[46:47], v[30:31]
  s_waitcnt vmcnt(5)
  v_lshlrev_b32 v40, 16, v120
  v_and_b32 v41, 0xffff0000, v120
  v_pk_add_f32 v[28:29], v[28:29], v[40:41]
  v_pk_fma_f32 v[30:31], v[40:41], v[40:41], v[30:31]
  v_lshlrev_b32 v42, 16, v121
  v_and_b32 v43, 0xffff0000, v121
  v_pk_add_f32 v[28:29], v[28:29], v[42:43]
  v_pk_fma_f32 v[30:31], v[42:43], v[42:43], v[30:31]
  v_lshlrev_b32 v44, 16, v122
  v_and_b32 v45, 0xffff0000, v122
  v_pk_add_f32 v[28:29], v[28:29], v[44:45]
  v_pk_fma_f32 v[30:31], v[44:45], v[44:45], v[30:31]
  v_lshlrev_b32 v46, 16, v123
  v_and_b32 v47, 0xffff0000, v123
  v_pk_add_f32 v[28:29], v[28:29], v[46:47]
  v_pk_fma_f32 v[30:31], v[46:47], v[46:47], v[30:31]
  s_waitcnt vmcnt(4)
  v_lshlrev_b32 v40, 16, v124
  v_and_b32 v41, 0xffff0000, v124
  v_pk_add_f32 v[28:29], v[28:29], v[40:41]
  v_pk_fma_f32 v[30:31], v[40:41], v[40:41], v[30:31]
  v_lshlrev_b32 v42, 16, v125
  v_and_b32 v43, 0xffff0000, v125
  v_pk_add_f32 v[28:29], v[28:29], v[42:43]
  v_pk_fma_f32 v[30:31], v[42:43], v[42:43], v[30:31]
  v_lshlrev_b32 v44, 16, v126
  v_and_b32 v45, 0xffff0000, v126
  v_pk_add_f32 v[28:29], v[28:29], v[44:45]
  v_pk_fma_f32 v[30:31], v[44:45], v[44:45], v[30:31]
  v_lshlrev_b32 v46, 16, v127
  v_and_b32 v47, 0xffff0000, v127
  v_pk_add_f32 v[28:29], v[28:29], v[46:47]
  v_pk_fma_f32 v[30:31], v[46:47], v[46:47], v[30:31]
  s_waitcnt vmcnt(3)
  v_lshlrev_b32 v40, 16, v128
  v_and_b32 v41, 0xffff0000, v128
  v_pk_add_f32 v[28:29], v[28:29], v[40:41]
  v_pk_fma_f32 v[30:31], v[40:41], v[40:41], v[30:31]
  v_lshlrev_b32 v42, 16, v129
  v_and_b32 v43, 0xffff0000, v129
  v_pk_add_f32 v[28:29], v[28:29], v[42:43]
  v_pk_fma_f32 v[30:31], v[42:43], v[42:43], v[30:31]
  v_lshlrev_b32 v44, 16, v130
  v_and_b32 v45, 0xffff0000, v130
  v_pk_add_f32 v[28:29], v[28:29], v[44:45]
  v_pk_fma_f32 v[30:31], v[44:45], v[44:45], v[30:31]
  v_lshlrev_b32 v46, 16, v131
  v_and_b32 v47, 0xffff0000, v131
  v_pk_add_f32 v[28:29], v[28:29], v[46:47]
  v_pk_fma_f32 v[30:31], v[46:47], v[46:47], v[30:31]
  s_waitcnt vmcnt(2)
  v_lshlrev_b32 v40, 16, v132
  v_and_b32 v41, 0xffff0000, v132
  v_pk_add_f32 v[28:29], v[28:29], v[40:41]
  v_pk_fma_f32 v[30:31], v[40:41], v[40:41], v[30:31]
  v_lshlrev_b32 v42, 16, v133
  v_and_b32 v43, 0xffff0000, v133
  v_pk_add_f32 v[28:29], v[28:29], v[42:43]
  v_pk_fma_f32 v[30:31], v[42:43], v[42:43], v[30:31]
  v_lshlrev_b32 v44, 16, v134
  v_and_b32 v45, 0xffff0000, v134
  v_pk_add_f32 v[28:29], v[28:29], v[44:45]
  v_pk_fma_f32 v[30:31], v[44:45], v[44:45], v[30:31]
  v_lshlrev_b32 v46, 16, v135
  v_and_b32 v47, 0xffff0000, v135
  v_pk_add_f32 v[28:29], v[28:29], v[46:47]
  v_pk_fma_f32 v[30:31], v[46:47], v[46:47], v[30:31]
  s_waitcnt vmcnt(1)
  v_lshlrev_b32 v40, 16, v136
  v_and_b32 v41, 0xffff0000, v136
  v_pk_add_f32 v[28:29], v[28:29], v[40:41]
  v_pk_fma_f32 v[30:31], v[40:41], v[40:41], v[30:31]
  v_lshlrev_b32 v42, 16, v137
  v_and_b32 v43, 0xffff0000, v137
  v_pk_add_f32 v[28:29], v[28:29], v[42:43]
  v_pk_fma_f32 v[30:31], v[42:43], v[42:43], v[30:31]
  v_lshlrev_b32 v44, 16, v138
  v_and_b32 v45, 0xffff0000, v138
  v_pk_add_f32 v[28:29], v[28:29], v[44:45]
  v_pk_fma_f32 v[30:31], v[44:45], v[44:45], v[30:31]
  v_lshlrev_b32 v46, 16, v139
  v_and_b32 v47, 0xffff0000, v139
  v_pk_add_f32 v[28:29], v[28:29], v[46:47]
  v_pk_fma_f32 v[30:31], v[46:47], v[46:47], v[30:31]
  s_waitcnt vmcnt(0)
  v_lshlrev_b32 v40, 16, v140
  v_and_b32 v41, 0xffff0000, v140
  v_pk_add_f32 v[28:29], v[28:29], v[40:41]
  v_pk_fma_f32 v[30:31], v[40:41], v[40:41], v[30:31]
  v_lshlrev_b32 v42, 16, v141
  v_and_b32 v43, 0xffff0000, v141
  v_pk_add_f32 v[28:29], v[28:29], v[42:43]
  v_pk_fma_f32 v[30:31], v[42:43], v[42:43], v[30:31]
  v_lshlrev_b32 v44, 16, v142
  v_and_b32 v45, 0xffff0000, v142
  v_pk_add_f32 v[28:29], v[28:29], v[44:45]
  v_pk_fma_f32 v[30:31], v[44:45], v[44:45], v[30:31]
  v_lshlrev_b32 v46, 16, v143
  v_and_b32 v47, 0xffff0000, v143
  v_pk_add_f32 v[28:29], v[28:29], v[46:47]
  v_pk_fma_f32 v[30:31], v[46:47], v[46:47], v[30:31]
  v_add_f32 v24, v24, v25
  v_add_f32 v26, v26, v27
  v_add_f32 v28, v28, v29
  v_add_f32 v30, v30, v31
  s_nop 1
  v_add_f32_dpp v24, v24, v24 quad_perm:[1,0,3,2] row_mask:0xf bank_mask:0xf
  v_add_f32_dpp v26, v26, v26 quad_perm:[1,0,3,2] row_mask:0xf bank_mask:0xf
  v_add_f32_dpp v28, v28, v28 quad_perm:[1,0,3,2] row_mask:0xf bank_mask:0xf
  v_add_f32_dpp v30, v30, v30 quad_perm:[1,0,3,2] row_mask:0xf bank_mask:0xf
  s_nop 1
  v_add_f32_dpp v24, v24, v24 quad_perm:[2,3,0,1] row_mask:0xf bank_mask:0xf
  v_add_f32_dpp v26, v26, v26 quad_perm:[2,3,0,1] row_mask:0xf bank_mask:0xf
  v_add_f32_dpp v28, v28, v28 quad_perm:[2,3,0,1] row_mask:0xf bank_mask:0xf
  v_add_f32_dpp v30, v30, v30 quad_perm:[2,3,0,1] row_mask:0xf bank_mask:0xf
  s_nop 1
  v_add_f32_dpp v24, v24, v24 row_half_mirror row_mask:0xf bank_mask:0xf
  v_add_f32_dpp v26, v26, v26 row_half_mirror row_mask:0xf bank_mask:0xf
  v_add_f32_dpp v28, v28, v28 row_half_mirror row_mask:0xf bank_mask:0xf
  v_add_f32_dpp v30, v30, v30 row_half_mirror row_mask:0xf bank_mask:0xf
  s_mov_b32 s30, 0x3acccccd
  s_mov_b32 s31, 0x3727c5ac
  v_mul_f32 v24, s30, v24
  v_mul_f32 v26, s30, v26
  v_mul_f32 v28, s30, v28
  v_mul_f32 v30, s30, v30
  v_fma_f32 v26, -v24, v24, v26
  v_fma_f32 v30, -v28, v28, v30
  v_max_f32 v26, 0, v26
  v_max_f32 v30, 0, v30
  v_add_f32 v26, s31, v26
  v_add_f32 v30, s31, v30
  v_rsq_f32 v25, v26
  v_rsq_f32 v29, v30
  s_add_u32 s12, s60, 0x00f00000
  s_addc_u32 s13, s61, 0
  s_mov_b32 s14, 0x00004000
  s_mov_b32 s15, 0x00020000

  v_lshlrev_b32 v5, 3, v5
  v_cmp_eq_u32 vcc, 0, v7
  s_nop 1
  s_and_saveexec_b64 s[36:37], vcc
  buffer_store_dwordx2 v[24:25], v5, s[12:15], 0 offen sc1
  buffer_store_dwordx2 v[28:29], v5, s[12:15], 0 offen offset:64 sc1
  s_mov_b64 exec, s[36:37]
  s_waitcnt vmcnt(0)
  s_barrier

  v_mov_b32 v6, 160020
  ds_read_b32 v7, v6
  s_waitcnt lgkmcnt(0)
  v_readfirstlane_b32 s101, v7
  s_nop 3

  s_cmp_eq_u32 s22, 0
  s_cbranch_scc0 L_ist_nosig

  s_lshl_b32 s3, s62, 7
  s_add_u32 s3, s3, 0x07003000

  s_lshl_b32 s30, s63, 2
  s_add_u32 s30, s30, s3
  v_mov_b32 v6, s30
  v_mov_b32 v7, s101
  s_mov_b64 exec, 1

  global_store_dword v6, v7, s[60:61] sc1
  s_mov_b64 exec, -1
L_ist_nosig:
  s_barrier

  v_mov_b32 v6, 160016
  ds_read_b64 v[6:7], v6
  s_waitcnt lgkmcnt(0)
  v_readfirstlane_b32 s46, v6
  v_readfirstlane_b32 s101, v7
  s_nop 3
  s_lshr_b32 s97, s46, 1
  s_and_b32 s46, s46, 1

L_c1_idle2:
  s_cmp_eq_u32 s96, 0
  s_cbranch_scc0 L_ip1_c
  s_sub_u32 s29, s63, 30
  s_lshl_b32 s29, s29, 3
  s_add_u32 s29, s29, s22
  s_cmp_eq_u32 s46, 0
  s_cbranch_scc0 L_tp1oc_end
  s_mul_i32 s28, s62, 327680
  s_add_u32 s12, s60, 0x00800000
  s_addc_u32 s13, s61, 0
  s_add_u32 s12, s12, s28
  s_addc_u32 s13, s13, 0
  s_mov_b32 s14, 0x00050000
  s_mov_b32 s15, 0x00020000
  v_and_b32 v2, 63, v0
  s_mov_b32 s27, s29
L_tp1oc_loop:
  s_cmp_ge_u32 s27, 40
  s_cbranch_scc1 L_tp1oc_end
  s_lshl_b32 s26, s27, 6
  v_add_u32 v5, s26, v2
  v_lshlrev_b32 v5, 7, v5
  buffer_load_dword v1, v5, s[12:15], 0 offen
  s_add_u32 s27, s27, 16
  s_branch L_tp1oc_loop
L_tp1oc_end:
L_ip1_c:
L_c1_tail:
  s_mov_b32 s37, s21

  v_and_b32 v2, 63, v0
  v_and_b32 v3, 31, v2
  v_lshrrev_b32 v4, 5, v2
  s_and_b32 s23, s63, 1
  s_lshr_b32 s24, s63, 1
  s_mul_i32 s24, s24, 5
  s_mul_i32 s25, s23, 3
  s_add_u32 s25, s25, s24
  s_add_u32 s24, s24, 2
  s_lshl_b32 s25, s25, 15
  s_lshl_b32 s24, s24, 15
  s_lshl_b32 s30, s62, 8
  s_sub_u32 s30, s30, 256
  s_cmp_eq_u32 s62, 0
  s_cselect_b32 s32, 1, 0
  s_cmp_lt_u32 s22, 4
  s_cselect_b32 s32, s32, 0
  s_cmp_eq_u32 s32, 1
  s_cselect_b32 s30, 0, s30
  s_lshl_b32 s32, s22, 6
  s_add_u32 s30, s30, s32
  s_lshl_b32 s30, s30, 4
  v_lshl_add_u32 v22, v2, 4, s30
  s_lshl_b32 s35, s22, 10
  s_lshl_b32 s30, s62, 8
  s_lshl_b32 s32, s22, 5
  s_add_u32 s30, s30, s32
  v_add_u32 v6, s30, v3
  v_lshlrev_b32 v7, 4, v6
  v_lshl_add_u32 v10, v4, 15, v7
  s_lshl_b32 s33, s23, 3
  v_add_u32 v11, s33, v7

  s_add_u32 s4, s60, 0x00000000
  s_addc_u32 s5, s61, 0
  s_mov_b32 s6, 0x00780000
  s_mov_b32 s7, 0x00020000
  s_add_u32 s16, s60, 0x00d80000
  s_addc_u32 s17, s61, 0
  s_add_u32 s16, s16, s47
  s_addc_u32 s17, s17, 0
  s_mov_b32 s18, 0x00780000
  s_mov_b32 s19, 0x00020000
  s_add_u32 s8, s60, 0x00800000
  s_addc_u32 s9, s61, 0
  s_mov_b32 s10, 0x00280000
  s_mov_b32 s11, 0x00020000

  v_mov_b32 v9, 0
  v_cmp_gt_u32 vcc, 256, v0
  s_cmp_eq_u32 s62, 0
  s_cselect_b32 s38, 0xf149, 0
  v_mov_b32 v5, s38
  v_cndmask_b32 v8, 0, v5, vcc
  v_lshlrev_b32 v12, 4, v0
  ds_write_b64 v12, v[8:9] offset:24576
  v_mov_b32 v8, 0x3f803f80
  v_mov_b32 v9, 0x3f803f80
  v_add_u32 v12, 57536, v12
  ds_write_b64 v12, v[8:9]
  s_lshl_b32 s32, s22, 5
  v_add_u32 v12, s32, v3
  v_lshlrev_b32 v12, 4, v12
  v_lshl_add_u32 v13, v4, 13, v12
  s_lshl_b32 s33, s23, 3
  v_mov_b32 v14, s33
  v_cmp_eq_u32 vcc, 1, v4
  v_mov_b32 v9, 8192
  s_nop 0
  v_cndmask_b32 v14, v14, v9, vcc
  v_add_u32 v14, v14, v12
  v_add_u32 v14, 16384, v14
  v_and_b32 v5, 15, v2
  v_lshrrev_b32 v6, 2, v5
  v_and_b32 v7, 3, v5
  v_lshl_add_u32 v8, v4, 2, v6
  v_add_u32 v8, s32, v8
  v_lshlrev_b32 v8, 4, v8
  v_lshrrev_b32 v9, 1, v7
  v_mul_u32_u24 v9, 8256, v9
  v_and_b32 v12, 1, v7
  v_lshl_add_u32 v9, v12, 3, v9
  v_mov_b32 v12, 24768
  s_add_u32 s33, s33, 16512
  v_mov_b32 v5, s33
  v_cmp_eq_u32 vcc, 0, v7
  s_nop 1
  v_cndmask_b32 v12, v12, v5, vcc
  v_and_b32 v5, 16, v2
  v_cmp_ne_u32 vcc, 0, v5
  s_nop 1
  v_cndmask_b32 v9, v9, v12, vcc
  v_add_u32 v15, v8, v9
  v_add_u32 v15, 32768, v15
  s_lshl_b32 s30, s62, 8
  s_add_u32 s30, s30, s32
  v_add_u32 v6, s30, v3
  v_lshrrev_b32 v7, 4, v6
  s_mov_b32 s33, 20480
  v_mul_lo_u32 v7, v7, s33
  v_and_b32 v6, 15, v6
  v_lshl_add_u32 v7, v6, 4, v7
  s_lshr_b32 s34, s25, 15
  v_add_u32 v8, s34, v4
  v_lshrrev_b32 v9, 2, v8
  v_lshl_add_u32 v12, v9, 10, v7
  v_and_b32 v9, 3, v8
  v_lshl_add_u32 v24, v9, 8, v12
  s_lshr_b32 s34, s24, 15
  s_lshr_b32 s36, s34, 2
  s_lshl_b32 s36, s36, 10
  s_and_b32 s34, s34, 3
  s_lshl_b32 s34, s34, 8
  s_add_u32 s34, s34, s36
  s_lshl_b32 s36, s23, 3
  s_add_u32 s34, s34, s36
  v_add_u32 v25, s34, v7

  s_cmp_eq_u32 s37, 15
  s_cselect_b32 s37, 0, s37
  s_cmp_lt_u32 s37, 5
  s_cbranch_scc1 L_c1_nopub
  s_waitcnt vmcnt(8)
  v_mov_b32 v5, 160000
  v_mov_b32 v6, 1
  s_mov_b64 exec, 1
  ds_add_rtn_u32 v7, v5, v6
  s_waitcnt lgkmcnt(0)
  v_readfirstlane_b32 s30, v7
  s_mov_b64 exec, -1
  s_and_b32 s30, s30, 3
  s_cmp_eq_u32 s30, 3
  s_cbranch_scc0 L_c1_nopub

  s_mul_i32 s3, s96, 6
  s_add_u32 s3, s3, 1
  s_lshl_b32 s3, s3, 3
  s_add_u32 s3, s3, s62
  s_lshl_b32 s3, s3, 7
  s_add_u32 s3, s3, 0x07000000

  s_lshl_b32 s30, s63, 2
  s_add_u32 s30, s30, s3
  v_mov_b32 v6, s30
  v_mov_b32 v7, s101
  s_mov_b64 exec, 1
  global_store_dword v6, v7, s[60:61] sc1
  s_mov_b64 exec, -1
L_c1_nopub:
  s_waitcnt vmcnt(0) lgkmcnt(0)
  s_barrier

  s_cmp_eq_u32 s22, 0
  s_cbranch_scc0 L_c1a_nosig

  s_mul_i32 s3, s96, 6
  s_add_u32 s3, s3, 0
  s_lshl_b32 s3, s3, 3
  s_add_u32 s3, s3, s62
  s_lshl_b32 s3, s3, 7
  s_add_u32 s3, s3, 0x07000000

  s_lshl_b32 s30, s63, 2
  s_add_u32 s30, s30, s3
  v_mov_b32 v6, s30
  v_mov_b32 v7, s101
  s_mov_b64 exec, 1

  s_cmp_eq_u32 s46, 0
  s_cbranch_scc0 L_c1a_sigg
  global_store_dword v6, v7, s[60:61]
  s_branch L_c1a_sigd
L_c1a_sigg:
  global_store_dword v6, v7, s[60:61] sc1
L_c1a_sigd:

  s_mov_b64 exec, -1
L_c1a_nosig:
  s_cmp_eq_u32 s22, 0
  s_cbranch_scc0 L_c1p_nopoll
  s_cmp_lg_u32 s97, 0
  s_cbranch_scc1 L_c1p_nopoll

  s_mul_i32 s3, s96, 6
  s_add_u32 s3, s3, 0
  s_lshl_b32 s3, s3, 3
  s_add_u32 s3, s3, s62
  s_lshl_b32 s3, s3, 7
  s_add_u32 s3, s3, 0x07000000

  v_and_b32 v6, 63, v0
  v_lshl_add_u32 v6, v6, 2, s3
  s_mov_b32 s3, 400000
  s_mov_b32 exec_lo, 0x3fffffff
  s_mov_b32 exec_hi, 0
L_c1p_poll:
  global_load_dword v7, v6, s[60:61] sc1
  s_waitcnt vmcnt(0)
  v_cmp_ne_u32 vcc, s101, v7
  s_cbranch_vccz L_c1p_ok
  s_sub_u32 s3, s3, 1
  s_cmp_eq_u32 s3, 0
  s_cbranch_scc0 L_c1p_poll
  s_mov_b32 s97, 1
L_c1p_ok:
  s_mov_b64 exec, -1
L_c1p_nopoll:

  s_barrier
L_att:
  s_cmp_ge_u32 s22, 4
  s_cselect_b32 s30, 1, 0
  s_cmp_eq_u32 s62, 0
  s_cselect_b32 s30, 1, s30
  s_cmp_eq_u32 s30, 1
  s_cbranch_scc0 L_attn_halo
  buffer_load_dwordx4 v[16:19], v10, s[4:7], s25 offen sc1
  buffer_load_dwordx2 v[20:21], v11, s[4:7], s24 offen sc1
  s_add_u32 m0, s35, 0
  s_add_u32 s36, s25, 2621440
  buffer_load_dwordx4 v22, s[4:7], s36 offen sc1 lds
  s_add_u32 m0, s35, 8192
  s_add_u32 s36, s25, 2654208
  buffer_load_dwordx4 v22, s[4:7], s36 offen sc1 lds
  s_add_u32 m0, s35, 16384
  s_add_u32 s36, s24, 2621440
  buffer_load_dwordx4 v22, s[4:7], s36 offen sc1 lds
  s_add_u32 m0, s35, 32768
  s_add_u32 s36, s25, 5242880
  buffer_load_dwordx4 v22, s[4:7], s36 offen sc1 lds
  s_add_u32 m0, s35, 41024
  s_add_u32 s36, s25, 5275648
  buffer_load_dwordx4 v22, s[4:7], s36 offen sc1 lds
  s_add_u32 m0, s35, 49280
  s_add_u32 s36, s24, 5242880
  buffer_load_dwordx4 v22, s[4:7], s36 offen sc1 lds
  s_barrier
  s_branch L_attn_ld
L_attn_halo:
  buffer_load_dwordx4 v[16:19], v10, s[4:7], s25 offen sc1
  buffer_load_dwordx2 v[20:21], v11, s[4:7], s24 offen sc1
  s_cmp_eq_u32 s22, 3
  s_cbranch_scc0 L_attnh_nopoll
  s_cmp_lg_u32 s97, 0
  s_cbranch_scc1 L_attnh_nopoll
  s_cmp_eq_u32 s62, 0
  s_cbranch_scc1 L_attnh_nopoll

  s_mul_i32 s3, s96, 6
  s_add_u32 s3, s3, 1
  s_lshl_b32 s3, s3, 3
  s_add_u32 s3, s3, s62
  s_lshl_b32 s3, s3, 7
  s_add_u32 s3, s3, 0x07000000

  s_sub_u32 s3, s3, 128

  v_and_b32 v6, 63, v0
  v_lshl_add_u32 v6, v6, 2, s3
  s_mov_b32 s3, 400000
  s_mov_b32 exec_lo, 0x3ffffc00
  s_mov_b32 exec_hi, 0
L_attnh_poll:
  global_load_dword v7, v6, s[60:61] sc1
  s_waitcnt vmcnt(0)
  v_cmp_ne_u32 vcc, s101, v7
  s_cbranch_vccz L_attnh_ok
  s_sub_u32 s3, s3, 1
  s_cmp_eq_u32 s3, 0
  s_cbranch_scc0 L_attnh_poll
  s_mov_b32 s97, 1
L_attnh_ok:
  s_mov_b64 exec, -1
L_attnh_nopoll:

  s_barrier
  s_add_u32 m0, s35, 0
  s_add_u32 s36, s25, 2621440
  buffer_load_dwordx4 v22, s[16:19], s36 offen sc1 lds
  s_add_u32 m0, s35, 8192
  s_add_u32 s36, s25, 2654208
  buffer_load_dwordx4 v22, s[16:19], s36 offen sc1 lds
  s_add_u32 m0, s35, 16384
  s_add_u32 s36, s24, 2621440
  buffer_load_dwordx4 v22, s[16:19], s36 offen sc1 lds
  s_add_u32 m0, s35, 32768
  s_add_u32 s36, s25, 5242880
  buffer_load_dwordx4 v22, s[16:19], s36 offen sc1 lds
  s_add_u32 m0, s35, 41024
  s_add_u32 s36, s25, 5275648
  buffer_load_dwordx4 v22, s[16:19], s36 offen sc1 lds
  s_add_u32 m0, s35, 49280
  s_add_u32 s36, s24, 5242880
  buffer_load_dwordx4 v22, s[16:19], s36 offen sc1 lds
L_attn_ld:

  s_waitcnt vmcnt(3) lgkmcnt(0)
  v_cmp_eq_u32 vcc, 1, v4
  v_mov_b32 v9, 0x3f80
  v_mov_b32 v8, 0
  v_cndmask_b32 v20, v20, v9, vcc
  v_cndmask_b32 v21, v21, v8, vcc
  s_barrier

  ds_read_b128 v[26:29], v13 offset:4096
  ds_read_b64 v[30:31], v14 offset:4096
  ds_read_b128 v[32:35], v13 offset:3584
  ds_read_b64 v[36:37], v14 offset:3584
  ds_read_b128 v[38:41], v13 offset:3072
  ds_read_b64 v[42:43], v14 offset:3072
  s_waitcnt lgkmcnt(4)
  v_mfma_f32_32x32x16_bf16 v[176:191], v[26:29], v[16:19], 0
  v_mfma_f32_32x32x8_bf16 v[176:191], v[30:31], v[20:21], v[176:191]
  ds_read_b128 v[26:29], v13 offset:2560
  ds_read_b64 v[30:31], v14 offset:2560
  s_waitcnt lgkmcnt(4)
  v_mfma_f32_32x32x16_bf16 v[160:175], v[32:35], v[16:19], 0
  v_mfma_f32_32x32x8_bf16 v[160:175], v[36:37], v[20:21], v[160:175]
  ds_read_b128 v[32:35], v13 offset:2048
  ds_read_b64 v[36:37], v14 offset:2048
  s_waitcnt lgkmcnt(4)
  v_mfma_f32_32x32x16_bf16 v[144:159], v[38:41], v[16:19], 0
  v_mfma_f32_32x32x8_bf16 v[144:159], v[42:43], v[20:21], v[144:159]
  ds_read_b128 v[38:41], v13 offset:1536
  ds_read_b64 v[42:43], v14 offset:1536
  s_waitcnt lgkmcnt(4)
  v_mfma_f32_32x32x16_bf16 v[128:143], v[26:29], v[16:19], 0
  v_mfma_f32_32x32x8_bf16 v[128:143], v[30:31], v[20:21], v[128:143]
  ds_read_b128 v[26:29], v13 offset:1024
  ds_read_b64 v[30:31], v14 offset:1024
  s_waitcnt lgkmcnt(4)
  v_mfma_f32_32x32x16_bf16 v[112:127], v[32:35], v[16:19], 0
  v_mfma_f32_32x32x8_bf16 v[112:127], v[36:37], v[20:21], v[112:127]
  ds_read_b128 v[32:35], v13 offset:512
  ds_read_b64 v[36:37], v14 offset:512
  s_waitcnt lgkmcnt(4)
  v_mfma_f32_32x32x16_bf16 v[96:111], v[38:41], v[16:19], 0
  v_mfma_f32_32x32x8_bf16 v[96:111], v[42:43], v[20:21], v[96:111]
  ds_read_b128 v[38:41], v13 offset:0
  ds_read_b64 v[42:43], v14 offset:0
  s_waitcnt lgkmcnt(4)
  v_mfma_f32_32x32x16_bf16 v[80:95], v[26:29], v[16:19], 0
  v_mfma_f32_32x32x8_bf16 v[80:95], v[30:31], v[20:21], v[80:95]
  s_waitcnt lgkmcnt(2)
  v_mfma_f32_32x32x16_bf16 v[64:79], v[32:35], v[16:19], 0
  v_mfma_f32_32x32x8_bf16 v[64:79], v[36:37], v[20:21], v[64:79]
  s_waitcnt lgkmcnt(0)
  v_mfma_f32_32x32x16_bf16 v[192:207], v[38:41], v[16:19], 0
  v_mfma_f32_32x32x8_bf16 v[192:207], v[42:43], v[20:21], v[192:207]
  v_max3_f32 v48, v160, v161, v162
  v_max3_f32 v49, v163, v164, v165
  v_max3_f32 v48, v166, v167, v48
  v_max3_f32 v49, v168, v169, v49
  v_max3_f32 v48, v170, v171, v48
  v_max3_f32 v49, v172, v173, v49
  v_max3_f32 v48, v174, v175, v48
  v_max3_f32 v49, v144, v145, v49
  v_max3_f32 v48, v146, v147, v48
  v_max3_f32 v49, v148, v149, v49
  v_max3_f32 v48, v150, v151, v48
  v_max3_f32 v49, v152, v153, v49
  v_max3_f32 v48, v154, v155, v48
  v_max3_f32 v49, v156, v157, v49
  v_max3_f32 v48, v158, v159, v48
  v_max3_f32 v49, v128, v129, v49
  v_max3_f32 v48, v130, v131, v48
  v_max3_f32 v49, v132, v133, v49
  v_max3_f32 v48, v134, v135, v48
  v_max3_f32 v49, v136, v137, v49
  v_max3_f32 v48, v138, v139, v48
  v_max3_f32 v49, v140, v141, v49
  v_max3_f32 v48, v142, v143, v48
  v_max3_f32 v49, v112, v113, v49
  v_max3_f32 v48, v114, v115, v48
  v_max3_f32 v49, v116, v117, v49
  v_max3_f32 v48, v118, v119, v48
  v_max3_f32 v49, v120, v121, v49
  v_max3_f32 v48, v122, v123, v48
  v_max3_f32 v49, v124, v125, v49
  v_max3_f32 v48, v126, v127, v48
  v_max3_f32 v49, v96, v97, v49
  v_max3_f32 v48, v98, v99, v48
  v_max3_f32 v49, v100, v101, v49
  v_max3_f32 v48, v102, v103, v48
  v_max3_f32 v49, v104, v105, v49
  v_max3_f32 v48, v106, v107, v48
  v_max3_f32 v49, v108, v109, v49
  v_max3_f32 v48, v110, v111, v48
  v_max3_f32 v49, v80, v81, v49
  v_max3_f32 v48, v82, v83, v48
  v_max3_f32 v49, v84, v85, v49
  v_max3_f32 v48, v86, v87, v48
  v_max3_f32 v49, v88, v89, v49
  v_max3_f32 v48, v90, v91, v48
  v_max3_f32 v49, v92, v93, v49
  v_max3_f32 v48, v94, v95, v48
  v_max3_f32 v49, v64, v65, v49
  v_max3_f32 v48, v66, v67, v48
  v_max3_f32 v49, v68, v69, v49
  v_max3_f32 v48, v70, v71, v48
  v_max3_f32 v49, v72, v73, v49
  v_max3_f32 v48, v74, v75, v48
  v_max3_f32 v49, v76, v77, v49
  v_max3_f32 v48, v78, v79, v48
  v_cndmask_b32 v176, v192, v176, s[64:65]
  v_cndmask_b32 v177, v193, v177, s[66:67]
  v_cndmask_b32 v178, v194, v178, s[68:69]
  v_cndmask_b32 v179, v195, v179, s[70:71]
  v_cndmask_b32 v180, v196, v180, s[72:73]
  v_cndmask_b32 v181, v197, v181, s[74:75]
  v_cndmask_b32 v182, v198, v182, s[76:77]
  v_cndmask_b32 v183, v199, v183, s[78:79]
  v_cndmask_b32 v184, v200, v184, s[80:81]
  v_cndmask_b32 v185, v201, v185, s[82:83]
  v_cndmask_b32 v186, v202, v186, s[84:85]
  v_cndmask_b32 v187, v203, v187, s[86:87]
  v_cndmask_b32 v188, v204, v188, s[88:89]
  v_cndmask_b32 v189, v205, v189, s[90:91]
  v_cndmask_b32 v190, v206, v190, s[92:93]
  v_cndmask_b32 v191, v207, v191, s[94:95]
  v_max3_f32 v48, v176, v177, v48
  v_max3_f32 v49, v178, v179, v49
  v_max3_f32 v48, v180, v181, v48
  v_max3_f32 v49, v182, v183, v49
  v_max3_f32 v48, v184, v185, v48
  v_max3_f32 v49, v186, v187, v49
  v_max3_f32 v48, v188, v189, v48
  v_max3_f32 v49, v190, v191, v49

  v_max_f32 v48, v48, v49
  v_mov_b32 v49, v48
  s_waitcnt vmcnt(0)
  s_barrier
  v_permlane32_swap_b32 v48, v49

  ds_read_b64_tr_b16 v[208:209], v15 offset:512
  ds_read_b64_tr_b16 v[210:211], v15 offset:640
  ds_read_b64_tr_b16 v[212:213], v15 offset:768
  ds_read_b64_tr_b16 v[214:215], v15 offset:896
  ds_read_b64_tr_b16 v[216:217], v15 offset:1024
  ds_read_b64_tr_b16 v[218:219], v15 offset:1152
  ds_read_b64_tr_b16 v[220:221], v15 offset:1280
  ds_read_b64_tr_b16 v[222:223], v15 offset:1408
  ds_read_b64_tr_b16 v[224:225], v15 offset:1536
  ds_read_b64_tr_b16 v[226:227], v15 offset:1664
  ds_read_b64_tr_b16 v[228:229], v15 offset:1792
  ds_read_b64_tr_b16 v[230:231], v15 offset:1920

  v_max_f32 v48, v48, v49
  v_sub_f32 v48, 0, v48
  v_mov_b32 v49, v48

  s_mul_i32 s30, s63, 43
  s_lshr_b32 s21, s30, 7
  s_cmp_ge_u32 s63, 30
  s_cselect_b32 s21, 0, s21
  v_lshrrev_b32 v5, 3, v2
  s_lshl_b32 s30, s22, 3
  v_add_u32 v5, s30, v5
  v_mul_u32_u24 v5, 1280, v5
  v_and_b32 v6, 7, v2
  v_lshrrev_b32 v7, 1, v6
  v_bfe_u32 v8, v2, 4, 1
  s_and_b32 s30, s22, 1
  s_lshl_b32 s30, s30, 1
  v_or_b32 v8, s30, v8
  v_xor_b32 v7, v7, v8
  v_lshl_add_u32 v5, v7, 5, v5
  v_and_b32 v6, 1, v2
  v_lshl_add_u32 v5, v6, 4, v5
  s_lshl_b32 s30, s21, 7
  v_add_u32 v58, s30, v5
  s_lshl_b32 s33, s22, 10
  s_add_u32 s33, s33, 65792

  s_add_u32 s12, s44, 0x00000000
  s_addc_u32 s13, s45, 0
  s_mov_b32 s14, 0x000c8000
  s_mov_b32 s15, 0x00020000
  s_cmp_eq_u32 s96, 0
  s_cbranch_scc0 L_attn_nocold
  s_lshl_b32 s30, s2, 3
  s_add_u32 s30, s30, s22
  v_lshlrev_b32 v5, 4, v2
  s_add_u32 s16, s48, 0x00000000
  s_addc_u32 s17, s49, 0
  s_mov_b32 s18, 0x0021c000
  s_mov_b32 s19, 0x00020000
  s_lshl_b32 s32, s30, 10
  buffer_load_dwordx4 v[52:55], v5, s[16:19], s32 offen
  s_add_u32 s32, s32, 2097152
  buffer_load_dwordx4 v[52:55], v5, s[16:19], s32 offen
  s_add_u32 s16, s52, 0x00000000
  s_addc_u32 s17, s53, 0
  s_mov_b32 s18, 0x0021c000
  s_mov_b32 s19, 0x00020000
  s_lshl_b32 s32, s30, 10
  buffer_load_dwordx4 v[52:55], v5, s[16:19], s32 offen
  s_add_u32 s32, s32, 2097152
  buffer_load_dwordx4 v[52:55], v5, s[16:19], s32 offen
L_attn_nocold:
  s_add_u32 m0, s33, 0
  s_mov_b32 s34, 0
  buffer_load_dwordx4 v58, s[12:15], s34 offen lds
  s_add_u32 m0, s33, 8192
  s_mov_b32 s34, 81920
  buffer_load_dwordx4 v58, s[12:15], s34 offen lds
  v_pk_add_f32 v[64:65], v[64:65], v[48:49]
  v_pk_add_f32 v[66:67], v[66:67], v[48:49]
  v_pk_add_f32 v[68:69], v[68:69], v[48:49]
  v_pk_add_f32 v[70:71], v[70:71], v[48:49]
  v_pk_add_f32 v[72:73], v[72:73], v[48:49]
  v_pk_add_f32 v[74:75], v[74:75], v[48:49]
  v_pk_add_f32 v[76:77], v[76:77], v[48:49]
  v_pk_add_f32 v[78:79], v[78:79], v[48:49]
  v_exp_f32 v64, v64
  v_exp_f32 v65, v65
  v_exp_f32 v66, v66
  v_exp_f32 v67, v67
  v_exp_f32 v68, v68
  v_exp_f32 v69, v69
  v_exp_f32 v70, v70
  v_exp_f32 v71, v71
  v_exp_f32 v72, v72
  v_exp_f32 v73, v73
  v_exp_f32 v74, v74
  v_exp_f32 v75, v75
  v_exp_f32 v76, v76
  v_exp_f32 v77, v77
  v_exp_f32 v78, v78
  v_exp_f32 v79, v79
  v_cvt_pk_bf16_f32 v232, v64, v65
  v_cvt_pk_bf16_f32 v233, v66, v67
  v_cvt_pk_bf16_f32 v234, v68, v69
  v_cvt_pk_bf16_f32 v235, v70, v71
  v_cvt_pk_bf16_f32 v236, v72, v73
  v_cvt_pk_bf16_f32 v237, v74, v75
  v_cvt_pk_bf16_f32 v238, v76, v77
  v_cvt_pk_bf16_f32 v239, v78, v79
  s_waitcnt lgkmcnt(8)
  s_nop 0
  v_mfma_f32_32x32x16_bf16 v[192:207], v[208:211], v[232:235], 0
  v_mfma_f32_32x32x16_bf16 v[192:207], v[212:215], v[236:239], v[192:207]
  ds_read_b64_tr_b16 v[208:209], v15 offset:2048
  ds_read_b64_tr_b16 v[210:211], v15 offset:2176
  ds_read_b64_tr_b16 v[212:213], v15 offset:2304
  ds_read_b64_tr_b16 v[214:215], v15 offset:2432
  s_add_u32 m0, s33, 16384
  s_mov_b32 s34, 163840
  buffer_load_dwordx4 v58, s[12:15], s34 offen lds
  s_add_u32 m0, s33, 24576
  s_mov_b32 s34, 245760
  buffer_load_dwordx4 v58, s[12:15], s34 offen lds
  v_pk_add_f32 v[80:81], v[80:81], v[48:49]
  v_pk_add_f32 v[82:83], v[82:83], v[48:49]
  v_pk_add_f32 v[84:85], v[84:85], v[48:49]
  v_pk_add_f32 v[86:87], v[86:87], v[48:49]
  v_pk_add_f32 v[88:89], v[88:89], v[48:49]
  v_pk_add_f32 v[90:91], v[90:91], v[48:49]
  v_pk_add_f32 v[92:93], v[92:93], v[48:49]
  v_pk_add_f32 v[94:95], v[94:95], v[48:49]
  v_exp_f32 v80, v80
  v_exp_f32 v81, v81
  v_exp_f32 v82, v82
  v_exp_f32 v83, v83
  v_exp_f32 v84, v84
  v_exp_f32 v85, v85
  v_exp_f32 v86, v86
  v_exp_f32 v87, v87
  v_exp_f32 v88, v88
  v_exp_f32 v89, v89
  v_exp_f32 v90, v90
  v_exp_f32 v91, v91
  v_exp_f32 v92, v92
  v_exp_f32 v93, v93
  v_exp_f32 v94, v94
  v_exp_f32 v95, v95
  v_cvt_pk_bf16_f32 v240, v80, v81
  v_cvt_pk_bf16_f32 v241, v82, v83
  v_cvt_pk_bf16_f32 v242, v84, v85
  v_cvt_pk_bf16_f32 v243, v86, v87
  v_cvt_pk_bf16_f32 v244, v88, v89
  v_cvt_pk_bf16_f32 v245, v90, v91
  v_cvt_pk_bf16_f32 v246, v92, v93
  v_cvt_pk_bf16_f32 v247, v94, v95
  s_waitcnt lgkmcnt(8)
  s_nop 0
  v_mfma_f32_32x32x16_bf16 v[192:207], v[216:219], v[240:243], v[192:207]
  v_mfma_f32_32x32x16_bf16 v[192:207], v[220:223], v[244:247], v[192:207]
  ds_read_b64_tr_b16 v[216:217], v15 offset:2560
  ds_read_b64_tr_b16 v[218:219], v15 offset:2688
  ds_read_b64_tr_b16 v[220:221], v15 offset:2816
  ds_read_b64_tr_b16 v[222:223], v15 offset:2944
  s_add_u32 m0, s33, 32768
  s_mov_b32 s34, 327680
  buffer_load_dwordx4 v58, s[12:15], s34 offen lds
  v_pk_add_f32 v[96:97], v[96:97], v[48:49]
  v_pk_add_f32 v[98:99], v[98:99], v[48:49]
  v_pk_add_f32 v[100:101], v[100:101], v[48:49]
  v_pk_add_f32 v[102:103], v[102:103], v[48:49]
  v_pk_add_f32 v[104:105], v[104:105], v[48:49]
  v_pk_add_f32 v[106:107], v[106:107], v[48:49]
  v_pk_add_f32 v[108:109], v[108:109], v[48:49]
  v_pk_add_f32 v[110:111], v[110:111], v[48:49]
  v_exp_f32 v96, v96
  v_exp_f32 v97, v97
  v_exp_f32 v98, v98
  v_exp_f32 v99, v99
  v_exp_f32 v100, v100
  v_exp_f32 v101, v101
  v_exp_f32 v102, v102
  v_exp_f32 v103, v103
  v_exp_f32 v104, v104
  v_exp_f32 v105, v105
  v_exp_f32 v106, v106
  v_exp_f32 v107, v107
  v_exp_f32 v108, v108
  v_exp_f32 v109, v109
  v_exp_f32 v110, v110
  v_exp_f32 v111, v111
  v_cvt_pk_bf16_f32 v232, v96, v97
  v_cvt_pk_bf16_f32 v233, v98, v99
  v_cvt_pk_bf16_f32 v234, v100, v101
  v_cvt_pk_bf16_f32 v235, v102, v103
  v_cvt_pk_bf16_f32 v236, v104, v105
  v_cvt_pk_bf16_f32 v237, v106, v107
  v_cvt_pk_bf16_f32 v238, v108, v109
  v_cvt_pk_bf16_f32 v239, v110, v111
  s_waitcnt lgkmcnt(8)
  s_nop 0
  v_mfma_f32_32x32x16_bf16 v[192:207], v[224:227], v[232:235], v[192:207]
  v_mfma_f32_32x32x16_bf16 v[192:207], v[228:231], v[236:239], v[192:207]
  ds_read_b64_tr_b16 v[224:225], v15 offset:3072
  ds_read_b64_tr_b16 v[226:227], v15 offset:3200
  ds_read_b64_tr_b16 v[228:229], v15 offset:3328
  ds_read_b64_tr_b16 v[230:231], v15 offset:3456
  s_add_u32 m0, s33, 40960
  s_mov_b32 s34, 409600
  buffer_load_dwordx4 v58, s[12:15], s34 offen lds
  v_pk_add_f32 v[112:113], v[112:113], v[48:49]
  v_pk_add_f32 v[114:115], v[114:115], v[48:49]
  v_pk_add_f32 v[116:117], v[116:117], v[48:49]
  v_pk_add_f32 v[118:119], v[118:119], v[48:49]
  v_pk_add_f32 v[120:121], v[120:121], v[48:49]
  v_pk_add_f32 v[122:123], v[122:123], v[48:49]
  v_pk_add_f32 v[124:125], v[124:125], v[48:49]
  v_pk_add_f32 v[126:127], v[126:127], v[48:49]
  v_exp_f32 v112, v112
  v_exp_f32 v113, v113
  v_exp_f32 v114, v114
  v_exp_f32 v115, v115
  v_exp_f32 v116, v116
  v_exp_f32 v117, v117
  v_exp_f32 v118, v118
  v_exp_f32 v119, v119
  v_exp_f32 v120, v120
  v_exp_f32 v121, v121
  v_exp_f32 v122, v122
  v_exp_f32 v123, v123
  v_exp_f32 v124, v124
  v_exp_f32 v125, v125
  v_exp_f32 v126, v126
  v_exp_f32 v127, v127
  v_cvt_pk_bf16_f32 v240, v112, v113
  v_cvt_pk_bf16_f32 v241, v114, v115
  v_cvt_pk_bf16_f32 v242, v116, v117
  v_cvt_pk_bf16_f32 v243, v118, v119
  v_cvt_pk_bf16_f32 v244, v120, v121
  v_cvt_pk_bf16_f32 v245, v122, v123
  v_cvt_pk_bf16_f32 v246, v124, v125
  v_cvt_pk_bf16_f32 v247, v126, v127
  s_waitcnt lgkmcnt(8)
  s_nop 0
  v_mfma_f32_32x32x16_bf16 v[192:207], v[208:211], v[240:243], v[192:207]
  v_mfma_f32_32x32x16_bf16 v[192:207], v[212:215], v[244:247], v[192:207]
  ds_read_b64_tr_b16 v[208:209], v15 offset:3584
  ds_read_b64_tr_b16 v[210:211], v15 offset:3712
  ds_read_b64_tr_b16 v[212:213], v15 offset:3840
  ds_read_b64_tr_b16 v[214:215], v15 offset:3968
  s_add_u32 m0, s33, 49152
  s_mov_b32 s34, 491520
  buffer_load_dwordx4 v58, s[12:15], s34 offen lds
  v_pk_add_f32 v[128:129], v[128:129], v[48:49]
  v_pk_add_f32 v[130:131], v[130:131], v[48:49]
  v_pk_add_f32 v[132:133], v[132:133], v[48:49]
  v_pk_add_f32 v[134:135], v[134:135], v[48:49]
  v_pk_add_f32 v[136:137], v[136:137], v[48:49]
  v_pk_add_f32 v[138:139], v[138:139], v[48:49]
  v_pk_add_f32 v[140:141], v[140:141], v[48:49]
  v_pk_add_f32 v[142:143], v[142:143], v[48:49]
  v_exp_f32 v128, v128
  v_exp_f32 v129, v129
  v_exp_f32 v130, v130
  v_exp_f32 v131, v131
  v_exp_f32 v132, v132
  v_exp_f32 v133, v133
  v_exp_f32 v134, v134
  v_exp_f32 v135, v135
  v_exp_f32 v136, v136
  v_exp_f32 v137, v137
  v_exp_f32 v138, v138
  v_exp_f32 v139, v139
  v_exp_f32 v140, v140
  v_exp_f32 v141, v141
  v_exp_f32 v142, v142
  v_exp_f32 v143, v143
  v_cvt_pk_bf16_f32 v232, v128, v129
  v_cvt_pk_bf16_f32 v233, v130, v131
  v_cvt_pk_bf16_f32 v234, v132, v133
  v_cvt_pk_bf16_f32 v235, v134, v135
  v_cvt_pk_bf16_f32 v236, v136, v137
  v_cvt_pk_bf16_f32 v237, v138, v139
  v_cvt_pk_bf16_f32 v238, v140, v141
  v_cvt_pk_bf16_f32 v239, v142, v143
  s_waitcnt lgkmcnt(8)
  s_nop 0
  v_mfma_f32_32x32x16_bf16 v[192:207], v[216:219], v[232:235], v[192:207]
  v_mfma_f32_32x32x16_bf16 v[192:207], v[220:223], v[236:239], v[192:207]
  ds_read_b64_tr_b16 v[216:217], v15 offset:4096
  ds_read_b64_tr_b16 v[218:219], v15 offset:4224
  ds_read_b64_tr_b16 v[220:221], v15 offset:4352
  ds_read_b64_tr_b16 v[222:223], v15 offset:4480
  s_add_u32 m0, s33, 57344
  s_mov_b32 s34, 573440
  buffer_load_dwordx4 v58, s[12:15], s34 offen lds
  v_pk_add_f32 v[144:145], v[144:145], v[48:49]
  v_pk_add_f32 v[146:147], v[146:147], v[48:49]
  v_pk_add_f32 v[148:149], v[148:149], v[48:49]
  v_pk_add_f32 v[150:151], v[150:151], v[48:49]
  v_pk_add_f32 v[152:153], v[152:153], v[48:49]
  v_pk_add_f32 v[154:155], v[154:155], v[48:49]
  v_pk_add_f32 v[156:157], v[156:157], v[48:49]
  v_pk_add_f32 v[158:159], v[158:159], v[48:49]
  v_exp_f32 v144, v144
  v_exp_f32 v145, v145
  v_exp_f32 v146, v146
  v_exp_f32 v147, v147
  v_exp_f32 v148, v148
  v_exp_f32 v149, v149
  v_exp_f32 v150, v150
  v_exp_f32 v151, v151
  v_exp_f32 v152, v152
  v_exp_f32 v153, v153
  v_exp_f32 v154, v154
  v_exp_f32 v155, v155
  v_exp_f32 v156, v156
  v_exp_f32 v157, v157
  v_exp_f32 v158, v158
  v_exp_f32 v159, v159
  v_cvt_pk_bf16_f32 v240, v144, v145
  v_cvt_pk_bf16_f32 v241, v146, v147
  v_cvt_pk_bf16_f32 v242, v148, v149
  v_cvt_pk_bf16_f32 v243, v150, v151
  v_cvt_pk_bf16_f32 v244, v152, v153
  v_cvt_pk_bf16_f32 v245, v154, v155
  v_cvt_pk_bf16_f32 v246, v156, v157
  v_cvt_pk_bf16_f32 v247, v158, v159
  s_waitcnt lgkmcnt(8)
  s_nop 0
  v_mfma_f32_32x32x16_bf16 v[192:207], v[224:227], v[240:243], v[192:207]
  v_mfma_f32_32x32x16_bf16 v[192:207], v[228:231], v[244:247], v[192:207]
  ds_read_b64_tr_b16 v[224:225], v15 offset:0
  ds_read_b64_tr_b16 v[226:227], v15 offset:128
  ds_read_b64_tr_b16 v[228:229], v15 offset:256
  ds_read_b64_tr_b16 v[230:231], v15 offset:384
  s_add_u32 m0, s33, 65536
  s_mov_b32 s34, 655360
  buffer_load_dwordx4 v58, s[12:15], s34 offen lds
  v_pk_add_f32 v[160:161], v[160:161], v[48:49]
  v_pk_add_f32 v[162:163], v[162:163], v[48:49]
  v_pk_add_f32 v[164:165], v[164:165], v[48:49]
  v_pk_add_f32 v[166:167], v[166:167], v[48:49]
  v_pk_add_f32 v[168:169], v[168:169], v[48:49]
  v_pk_add_f32 v[170:171], v[170:171], v[48:49]
  v_pk_add_f32 v[172:173], v[172:173], v[48:49]
  v_pk_add_f32 v[174:175], v[174:175], v[48:49]
  v_exp_f32 v160, v160
  v_exp_f32 v161, v161
  v_exp_f32 v162, v162
  v_exp_f32 v163, v163
  v_exp_f32 v164, v164
  v_exp_f32 v165, v165
  v_exp_f32 v166, v166
  v_exp_f32 v167, v167
  v_exp_f32 v168, v168
  v_exp_f32 v169, v169
  v_exp_f32 v170, v170
  v_exp_f32 v171, v171
  v_exp_f32 v172, v172
  v_exp_f32 v173, v173
  v_exp_f32 v174, v174
  v_exp_f32 v175, v175
  v_cvt_pk_bf16_f32 v232, v160, v161
  v_cvt_pk_bf16_f32 v233, v162, v163
  v_cvt_pk_bf16_f32 v234, v164, v165
  v_cvt_pk_bf16_f32 v235, v166, v167
  v_cvt_pk_bf16_f32 v236, v168, v169
  v_cvt_pk_bf16_f32 v237, v170, v171
  v_cvt_pk_bf16_f32 v238, v172, v173
  v_cvt_pk_bf16_f32 v239, v174, v175
  s_waitcnt lgkmcnt(8)
  s_nop 0
  v_mfma_f32_32x32x16_bf16 v[192:207], v[208:211], v[232:235], v[192:207]
  v_mfma_f32_32x32x16_bf16 v[192:207], v[212:215], v[236:239], v[192:207]
  s_add_u32 m0, s33, 73728
  s_mov_b32 s34, 737280
  buffer_load_dwordx4 v58, s[12:15], s34 offen lds
  v_pk_add_f32 v[176:177], v[176:177], v[48:49]
  v_pk_add_f32 v[178:179], v[178:179], v[48:49]
  v_pk_add_f32 v[180:181], v[180:181], v[48:49]
  v_pk_add_f32 v[182:183], v[182:183], v[48:49]
  v_pk_add_f32 v[184:185], v[184:185], v[48:49]
  v_pk_add_f32 v[186:187], v[186:187], v[48:49]
  v_pk_add_f32 v[188:189], v[188:189], v[48:49]
  v_pk_add_f32 v[190:191], v[190:191], v[48:49]
  v_exp_f32 v176, v176
  v_exp_f32 v177, v177
  v_exp_f32 v178, v178
  v_exp_f32 v179, v179
  v_exp_f32 v180, v180
  v_exp_f32 v181, v181
  v_exp_f32 v182, v182
  v_exp_f32 v183, v183
  v_exp_f32 v184, v184
  v_exp_f32 v185, v185
  v_exp_f32 v186, v186
  v_exp_f32 v187, v187
  v_exp_f32 v188, v188
  v_exp_f32 v189, v189
  v_exp_f32 v190, v190
  v_exp_f32 v191, v191
  v_cndmask_b32 v64, 0, v176, s[64:65]
  v_cndmask_b32 v65, 0, v177, s[66:67]
  v_cndmask_b32 v66, 0, v178, s[68:69]
  v_cndmask_b32 v67, 0, v179, s[70:71]
  v_cndmask_b32 v68, 0, v180, s[72:73]
  v_cndmask_b32 v69, 0, v181, s[74:75]
  v_cndmask_b32 v70, 0, v182, s[76:77]
  v_cndmask_b32 v71, 0, v183, s[78:79]
  v_cndmask_b32 v72, 0, v184, s[80:81]
  v_cndmask_b32 v73, 0, v185, s[82:83]
  v_cndmask_b32 v74, 0, v186, s[84:85]
  v_cndmask_b32 v75, 0, v187, s[86:87]
  v_cndmask_b32 v76, 0, v188, s[88:89]
  v_cndmask_b32 v77, 0, v189, s[90:91]
  v_cndmask_b32 v78, 0, v190, s[92:93]
  v_cndmask_b32 v79, 0, v191, s[94:95]
  v_cvt_pk_bf16_f32 v240, v64, v65
  v_cvt_pk_bf16_f32 v241, v66, v67
  v_cvt_pk_bf16_f32 v242, v68, v69
  v_cvt_pk_bf16_f32 v243, v70, v71
  v_cvt_pk_bf16_f32 v244, v72, v73
  v_cvt_pk_bf16_f32 v245, v74, v75
  v_cvt_pk_bf16_f32 v246, v76, v77
  v_cvt_pk_bf16_f32 v247, v78, v79
  s_waitcnt lgkmcnt(4)
  s_nop 0
  v_mfma_f32_32x32x16_bf16 v[192:207], v[216:219], v[240:243], v[192:207]
  v_mfma_f32_32x32x16_bf16 v[192:207], v[220:223], v[244:247], v[192:207]
  v_cndmask_b32 v176, v176, 0, s[64:65]
  v_cndmask_b32 v177, v177, 0, s[66:67]
  v_cndmask_b32 v178, v178, 0, s[68:69]
  v_cndmask_b32 v179, v179, 0, s[70:71]
  v_cndmask_b32 v180, v180, 0, s[72:73]
  v_cndmask_b32 v181, v181, 0, s[74:75]
  v_cndmask_b32 v182, v182, 0, s[76:77]
  v_cndmask_b32 v183, v183, 0, s[78:79]
  v_cndmask_b32 v184, v184, 0, s[80:81]
  v_cndmask_b32 v185, v185, 0, s[82:83]
  v_cndmask_b32 v186, v186, 0, s[84:85]
  v_cndmask_b32 v187, v187, 0, s[86:87]
  v_cndmask_b32 v188, v188, 0, s[88:89]
  v_cndmask_b32 v189, v189, 0, s[90:91]
  v_cndmask_b32 v190, v190, 0, s[92:93]
  v_cndmask_b32 v191, v191, 0, s[94:95]
  v_cvt_pk_bf16_f32 v232, v176, v177
  v_cvt_pk_bf16_f32 v233, v178, v179
  v_cvt_pk_bf16_f32 v234, v180, v181
  v_cvt_pk_bf16_f32 v235, v182, v183
  v_cvt_pk_bf16_f32 v236, v184, v185
  v_cvt_pk_bf16_f32 v237, v186, v187
  v_cvt_pk_bf16_f32 v238, v188, v189
  v_cvt_pk_bf16_f32 v239, v190, v191
  s_waitcnt lgkmcnt(0)
  s_nop 0
  v_mfma_f32_32x32x16_bf16 v[192:207], v[224:227], v[232:235], v[192:207]
  v_mfma_f32_32x32x16_bf16 v[192:207], v[228:231], v[236:239], v[192:207]

  s_nop 7
  s_nop 3
  v_rcp_f32 v5, v204
  s_nop 0

  v_mul_f32 v192, v192, v5
  v_mul_f32 v193, v193, v5
  v_mul_f32 v194, v194, v5
  v_mul_f32 v195, v195, v5
  v_mul_f32 v196, v196, v5
  v_mul_f32 v197, v197, v5
  v_mul_f32 v198, v198, v5
  v_mul_f32 v199, v199, v5
  v_mul_f32 v200, v200, v5
  v_mul_f32 v201, v201, v5
  v_mul_f32 v202, v202, v5
  v_mul_f32 v203, v203, v5
  v_cvt_pk_bf16_f32 v28, v192, v193
  v_cvt_pk_bf16_f32 v29, v194, v195
  v_cvt_pk_bf16_f32 v30, v196, v197
  v_cvt_pk_bf16_f32 v31, v198, v199
  v_cvt_pk_bf16_f32 v32, v200, v201
  v_cvt_pk_bf16_f32 v33, v202, v203

  s_nop 1
  v_permlane32_swap_b32 v28, v30
  v_permlane32_swap_b32 v29, v31

  s_cmp_eq_u32 s46, 0
  s_cbranch_scc0 L_slow_9
  buffer_store_dwordx4 v[28:31], v24, s[8:11], 0 offen
L_back_9:
  s_mov_b32 exec_hi, 0
  s_cmp_eq_u32 s46, 0
  s_cbranch_scc0 L_slow_10
  buffer_store_dwordx2 v[32:33], v25, s[8:11], 0 offen
L_back_10:
  s_mov_b32 exec_hi, -1
  s_cmp_ge_u32 s22, 4
  s_cbranch_scc1 L_l_att_tail

  s_mul_i32 s30, s63, 43
  s_lshr_b32 s21, s30, 7
  s_mul_i32 s30, s21, 3
  s_sub_u32 s30, s63, s30
  s_mul_i32 s30, s30, 6
  s_lshl_b32 s20, s62, 4
  s_add_u32 s39, s20, 16
  s_add_u32 s20, s20, s30
  s_cmp_ge_u32 s63, 30
  s_cselect_b32 s21, 15, s21

  v_and_b32 v2, 63, v0
  v_and_b32 v3, 15, v2
  v_lshrrev_b32 v4, 4, v2
  s_and_b32 s23, s22, 1
  s_lshr_b32 s24, s22, 1
  s_lshl_b32 s30, s21, 3
  s_lshl_b32 s32, s24, 2
  s_add_u32 s30, s30, s32
  s_mul_i32 s32, s23, 3
  s_add_u32 s31, s20, s32
  v_and_b32 v5, 1, v4
  v_lshrrev_b32 v6, 1, v4
  v_lshl_add_u32 v5, v5, 1, v6
  s_mul_i32 s32, s31, 20480
  s_lshl_b32 s33, s30, 8
  s_add_u32 s32, s32, s33
  v_lshlrev_b32 v23, 8, v5
  v_lshl_add_u32 v23, v3, 4, v23
  v_add_u32 v23, s32, v23

  s_mul_i32 s30, s23, 6144
  v_lshlrev_b32 v6, 4, v2
  v_add_u32 v10, s30, v6
  v_lshrrev_b32 v5, 2, v3
  v_and_b32 v6, 3, v3
  v_lshrrev_b32 v7, 1, v5
  v_and_b32 v9, 1, v4
  v_lshl_or_b32 v7, v9, 1, v7
  v_lshl_add_u32 v8, v4, 3, v5
  v_lshlrev_b32 v8, 7, v8
  v_lshl_add_u32 v8, v6, 3, v8
  s_lshl_b32 s30, s24, 1

  s_add_u32 s32, s30, 0
  v_xor_b32 v9, s32, v7
  v_lshl_add_u32 v12, v9, 5, v8

  s_add_u32 s32, s30, 1
  v_xor_b32 v9, s32, v7
  v_lshl_add_u32 v13, v9, 5, v8

  s_waitcnt vmcnt(0) lgkmcnt(0)
  s_barrier
  s_cmp_eq_u32 s22, 0
  s_cbranch_scc0 L_c2_nosig

  s_mul_i32 s3, s96, 6
  s_add_u32 s3, s3, 2
  s_lshl_b32 s3, s3, 3
  s_add_u32 s3, s3, s62
  s_lshl_b32 s3, s3, 7
  s_add_u32 s3, s3, 0x07000000

  s_lshl_b32 s30, s63, 2
  s_add_u32 s30, s30, s3
  v_mov_b32 v6, s30
  v_mov_b32 v7, s101
  s_mov_b64 exec, 1

  s_cmp_eq_u32 s46, 0
  s_cbranch_scc0 L_c2_sigg
  global_store_dword v6, v7, s[60:61]
  s_branch L_c2_sigd
L_c2_sigg:
  global_store_dword v6, v7, s[60:61] sc1
L_c2_sigd:

  s_mov_b64 exec, -1
L_c2_nosig:
  s_cmp_eq_u32 s22, 0
  s_cbranch_scc0 L_c2_nopoll
  s_cmp_lg_u32 s97, 0
  s_cbranch_scc1 L_c2_nopoll

  s_mul_i32 s3, s96, 6
  s_add_u32 s3, s3, 2
  s_lshl_b32 s3, s3, 3
  s_add_u32 s3, s3, s62
  s_lshl_b32 s3, s3, 7
  s_add_u32 s3, s3, 0x07000000

  v_and_b32 v6, 63, v0
  v_lshl_add_u32 v6, v6, 2, s3
  s_mov_b32 s3, 400000
  s_mov_b32 exec_lo, 0xffffffff
  s_mov_b32 exec_hi, 0
L_c2_poll:
  global_load_dword v7, v6, s[60:61] sc1
  s_waitcnt vmcnt(0)
  v_cmp_ne_u32 vcc, s101, v7
  s_cbranch_vccz L_c2_ok
  s_sub_u32 s3, s3, 1
  s_cmp_eq_u32 s3, 0
  s_cbranch_scc0 L_c2_poll
  s_mov_b32 s97, 1
L_c2_ok:
  s_mov_b64 exec, -1
L_c2_nopoll:

  s_cmp_eq_u32 s21, 15
  s_cbranch_scc1 L_ce_10
  s_add_u32 s12, s60, 0x00b00000
  s_addc_u32 s13, s61, 0
  s_mul_i32 s14, s39, 20480
  s_mov_b32 s15, 0x00020000
  s_mov_b32 s33, 0
  buffer_load_dwordx4 v[176:179], v23, s[12:15], s33 offen sc1
  s_mov_b32 s33, 20480
  buffer_load_dwordx4 v[180:183], v23, s[12:15], s33 offen sc1
  s_mov_b32 s33, 40960
  buffer_load_dwordx4 v[184:187], v23, s[12:15], s33 offen sc1
  s_add_u32 s16, s60, 0x00e00000
  s_addc_u32 s17, s61, 0
  s_mov_b32 s18, 0x00050000
  s_mov_b32 s19, 0x00020000

  s_mul_i32 s31, s23, 3
  s_add_u32 s31, s31, s20
  s_lshl_b32 s30, s21, 1
  s_add_u32 s30, s30, s24
  s_lshl_b32 s30, s30, 14
  v_and_b32 v5, 1, v4
  v_add_u32 v5, s31, v5
  v_lshl_add_u32 v6, v5, 4, v3
  v_lshlrev_b32 v6, 2, v6
  v_lshrrev_b32 v7, 1, v4
  v_lshl_add_u32 v6, v7, 13, v6
  v_add_u32 v27, s30, v6
  v_cmp_gt_u32 s[36:37], s39, v5

L_ce_10:
  s_barrier
  s_cmp_eq_u32 s21, 15
  s_cbranch_scc1 L_c3_idle

  s_mul_i32 s31, s23, 3
  s_add_u32 s31, s31, s20
  s_mov_b32 s26, 0
  s_mov_b32 s27, 65792

  v_add_u32 v18, 65792, v12
  v_add_u32 v19, 65792, v13
  v_add_u32 v20, 131328, v12
  v_add_u32 v21, 131328, v13
  s_barrier
  ds_read_b64_tr_b16 v[96:97], v18 offset:0
  ds_read_b64_tr_b16 v[98:99], v18 offset:512
  ds_read_b64_tr_b16 v[100:101], v19 offset:0
  ds_read_b64_tr_b16 v[102:103], v19 offset:512
  ds_read_b128 v[104:107], v10 offset:0
  ds_read_b128 v[108:111], v10 offset:2048
  ds_read_b128 v[112:115], v10 offset:4096
  ds_read_b64_tr_b16 v[116:117], v18 offset:4096
  ds_read_b64_tr_b16 v[118:119], v18 offset:4608
  ds_read_b64_tr_b16 v[120:121], v19 offset:4096
  ds_read_b64_tr_b16 v[122:123], v19 offset:4608
  ds_read_b128 v[124:127], v10 offset:1024
  ds_read_b128 v[128:131], v10 offset:3072
  ds_read_b128 v[132:135], v10 offset:5120
  s_barrier
  ds_read_b64_tr_b16 v[136:137], v18 offset:8192
  ds_read_b64_tr_b16 v[138:139], v18 offset:8704
  ds_read_b64_tr_b16 v[140:141], v19 offset:8192
  s_waitcnt lgkmcnt(10)
  v_mfma_f32_16x16x32_bf16 v[64:67], v[96:99], v[104:107], 0
  ds_read_b64_tr_b16 v[142:143], v19 offset:8704
  v_mfma_f32_16x16x32_bf16 v[68:71], v[96:99], v[108:111], 0
  ds_read_b128 v[144:147], v10 offset:12288
  v_mfma_f32_16x16x32_bf16 v[72:75], v[96:99], v[112:115], 0
  ds_read_b128 v[148:151], v10 offset:14336
  v_mfma_f32_16x16x32_bf16 v[76:79], v[100:103], v[104:107], 0
  ds_read_b128 v[152:155], v10 offset:16384
  v_mfma_f32_16x16x32_bf16 v[80:83], v[100:103], v[108:111], 0
  ds_read_b64_tr_b16 v[156:157], v18 offset:12288
  v_mfma_f32_16x16x32_bf16 v[84:87], v[100:103], v[112:115], 0
  ds_read_b64_tr_b16 v[158:159], v18 offset:12800
  s_waitcnt lgkmcnt(9)
  v_mfma_f32_16x16x32_bf16 v[64:67], v[116:119], v[124:127], v[64:67]
  ds_read_b64_tr_b16 v[160:161], v19 offset:12288
  v_mfma_f32_16x16x32_bf16 v[68:71], v[116:119], v[128:131], v[68:71]
  ds_read_b64_tr_b16 v[162:163], v19 offset:12800
  v_mfma_f32_16x16x32_bf16 v[72:75], v[116:119], v[132:135], v[72:75]
  ds_read_b128 v[164:167], v10 offset:13312
  v_mfma_f32_16x16x32_bf16 v[76:79], v[120:123], v[124:127], v[76:79]
  ds_read_b128 v[168:171], v10 offset:15360
  v_mfma_f32_16x16x32_bf16 v[80:83], v[120:123], v[128:131], v[80:83]
  ds_read_b128 v[172:175], v10 offset:17408
  v_mfma_f32_16x16x32_bf16 v[84:87], v[120:123], v[132:135], v[84:87]
  s_waitcnt vmcnt(0)
  v_permlane16_swap_b32 v176, v178
  v_permlane16_swap_b32 v177, v179
  v_permlane16_swap_b32 v180, v182
  v_permlane16_swap_b32 v181, v183
  v_permlane16_swap_b32 v184, v186
  v_permlane16_swap_b32 v185, v187
  s_nop 1
  v_lshlrev_b32 v192, 16, v176
  v_and_b32 v193, 0xffff0000, v176
  v_lshlrev_b32 v194, 16, v177
  v_and_b32 v195, 0xffff0000, v177
  v_lshlrev_b32 v196, 16, v180
  v_and_b32 v197, 0xffff0000, v180
  v_lshlrev_b32 v198, 16, v181
  v_and_b32 v199, 0xffff0000, v181
  v_lshlrev_b32 v200, 16, v184
  v_and_b32 v201, 0xffff0000, v184
  v_lshlrev_b32 v202, 16, v185
  v_and_b32 v203, 0xffff0000, v185
  v_lshlrev_b32 v204, 16, v178
  v_and_b32 v205, 0xffff0000, v178
  v_lshlrev_b32 v206, 16, v179
  v_and_b32 v207, 0xffff0000, v179
  v_lshlrev_b32 v208, 16, v182
  v_and_b32 v209, 0xffff0000, v182
  v_lshlrev_b32 v210, 16, v183
  v_and_b32 v211, 0xffff0000, v183
  v_lshlrev_b32 v212, 16, v186
  v_and_b32 v213, 0xffff0000, v186
  v_lshlrev_b32 v214, 16, v187
  v_and_b32 v215, 0xffff0000, v187
  s_barrier
  ds_read_b64_tr_b16 v[96:97], v18 offset:16384
  ds_read_b64_tr_b16 v[98:99], v18 offset:16896
  ds_read_b64_tr_b16 v[100:101], v19 offset:16384
  s_waitcnt lgkmcnt(10)
  v_mfma_f32_16x16x32_bf16 v[64:67], v[136:139], v[144:147], v[64:67]
  ds_read_b64_tr_b16 v[102:103], v19 offset:16896
  v_mfma_f32_16x16x32_bf16 v[68:71], v[136:139], v[148:151], v[68:71]
  ds_read_b128 v[104:107], v10 offset:24576
  v_mfma_f32_16x16x32_bf16 v[72:75], v[136:139], v[152:155], v[72:75]
  ds_read_b128 v[108:111], v10 offset:26624
  v_mfma_f32_16x16x32_bf16 v[76:79], v[140:143], v[144:147], v[76:79]
  ds_read_b128 v[112:115], v10 offset:28672
  v_mfma_f32_16x16x32_bf16 v[80:83], v[140:143], v[148:151], v[80:83]
  ds_read_b64_tr_b16 v[116:117], v18 offset:20480
  v_mfma_f32_16x16x32_bf16 v[84:87], v[140:143], v[152:155], v[84:87]
  ds_read_b64_tr_b16 v[118:119], v18 offset:20992
  s_waitcnt lgkmcnt(9)
  v_mfma_f32_16x16x32_bf16 v[64:67], v[156:159], v[164:167], v[64:67]
  ds_read_b64_tr_b16 v[120:121], v19 offset:20480
  v_mfma_f32_16x16x32_bf16 v[68:71], v[156:159], v[168:171], v[68:71]
  ds_read_b64_tr_b16 v[122:123], v19 offset:20992
  v_mfma_f32_16x16x32_bf16 v[72:75], v[156:159], v[172:175], v[72:75]
  ds_read_b128 v[124:127], v10 offset:25600
  v_mfma_f32_16x16x32_bf16 v[76:79], v[160:163], v[164:167], v[76:79]
  ds_read_b128 v[128:131], v10 offset:27648
  v_mfma_f32_16x16x32_bf16 v[80:83], v[160:163], v[168:171], v[80:83]
  ds_read_b128 v[132:135], v10 offset:29696
  v_mfma_f32_16x16x32_bf16 v[84:87], v[160:163], v[172:175], v[84:87]
  s_barrier
  ds_read_b64_tr_b16 v[136:137], v18 offset:24576
  ds_read_b64_tr_b16 v[138:139], v18 offset:25088
  ds_read_b64_tr_b16 v[140:141], v19 offset:24576
  s_waitcnt lgkmcnt(10)
  v_mfma_f32_16x16x32_bf16 v[64:67], v[96:99], v[104:107], v[64:67]
  ds_read_b64_tr_b16 v[142:143], v19 offset:25088
  v_mfma_f32_16x16x32_bf16 v[68:71], v[96:99], v[108:111], v[68:71]
  ds_read_b128 v[144:147], v10 offset:36864
  v_mfma_f32_16x16x32_bf16 v[72:75], v[96:99], v[112:115], v[72:75]
  ds_read_b128 v[148:151], v10 offset:38912
  v_mfma_f32_16x16x32_bf16 v[76:79], v[100:103], v[104:107], v[76:79]
  ds_read_b128 v[152:155], v10 offset:40960
  v_mfma_f32_16x16x32_bf16 v[80:83], v[100:103], v[108:111], v[80:83]
  ds_read_b64_tr_b16 v[156:157], v18 offset:28672
  v_mfma_f32_16x16x32_bf16 v[84:87], v[100:103], v[112:115], v[84:87]
  ds_read_b64_tr_b16 v[158:159], v18 offset:29184
  s_waitcnt lgkmcnt(9)
  v_mfma_f32_16x16x32_bf16 v[64:67], v[116:119], v[124:127], v[64:67]
  ds_read_b64_tr_b16 v[160:161], v19 offset:28672
  v_mfma_f32_16x16x32_bf16 v[68:71], v[116:119], v[128:131], v[68:71]
  ds_read_b64_tr_b16 v[162:163], v19 offset:29184
  v_mfma_f32_16x16x32_bf16 v[72:75], v[116:119], v[132:135], v[72:75]
  ds_read_b128 v[164:167], v10 offset:37888
  v_mfma_f32_16x16x32_bf16 v[76:79], v[120:123], v[124:127], v[76:79]
  ds_read_b128 v[168:171], v10 offset:39936
  v_mfma_f32_16x16x32_bf16 v[80:83], v[120:123], v[128:131], v[80:83]
  ds_read_b128 v[172:175], v10 offset:41984
  v_mfma_f32_16x16x32_bf16 v[84:87], v[120:123], v[132:135], v[84:87]
  s_barrier
  ds_read_b64_tr_b16 v[96:97], v18 offset:32768
  ds_read_b64_tr_b16 v[98:99], v18 offset:33280
  ds_read_b64_tr_b16 v[100:101], v19 offset:32768
  s_waitcnt lgkmcnt(10)
  v_mfma_f32_16x16x32_bf16 v[64:67], v[136:139], v[144:147], v[64:67]
  ds_read_b64_tr_b16 v[102:103], v19 offset:33280
  v_mfma_f32_16x16x32_bf16 v[68:71], v[136:139], v[148:151], v[68:71]
  ds_read_b128 v[104:107], v10 offset:49152
  v_mfma_f32_16x16x32_bf16 v[72:75], v[136:139], v[152:155], v[72:75]
  ds_read_b128 v[108:111], v10 offset:51200
  v_mfma_f32_16x16x32_bf16 v[76:79], v[140:143], v[144:147], v[76:79]
  ds_read_b128 v[112:115], v10 offset:53248
  v_mfma_f32_16x16x32_bf16 v[80:83], v[140:143], v[148:151], v[80:83]
  ds_read_b64_tr_b16 v[116:117], v18 offset:36864
  v_mfma_f32_16x16x32_bf16 v[84:87], v[140:143], v[152:155], v[84:87]
  ds_read_b64_tr_b16 v[118:119], v18 offset:37376
  s_waitcnt lgkmcnt(9)
  v_mfma_f32_16x16x32_bf16 v[64:67], v[156:159], v[164:167], v[64:67]
  ds_read_b64_tr_b16 v[120:121], v19 offset:36864
  v_mfma_f32_16x16x32_bf16 v[68:71], v[156:159], v[168:171], v[68:71]
  ds_read_b64_tr_b16 v[122:123], v19 offset:37376
  v_mfma_f32_16x16x32_bf16 v[72:75], v[156:159], v[172:175], v[72:75]
  ds_read_b128 v[124:127], v10 offset:50176
  v_mfma_f32_16x16x32_bf16 v[76:79], v[160:163], v[164:167], v[76:79]
  ds_read_b128 v[128:131], v10 offset:52224
  v_mfma_f32_16x16x32_bf16 v[80:83], v[160:163], v[168:171], v[80:83]
  ds_read_b128 v[132:135], v10 offset:54272
  v_mfma_f32_16x16x32_bf16 v[84:87], v[160:163], v[172:175], v[84:87]
  s_barrier
  ds_read_b64_tr_b16 v[136:137], v18 offset:40960
  ds_read_b64_tr_b16 v[138:139], v18 offset:41472
  ds_read_b64_tr_b16 v[140:141], v19 offset:40960
  s_waitcnt lgkmcnt(10)
  v_mfma_f32_16x16x32_bf16 v[64:67], v[96:99], v[104:107], v[64:67]
  ds_read_b64_tr_b16 v[142:143], v19 offset:41472
  v_mfma_f32_16x16x32_bf16 v[68:71], v[96:99], v[108:111], v[68:71]
  ds_read_b128 v[144:147], v10 offset:0
  v_mfma_f32_16x16x32_bf16 v[72:75], v[96:99], v[112:115], v[72:75]
  ds_read_b128 v[148:151], v10 offset:2048
  v_mfma_f32_16x16x32_bf16 v[76:79], v[100:103], v[104:107], v[76:79]
  ds_read_b128 v[152:155], v10 offset:4096
  v_mfma_f32_16x16x32_bf16 v[80:83], v[100:103], v[108:111], v[80:83]
  ds_read_b64_tr_b16 v[156:157], v18 offset:45056
  v_mfma_f32_16x16x32_bf16 v[84:87], v[100:103], v[112:115], v[84:87]
  ds_read_b64_tr_b16 v[158:159], v18 offset:45568
  s_waitcnt lgkmcnt(9)
  v_mfma_f32_16x16x32_bf16 v[64:67], v[116:119], v[124:127], v[64:67]
  ds_read_b64_tr_b16 v[160:161], v19 offset:45056
  v_mfma_f32_16x16x32_bf16 v[68:71], v[116:119], v[128:131], v[68:71]
  ds_read_b64_tr_b16 v[162:163], v19 offset:45568
  v_mfma_f32_16x16x32_bf16 v[72:75], v[116:119], v[132:135], v[72:75]
  ds_read_b128 v[164:167], v10 offset:1024
  v_mfma_f32_16x16x32_bf16 v[76:79], v[120:123], v[124:127], v[76:79]
  ds_read_b128 v[168:171], v10 offset:3072
  v_mfma_f32_16x16x32_bf16 v[80:83], v[120:123], v[128:131], v[80:83]
  ds_read_b128 v[172:175], v10 offset:5120
  v_mfma_f32_16x16x32_bf16 v[84:87], v[120:123], v[132:135], v[84:87]
  s_barrier
  ds_read_b64_tr_b16 v[96:97], v18 offset:49152
  ds_read_b64_tr_b16 v[98:99], v18 offset:49664
  ds_read_b64_tr_b16 v[100:101], v19 offset:49152
  s_waitcnt lgkmcnt(10)
  v_mfma_f32_16x16x32_bf16 v[64:67], v[136:139], v[144:147], v[64:67]
  ds_read_b64_tr_b16 v[102:103], v19 offset:49664
  v_mfma_f32_16x16x32_bf16 v[68:71], v[136:139], v[148:151], v[68:71]
  ds_read_b128 v[104:107], v10 offset:12288
  v_mfma_f32_16x16x32_bf16 v[72:75], v[136:139], v[152:155], v[72:75]
  ds_read_b128 v[108:111], v10 offset:14336
  v_mfma_f32_16x16x32_bf16 v[76:79], v[140:143], v[144:147], v[76:79]
  ds_read_b128 v[112:115], v10 offset:16384
  v_mfma_f32_16x16x32_bf16 v[80:83], v[140:143], v[148:151], v[80:83]
  ds_read_b64_tr_b16 v[116:117], v18 offset:53248
  v_mfma_f32_16x16x32_bf16 v[84:87], v[140:143], v[152:155], v[84:87]
  ds_read_b64_tr_b16 v[118:119], v18 offset:53760
  s_waitcnt lgkmcnt(9)
  v_mfma_f32_16x16x32_bf16 v[64:67], v[156:159], v[164:167], v[64:67]
  ds_read_b64_tr_b16 v[120:121], v19 offset:53248
  v_mfma_f32_16x16x32_bf16 v[68:71], v[156:159], v[168:171], v[68:71]
  ds_read_b64_tr_b16 v[122:123], v19 offset:53760
  v_mfma_f32_16x16x32_bf16 v[72:75], v[156:159], v[172:175], v[72:75]
  ds_read_b128 v[124:127], v10 offset:13312
  v_mfma_f32_16x16x32_bf16 v[76:79], v[160:163], v[164:167], v[76:79]
  ds_read_b128 v[128:131], v10 offset:15360
  v_mfma_f32_16x16x32_bf16 v[80:83], v[160:163], v[168:171], v[80:83]
  ds_read_b128 v[132:135], v10 offset:17408
  v_mfma_f32_16x16x32_bf16 v[84:87], v[160:163], v[172:175], v[84:87]
  s_barrier
  ds_read_b64_tr_b16 v[136:137], v18 offset:57344
  ds_read_b64_tr_b16 v[138:139], v18 offset:57856
  ds_read_b64_tr_b16 v[140:141], v19 offset:57344
  s_waitcnt lgkmcnt(10)
  v_mfma_f32_16x16x32_bf16 v[64:67], v[96:99], v[104:107], v[64:67]
  ds_read_b64_tr_b16 v[142:143], v19 offset:57856
  v_mfma_f32_16x16x32_bf16 v[68:71], v[96:99], v[108:111], v[68:71]
  ds_read_b128 v[144:147], v10 offset:24576
  v_mfma_f32_16x16x32_bf16 v[72:75], v[96:99], v[112:115], v[72:75]
  ds_read_b128 v[148:151], v10 offset:26624
  v_mfma_f32_16x16x32_bf16 v[76:79], v[100:103], v[104:107], v[76:79]
  ds_read_b128 v[152:155], v10 offset:28672
  v_mfma_f32_16x16x32_bf16 v[80:83], v[100:103], v[108:111], v[80:83]
  ds_read_b64_tr_b16 v[156:157], v18 offset:61440
  v_mfma_f32_16x16x32_bf16 v[84:87], v[100:103], v[112:115], v[84:87]
  ds_read_b64_tr_b16 v[158:159], v18 offset:61952
  s_waitcnt lgkmcnt(9)
  v_mfma_f32_16x16x32_bf16 v[64:67], v[116:119], v[124:127], v[64:67]
  ds_read_b64_tr_b16 v[160:161], v19 offset:61440
  v_mfma_f32_16x16x32_bf16 v[68:71], v[116:119], v[128:131], v[68:71]
  ds_read_b64_tr_b16 v[162:163], v19 offset:61952
  v_mfma_f32_16x16x32_bf16 v[72:75], v[116:119], v[132:135], v[72:75]
  ds_read_b128 v[164:167], v10 offset:25600
  v_mfma_f32_16x16x32_bf16 v[76:79], v[120:123], v[124:127], v[76:79]
  ds_read_b128 v[168:171], v10 offset:27648
  v_mfma_f32_16x16x32_bf16 v[80:83], v[120:123], v[128:131], v[80:83]
  ds_read_b128 v[172:175], v10 offset:29696
  v_mfma_f32_16x16x32_bf16 v[84:87], v[120:123], v[132:135], v[84:87]
  s_barrier
  ds_read_b64_tr_b16 v[96:97], v20 offset:0
  ds_read_b64_tr_b16 v[98:99], v20 offset:512
  ds_read_b64_tr_b16 v[100:101], v21 offset:0
  s_waitcnt lgkmcnt(10)
  v_mfma_f32_16x16x32_bf16 v[64:67], v[136:139], v[144:147], v[64:67]
  ds_read_b64_tr_b16 v[102:103], v21 offset:512
  v_mfma_f32_16x16x32_bf16 v[68:71], v[136:139], v[148:151], v[68:71]
  ds_read_b128 v[104:107], v10 offset:36864
  v_mfma_f32_16x16x32_bf16 v[72:75], v[136:139], v[152:155], v[72:75]
  ds_read_b128 v[108:111], v10 offset:38912
  v_mfma_f32_16x16x32_bf16 v[76:79], v[140:143], v[144:147], v[76:79]
  ds_read_b128 v[112:115], v10 offset:40960
  v_mfma_f32_16x16x32_bf16 v[80:83], v[140:143], v[148:151], v[80:83]
  ds_read_b64_tr_b16 v[116:117], v20 offset:4096
  v_mfma_f32_16x16x32_bf16 v[84:87], v[140:143], v[152:155], v[84:87]
  ds_read_b64_tr_b16 v[118:119], v20 offset:4608
  s_waitcnt lgkmcnt(9)
  v_mfma_f32_16x16x32_bf16 v[64:67], v[156:159], v[164:167], v[64:67]
  ds_read_b64_tr_b16 v[120:121], v21 offset:4096
  v_mfma_f32_16x16x32_bf16 v[68:71], v[156:159], v[168:171], v[68:71]
  ds_read_b64_tr_b16 v[122:123], v21 offset:4608
  v_mfma_f32_16x16x32_bf16 v[72:75], v[156:159], v[172:175], v[72:75]
  ds_read_b128 v[124:127], v10 offset:37888
  v_mfma_f32_16x16x32_bf16 v[76:79], v[160:163], v[164:167], v[76:79]
  ds_read_b128 v[128:131], v10 offset:39936
  v_mfma_f32_16x16x32_bf16 v[80:83], v[160:163], v[168:171], v[80:83]
  ds_read_b128 v[132:135], v10 offset:41984
  v_mfma_f32_16x16x32_bf16 v[84:87], v[160:163], v[172:175], v[84:87]
  s_barrier
  ds_read_b64_tr_b16 v[136:137], v20 offset:8192
  ds_read_b64_tr_b16 v[138:139], v20 offset:8704
  ds_read_b64_tr_b16 v[140:141], v21 offset:8192
  s_waitcnt lgkmcnt(10)
  v_mfma_f32_16x16x32_bf16 v[64:67], v[96:99], v[104:107], v[64:67]
  ds_read_b64_tr_b16 v[142:143], v21 offset:8704
  v_mfma_f32_16x16x32_bf16 v[68:71], v[96:99], v[108:111], v[68:71]
  ds_read_b128 v[144:147], v10 offset:49152
  v_mfma_f32_16x16x32_bf16 v[72:75], v[96:99], v[112:115], v[72:75]
  ds_read_b128 v[148:151], v10 offset:51200
  v_mfma_f32_16x16x32_bf16 v[76:79], v[100:103], v[104:107], v[76:79]
  ds_read_b128 v[152:155], v10 offset:53248
  v_mfma_f32_16x16x32_bf16 v[80:83], v[100:103], v[108:111], v[80:83]
  ds_read_b64_tr_b16 v[156:157], v20 offset:12288
  v_mfma_f32_16x16x32_bf16 v[84:87], v[100:103], v[112:115], v[84:87]
  ds_read_b64_tr_b16 v[158:159], v20 offset:12800
  s_waitcnt lgkmcnt(9)
  v_mfma_f32_16x16x32_bf16 v[64:67], v[116:119], v[124:127], v[64:67]
  ds_read_b64_tr_b16 v[160:161], v21 offset:12288
  v_mfma_f32_16x16x32_bf16 v[68:71], v[116:119], v[128:131], v[68:71]
  ds_read_b64_tr_b16 v[162:163], v21 offset:12800
  v_mfma_f32_16x16x32_bf16 v[72:75], v[116:119], v[132:135], v[72:75]
  ds_read_b128 v[164:167], v10 offset:50176
  v_mfma_f32_16x16x32_bf16 v[76:79], v[120:123], v[124:127], v[76:79]
  ds_read_b128 v[168:171], v10 offset:52224
  v_mfma_f32_16x16x32_bf16 v[80:83], v[120:123], v[128:131], v[80:83]
  ds_read_b128 v[172:175], v10 offset:54272
  v_mfma_f32_16x16x32_bf16 v[84:87], v[120:123], v[132:135], v[84:87]
  s_waitcnt lgkmcnt(0)
  s_barrier
  v_mfma_f32_16x16x32_bf16 v[64:67], v[136:139], v[144:147], v[64:67]
  v_mfma_f32_16x16x32_bf16 v[68:71], v[136:139], v[148:151], v[68:71]
  v_mfma_f32_16x16x32_bf16 v[72:75], v[136:139], v[152:155], v[72:75]
  v_mfma_f32_16x16x32_bf16 v[76:79], v[140:143], v[144:147], v[76:79]
  v_mfma_f32_16x16x32_bf16 v[80:83], v[140:143], v[148:151], v[80:83]
  v_mfma_f32_16x16x32_bf16 v[84:87], v[140:143], v[152:155], v[84:87]
  v_mfma_f32_16x16x32_bf16 v[64:67], v[156:159], v[164:167], v[64:67]
  v_mfma_f32_16x16x32_bf16 v[68:71], v[156:159], v[168:171], v[68:71]
  v_mfma_f32_16x16x32_bf16 v[72:75], v[156:159], v[172:175], v[72:75]
  v_mfma_f32_16x16x32_bf16 v[76:79], v[160:163], v[164:167], v[76:79]
  v_mfma_f32_16x16x32_bf16 v[80:83], v[160:163], v[168:171], v[80:83]
  v_mfma_f32_16x16x32_bf16 v[84:87], v[160:163], v[172:175], v[84:87]
  s_nop 3
  v_pk_add_f32 v[64:65], v[64:65], v[192:193]
  v_pk_add_f32 v[66:67], v[66:67], v[194:195]
  v_pk_add_f32 v[76:77], v[76:77], v[204:205]
  v_pk_add_f32 v[78:79], v[78:79], v[206:207]
  v_pk_add_f32 v[68:69], v[68:69], v[196:197]
  v_pk_add_f32 v[70:71], v[70:71], v[198:199]
  v_pk_add_f32 v[80:81], v[80:81], v[208:209]
  v_pk_add_f32 v[82:83], v[82:83], v[210:211]
  v_pk_add_f32 v[72:73], v[72:73], v[200:201]
  v_pk_add_f32 v[74:75], v[74:75], v[202:203]
  v_pk_add_f32 v[84:85], v[84:85], v[212:213]
  v_pk_add_f32 v[86:87], v[86:87], v[214:215]
  v_cvt_pk_bf16_f32 v224, v64, v65
  v_cvt_pk_bf16_f32 v225, v66, v67
  v_cvt_pk_bf16_f32 v226, v76, v77
  v_cvt_pk_bf16_f32 v227, v78, v79
  v_cvt_pk_bf16_f32 v228, v68, v69
  v_cvt_pk_bf16_f32 v229, v70, v71
  v_cvt_pk_bf16_f32 v230, v80, v81
  v_cvt_pk_bf16_f32 v231, v82, v83
  v_cvt_pk_bf16_f32 v232, v72, v73
  v_cvt_pk_bf16_f32 v233, v74, v75
  v_cvt_pk_bf16_f32 v234, v84, v85
  v_cvt_pk_bf16_f32 v235, v86, v87
  s_nop 1
  v_permlane16_swap_b32 v224, v226
  v_permlane16_swap_b32 v225, v227
  v_permlane16_swap_b32 v228, v230
  v_permlane16_swap_b32 v229, v231
  v_permlane16_swap_b32 v232, v234
  v_permlane16_swap_b32 v233, v235
  s_mov_b32 s32, 20480
  s_mov_b32 s33, 40960
  s_cmp_eq_u32 s46, 0
  s_cbranch_scc0 L_slow_11
  buffer_store_dwordx4 v[224:227], v23, s[12:15], 0 offen
  buffer_store_dwordx4 v[228:231], v23, s[12:15], s32 offen
  buffer_store_dwordx4 v[232:235], v23, s[12:15], s33 offen
L_back_11:
  v_pk_add_f32 v[96:97], v[64:65], v[66:67]
  v_pk_mul_f32 v[98:99], v[64:65], v[64:65]
  v_pk_add_f32 v[100:101], v[68:69], v[70:71]
  v_pk_mul_f32 v[102:103], v[68:69], v[68:69]
  v_pk_add_f32 v[104:105], v[72:73], v[74:75]
  v_pk_mul_f32 v[106:107], v[72:73], v[72:73]
  v_pk_add_f32 v[96:97], v[96:97], v[76:77]
  v_pk_fma_f32 v[98:99], v[66:67], v[66:67], v[98:99]
  v_pk_add_f32 v[100:101], v[100:101], v[80:81]
  v_pk_fma_f32 v[102:103], v[70:71], v[70:71], v[102:103]
  v_pk_add_f32 v[104:105], v[104:105], v[84:85]
  v_pk_fma_f32 v[106:107], v[74:75], v[74:75], v[106:107]
  v_pk_add_f32 v[96:97], v[96:97], v[78:79]
  v_pk_fma_f32 v[98:99], v[76:77], v[76:77], v[98:99]
  v_pk_add_f32 v[100:101], v[100:101], v[82:83]
  v_pk_fma_f32 v[102:103], v[80:81], v[80:81], v[102:103]
  v_pk_add_f32 v[104:105], v[104:105], v[86:87]
  v_pk_fma_f32 v[106:107], v[84:85], v[84:85], v[106:107]
  v_pk_fma_f32 v[98:99], v[78:79], v[78:79], v[98:99]
  v_add_f32 v96, v96, v97
  v_pk_fma_f32 v[102:103], v[82:83], v[82:83], v[102:103]
  v_add_f32 v100, v100, v101
  v_pk_fma_f32 v[106:107], v[86:87], v[86:87], v[106:107]
  v_add_f32 v104, v104, v105
  v_add_f32 v98, v98, v99
  v_add_f32 v102, v102, v103
  v_add_f32 v106, v106, v107
  s_nop 1
  v_permlane32_swap_b32 v96, v98
  v_permlane32_swap_b32 v100, v102
  v_permlane32_swap_b32 v104, v106
  s_nop 1
  v_add_f32 v96, v96, v98
  v_add_f32 v100, v100, v102
  v_add_f32 v104, v104, v106
  v_mov_b32 v105, v104
  s_nop 1
  v_permlane16_swap_b32 v96, v100
  v_permlane16_swap_b32 v104, v105

  s_nop 1
  v_add_f32 v96, v96, v100
  v_add_f32 v104, v104, v105
  s_and_saveexec_b64 s[34:35], s[36:37]

  s_cmp_eq_u32 s46, 0
  s_cbranch_scc0 L_slow_12
  buffer_store_dword v96, v27, s[16:19], 0 offen
L_back_12:

  s_mov_b64 exec, s[34:35]
  s_add_u32 s32, s31, 2
  s_cmp_lt_u32 s32, s39
  s_cbranch_scc0 L_wo_nost
  s_mov_b32 exec_lo, 0x0000ffff
  s_mov_b32 exec_hi, 0x0000ffff

  s_cmp_eq_u32 s46, 0
  s_cbranch_scc0 L_slow_13
  buffer_store_dword v104, v27, s[16:19], 0 offen offset:128
L_back_13:
  s_mov_b64 exec, -1
L_wo_nost:
  s_branch L_c3_tail
L_c3_idle:
L_c3_tail:

  s_and_b32 s30, s63, 1
  s_lshl_b32 s20, s62, 1
  s_add_u32 s20, s20, s30
  s_lshr_b32 s21, s63, 1
  s_cmp_ge_u32 s63, 28
  s_cselect_b32 s21, 15, s21

  v_and_b32 v2, 63, v0
  v_and_b32 v3, 31, v2
  v_lshrrev_b32 v4, 5, v2
  s_and_b32 s23, s22, 1
  s_lshr_b32 s24, s22, 1
  v_and_b32 v5, 15, v2
  v_lshrrev_b32 v6, 2, v5
  v_and_b32 v7, 3, v5
  v_lshl_add_u32 v8, v4, 3, v6
  v_lshlrev_b32 v8, 8, v8
  v_lshl_add_u32 v8, v7, 3, v8
  v_bfe_u32 v9, v2, 4, 1
  v_lshl_add_u32 v8, v9, 5, v8
  s_lshl_b32 s30, s24, 1

  s_xor_b32 s32, s23, 0
  s_add_u32 s32, s32, s30
  v_xor_b32 v9, s32, v6
  v_lshl_add_u32 v12, v9, 6, v8

  s_xor_b32 s32, s23, 1
  s_add_u32 s32, s32, s30
  v_xor_b32 v9, s32, v6
  v_lshl_add_u32 v13, v9, 6, v8

  v_lshrrev_b32 v5, 4, v3
  v_lshlrev_b32 v5, 11, v5
  v_and_b32 v6, 15, v3
  v_lshl_add_u32 v5, v6, 4, v5
  v_lshl_add_u32 v5, v4, 8, v5
  s_lshl_b32 s30, s23, 13
  v_add_u32 v10, s30, v5

  s_waitcnt vmcnt(0) lgkmcnt(0)
  s_barrier
  s_cmp_eq_u32 s22, 0
  s_cbranch_scc0 L_c3_nosig

  s_mul_i32 s3, s96, 6
  s_add_u32 s3, s3, 3
  s_lshl_b32 s3, s3, 3
  s_add_u32 s3, s3, s62
  s_lshl_b32 s3, s3, 7
  s_add_u32 s3, s3, 0x07000000

  s_lshl_b32 s30, s63, 2
  s_add_u32 s30, s30, s3
  v_mov_b32 v6, s30
  v_mov_b32 v7, s101
  s_mov_b64 exec, 1

  s_cmp_eq_u32 s46, 0
  s_cbranch_scc0 L_c3_sigg
  global_store_dword v6, v7, s[60:61]
  s_branch L_c3_sigd
L_c3_sigg:
  global_store_dword v6, v7, s[60:61] sc1
L_c3_sigd:

  s_mov_b64 exec, -1
L_c3_nosig:
  s_cmp_eq_u32 s22, 0
  s_cbranch_scc0 L_c3_nopoll
  s_cmp_lg_u32 s97, 0
  s_cbranch_scc1 L_c3_nopoll

  s_mul_i32 s3, s96, 6
  s_add_u32 s3, s3, 3
  s_lshl_b32 s3, s3, 3
  s_add_u32 s3, s3, s62
  s_lshl_b32 s3, s3, 7
  s_add_u32 s3, s3, 0x07000000

  v_and_b32 v6, 63, v0
  v_lshl_add_u32 v6, v6, 2, s3
  s_mov_b32 s3, 400000
  s_mov_b32 exec_lo, 0x3fffffff
  s_mov_b32 exec_hi, 0
L_c3_poll:
  global_load_dword v7, v6, s[60:61] sc1
  s_waitcnt vmcnt(0)
  v_cmp_ne_u32 vcc, s101, v7
  s_cbranch_vccz L_c3_ok
  s_sub_u32 s3, s3, 1
  s_cmp_eq_u32 s3, 0
  s_cbranch_scc0 L_c3_poll
  s_mov_b32 s97, 1
L_c3_ok:
  s_mov_b64 exec, -1
L_c3_nopoll:

  s_barrier

  s_cmp_eq_u32 s21, 15
  s_cbranch_scc1 L_c4_idle
  s_cmp_eq_u32 s96, 0
  s_cbranch_scc0 L_c4_lean

  v_and_b32 v5, 15, v2
  v_bfe_u32 v6, v2, 4, 1
  v_cmp_eq_u32 vcc, v5, v6
  v_mov_b32 v7, 0x3f803f80
  v_mov_b32 v9, 0
  v_cndmask_b32 v200, v9, v7, vcc
  v_cndmask_b32 v201, v9, v7, vcc
  v_cndmask_b32 v202, v9, v7, vcc
  v_cndmask_b32 v203, v9, v7, vcc
  v_mov_b32 v128, 0
  v_mov_b32 v129, 0
  v_mov_b32 v130, 0
  v_mov_b32 v131, 0

  s_mov_b32 s26, 81920
  s_mov_b32 s27, 0
  v_add_u32 v16, s26, v10
  v_add_u32 v18, s27, v12
  v_add_u32 v19, s27, v13
  s_barrier
  ds_read_b64_tr_b16 v[136:137], v18 offset:0
  ds_read_b64_tr_b16 v[138:139], v18 offset:1024
  ds_read_b64_tr_b16 v[144:145], v19 offset:0
  ds_read_b64_tr_b16 v[146:147], v19 offset:1024
  ds_read_b128 v[152:155], v16 offset:0
  ds_read_b128 v[160:163], v16 offset:4096
  ds_read_b64_tr_b16 v[140:141], v18 offset:4096
  ds_read_b64_tr_b16 v[142:143], v18 offset:5120
  ds_read_b64_tr_b16 v[148:149], v19 offset:4096
  ds_read_b64_tr_b16 v[150:151], v19 offset:5120
  ds_read_b128 v[156:159], v16 offset:512
  ds_read_b128 v[164:167], v16 offset:4608
  s_waitcnt lgkmcnt(0)
  ds_read_b64_tr_b16 v[168:169], v18 offset:8192
  ds_read_b64_tr_b16 v[170:171], v18 offset:9216
  v_mfma_f32_16x16x32_bf16 v[128:131], v[136:139], v[200:203], v[128:131]
  ds_read_b64_tr_b16 v[176:177], v19 offset:8192
  ds_read_b64_tr_b16 v[178:179], v19 offset:9216
  v_mfma_f32_32x32x16_bf16 v[64:79], v[136:139], v[152:155], 0
  ds_read_b128 v[184:187], v16 offset:1024
  ds_read_b128 v[192:195], v16 offset:5120
  v_mfma_f32_32x32x16_bf16 v[80:95], v[136:139], v[160:163], 0
  ds_read_b64_tr_b16 v[172:173], v18 offset:12288
  ds_read_b64_tr_b16 v[174:175], v18 offset:13312
  v_mfma_f32_32x32x16_bf16 v[96:111], v[144:147], v[152:155], 0
  ds_read_b64_tr_b16 v[180:181], v19 offset:12288
  ds_read_b64_tr_b16 v[182:183], v19 offset:13312
  v_mfma_f32_32x32x16_bf16 v[112:127], v[144:147], v[160:163], 0
  ds_read_b128 v[188:191], v16 offset:1536
  ds_read_b128 v[196:199], v16 offset:5632
  v_mfma_f32_16x16x32_bf16 v[128:131], v[140:143], v[200:203], v[128:131]
  v_mfma_f32_32x32x16_bf16 v[64:79], v[140:143], v[156:159], v[64:79]
  v_mfma_f32_32x32x16_bf16 v[80:95], v[140:143], v[164:167], v[80:95]
  v_mfma_f32_32x32x16_bf16 v[96:111], v[148:151], v[156:159], v[96:111]
  v_mfma_f32_32x32x16_bf16 v[112:127], v[148:151], v[164:167], v[112:127]
  s_add_u32 s26, s26, 16384
  s_cmp_eq_u32 s26, 131072
  s_cselect_b32 s26, 81920, s26
  s_add_u32 s27, s27, 16384
  s_cmp_eq_u32 s27, 81920
  s_cselect_b32 s27, 0, s27
  v_add_u32 v16, s26, v10
  v_add_u32 v18, s27, v12
  v_add_u32 v19, s27, v13
  s_mov_b32 s25, 1
  s_waitcnt lgkmcnt(0)
L_mlp1_aloop:
  s_barrier
  ds_read_b64_tr_b16 v[136:137], v18 offset:0
  ds_read_b64_tr_b16 v[138:139], v18 offset:1024
  v_mfma_f32_16x16x32_bf16 v[128:131], v[168:171], v[200:203], v[128:131]
  ds_read_b64_tr_b16 v[144:145], v19 offset:0
  ds_read_b64_tr_b16 v[146:147], v19 offset:1024
  v_mfma_f32_32x32x16_bf16 v[64:79], v[168:171], v[184:187], v[64:79]
  ds_read_b128 v[152:155], v16 offset:0
  ds_read_b128 v[160:163], v16 offset:4096
  v_mfma_f32_32x32x16_bf16 v[80:95], v[168:171], v[192:195], v[80:95]
  ds_read_b64_tr_b16 v[140:141], v18 offset:4096
  ds_read_b64_tr_b16 v[142:143], v18 offset:5120
  v_mfma_f32_32x32x16_bf16 v[96:111], v[176:179], v[184:187], v[96:111]
  ds_read_b64_tr_b16 v[148:149], v19 offset:4096
  ds_read_b64_tr_b16 v[150:151], v19 offset:5120
  v_mfma_f32_32x32x16_bf16 v[112:127], v[176:179], v[192:195], v[112:127]
  ds_read_b128 v[156:159], v16 offset:512
  ds_read_b128 v[164:167], v16 offset:4608
  v_mfma_f32_16x16x32_bf16 v[128:131], v[172:175], v[200:203], v[128:131]
  v_mfma_f32_32x32x16_bf16 v[64:79], v[172:175], v[188:191], v[64:79]
  v_mfma_f32_32x32x16_bf16 v[80:95], v[172:175], v[196:199], v[80:95]
  v_mfma_f32_32x32x16_bf16 v[96:111], v[180:183], v[188:191], v[96:111]
  v_mfma_f32_32x32x16_bf16 v[112:127], v[180:183], v[196:199], v[112:127]
  s_waitcnt lgkmcnt(0)
  ds_read_b64_tr_b16 v[168:169], v18 offset:8192
  ds_read_b64_tr_b16 v[170:171], v18 offset:9216
  v_mfma_f32_16x16x32_bf16 v[128:131], v[136:139], v[200:203], v[128:131]
  ds_read_b64_tr_b16 v[176:177], v19 offset:8192
  ds_read_b64_tr_b16 v[178:179], v19 offset:9216
  v_mfma_f32_32x32x16_bf16 v[64:79], v[136:139], v[152:155], v[64:79]
  ds_read_b128 v[184:187], v16 offset:1024
  ds_read_b128 v[192:195], v16 offset:5120
  v_mfma_f32_32x32x16_bf16 v[80:95], v[136:139], v[160:163], v[80:95]
  ds_read_b64_tr_b16 v[172:173], v18 offset:12288
  ds_read_b64_tr_b16 v[174:175], v18 offset:13312
  v_mfma_f32_32x32x16_bf16 v[96:111], v[144:147], v[152:155], v[96:111]
  ds_read_b64_tr_b16 v[180:181], v19 offset:12288
  ds_read_b64_tr_b16 v[182:183], v19 offset:13312
  v_mfma_f32_32x32x16_bf16 v[112:127], v[144:147], v[160:163], v[112:127]
  ds_read_b128 v[188:191], v16 offset:1536
  ds_read_b128 v[196:199], v16 offset:5632
  v_mfma_f32_16x16x32_bf16 v[128:131], v[140:143], v[200:203], v[128:131]
  v_mfma_f32_32x32x16_bf16 v[64:79], v[140:143], v[156:159], v[64:79]
  v_mfma_f32_32x32x16_bf16 v[80:95], v[140:143], v[164:167], v[80:95]
  v_mfma_f32_32x32x16_bf16 v[96:111], v[148:151], v[156:159], v[96:111]
  v_mfma_f32_32x32x16_bf16 v[112:127], v[148:151], v[164:167], v[112:127]
  s_add_u32 s26, s26, 16384
  s_cmp_eq_u32 s26, 131072
  s_cselect_b32 s26, 81920, s26
  s_add_u32 s27, s27, 16384
  s_cmp_eq_u32 s27, 81920
  s_cselect_b32 s27, 0, s27
  v_add_u32 v16, s26, v10
  v_add_u32 v18, s27, v12
  v_add_u32 v19, s27, v13
  s_add_u32 s25, s25, 1
  s_cmp_lt_u32 s25, 10
  s_waitcnt lgkmcnt(0)
  s_cbranch_scc1 L_mlp1_aloop
  v_mfma_f32_16x16x32_bf16 v[128:131], v[168:171], v[200:203], v[128:131]
  v_mfma_f32_16x16x32_bf16 v[128:131], v[172:175], v[200:203], v[128:131]
  v_mfma_f32_32x32x16_bf16 v[64:79], v[168:171], v[184:187], v[64:79]
  v_mfma_f32_32x32x16_bf16 v[80:95], v[168:171], v[192:195], v[80:95]
  v_mfma_f32_32x32x16_bf16 v[96:111], v[176:179], v[184:187], v[96:111]
  v_mfma_f32_32x32x16_bf16 v[112:127], v[176:179], v[192:195], v[112:127]
  v_mfma_f32_32x32x16_bf16 v[64:79], v[172:175], v[188:191], v[64:79]
  v_mfma_f32_32x32x16_bf16 v[80:95], v[172:175], v[196:199], v[80:95]
  v_mfma_f32_32x32x16_bf16 v[96:111], v[180:183], v[188:191], v[96:111]
  v_mfma_f32_32x32x16_bf16 v[112:127], v[180:183], v[196:199], v[112:127]

  s_lshl_b32 s30, s24, 1
  s_add_u32 s30, s30, s23
  s_lshl_b32 s30, s30, 7
  s_add_u32 s30, s30, 162816
  v_and_b32 v5, 15, v2
  v_lshrrev_b32 v6, 4, v2
  v_lshlrev_b32 v6, 4, v6
  v_lshl_add_u32 v6, v5, 6, v6
  v_add_u32 v6, s30, v6
  v_cmp_gt_u32 vcc, 2, v5
  s_nop 1
  s_and_saveexec_b64 s[34:35], vcc
  ds_write_b128 v6, v[128:131]
  s_mov_b64 exec, s[34:35]
  s_waitcnt lgkmcnt(0)
  s_barrier

  s_lshl_b32 s30, s23, 9
  s_add_u32 s30, s30, 161280
  v_lshl_add_u32 v5, v3, 3, s30
  ds_read_b64 v[38:39], v5
  ds_read_b64 v[40:41], v5 offset:256
  s_lshl_b32 s30, s24, 8
  s_add_u32 s30, s30, 162816
  v_lshl_add_u32 v6, v4, 4, s30
  s_lshl_b32 s31, s23, 7

  s_xor_b32 s32, s31, 0
  v_add_u32 v7, s32, v6
  ds_read_b128 v[224:227], v7 offset:0
  ds_read_b128 v[228:231], v7 offset:32
  ds_read_b128 v[232:235], v7 offset:64
  ds_read_b128 v[236:239], v7 offset:96
  ds_read_b128 v[136:139], v7 offset:512
  ds_read_b128 v[140:143], v7 offset:544
  ds_read_b128 v[144:147], v7 offset:576
  ds_read_b128 v[148:151], v7 offset:608
  s_xor_b32 s32, s31, 128
  v_add_u32 v7, s32, v6
  ds_read_b128 v[240:243], v7 offset:0
  ds_read_b128 v[244:247], v7 offset:32
  ds_read_b128 v[248:251], v7 offset:64
  ds_read_b128 v[252:255], v7 offset:96
  ds_read_b128 v[152:155], v7 offset:512
  ds_read_b128 v[156:159], v7 offset:544
  ds_read_b128 v[160:163], v7 offset:576
  ds_read_b128 v[164:167], v7 offset:608
  s_add_u32 s12, s60, 0x00000000
  s_addc_u32 s13, s61, 0
  s_mov_b32 s14, 0x00780000
  s_mov_b32 s15, 0x00020000

  s_cmp_eq_u32 s21, 13
  s_cselect_b32 s30, s24, 0
  s_cmp_eq_u32 s30, 1
  s_cbranch_scc1 L_c4_tail
  s_and_b32 s30, s20, 1
  s_lshl_b32 s30, s30, 3
  s_lshl_b32 s32, s23, 2
  s_add_u32 s30, s30, s32
  v_lshrrev_b32 v8, 4, v3
  v_add_u32 v8, s30, v8
  v_mul_u32_u24 v8, 14, v8
  v_add_u32 v8, s21, v8
  v_lshlrev_b32 v8, 15, v8
  v_lshl_add_u32 v8, v4, 8, v8
  v_and_b32 v9, 15, v3
  v_lshl_add_u32 v8, v9, 4, v8
  s_lshl_b32 s30, s62, 12
  s_lshl_b32 s32, s24, 11
  s_add_u32 s30, s30, s32
  v_add_u32 v46, s30, v8
  s_lshl_b32 s38, s23, 10

  v_mov_b32 v42, 0xc0135761
  v_mov_b32 v43, 0xbdd2d3e8
  v_mov_b32 v44, 1.0
  v_mov_b32 v45, 1.0

  s_branch L_c4_epi
L_c4_lean:
  s_mov_b32 s26, 81920
  s_mov_b32 s27, 0
  v_add_u32 v16, s26, v10
  v_add_u32 v18, s27, v12
  v_add_u32 v19, s27, v13
  s_barrier
  ds_read_b64_tr_b16 v[136:137], v18 offset:0
  ds_read_b64_tr_b16 v[138:139], v18 offset:1024
  ds_read_b64_tr_b16 v[144:145], v19 offset:0
  ds_read_b64_tr_b16 v[146:147], v19 offset:1024
  ds_read_b128 v[152:155], v16 offset:0
  ds_read_b128 v[160:163], v16 offset:4096
  ds_read_b64_tr_b16 v[140:141], v18 offset:4096
  ds_read_b64_tr_b16 v[142:143], v18 offset:5120
  ds_read_b64_tr_b16 v[148:149], v19 offset:4096
  ds_read_b64_tr_b16 v[150:151], v19 offset:5120
  ds_read_b128 v[156:159], v16 offset:512
  ds_read_b128 v[164:167], v16 offset:4608
  s_waitcnt lgkmcnt(0)
  ds_read_b64_tr_b16 v[168:169], v18 offset:8192
  ds_read_b64_tr_b16 v[170:171], v18 offset:9216
  v_mfma_f32_32x32x16_bf16 v[64:79], v[136:139], v[152:155], 0
  ds_read_b64_tr_b16 v[176:177], v19 offset:8192
  ds_read_b64_tr_b16 v[178:179], v19 offset:9216
  ds_read_b128 v[184:187], v16 offset:1024
  v_mfma_f32_32x32x16_bf16 v[80:95], v[136:139], v[160:163], 0
  ds_read_b128 v[192:195], v16 offset:5120
  ds_read_b64_tr_b16 v[172:173], v18 offset:12288
  ds_read_b64_tr_b16 v[174:175], v18 offset:13312
  v_mfma_f32_32x32x16_bf16 v[96:111], v[144:147], v[152:155], 0
  ds_read_b64_tr_b16 v[180:181], v19 offset:12288
  ds_read_b64_tr_b16 v[182:183], v19 offset:13312
  ds_read_b128 v[188:191], v16 offset:1536
  v_mfma_f32_32x32x16_bf16 v[112:127], v[144:147], v[160:163], 0
  ds_read_b128 v[196:199], v16 offset:5632
  v_mfma_f32_32x32x16_bf16 v[64:79], v[140:143], v[156:159], v[64:79]
  v_mfma_f32_32x32x16_bf16 v[80:95], v[140:143], v[164:167], v[80:95]
  v_mfma_f32_32x32x16_bf16 v[96:111], v[148:151], v[156:159], v[96:111]
  v_mfma_f32_32x32x16_bf16 v[112:127], v[148:151], v[164:167], v[112:127]
  s_add_u32 s26, s26, 16384
  s_cmp_eq_u32 s26, 131072
  s_cselect_b32 s26, 81920, s26
  s_add_u32 s27, s27, 16384
  s_cmp_eq_u32 s27, 81920
  s_cselect_b32 s27, 0, s27
  v_add_u32 v16, s26, v10
  v_add_u32 v18, s27, v12
  v_add_u32 v19, s27, v13
  s_mov_b32 s25, 1
  s_waitcnt lgkmcnt(0)
L_mlp1_bloop:
  s_barrier
  ds_read_b64_tr_b16 v[136:137], v18 offset:0
  ds_read_b64_tr_b16 v[138:139], v18 offset:1024
  v_mfma_f32_32x32x16_bf16 v[64:79], v[168:171], v[184:187], v[64:79]
  ds_read_b64_tr_b16 v[144:145], v19 offset:0
  ds_read_b64_tr_b16 v[146:147], v19 offset:1024
  ds_read_b128 v[152:155], v16 offset:0
  v_mfma_f32_32x32x16_bf16 v[80:95], v[168:171], v[192:195], v[80:95]
  ds_read_b128 v[160:163], v16 offset:4096
  ds_read_b64_tr_b16 v[140:141], v18 offset:4096
  ds_read_b64_tr_b16 v[142:143], v18 offset:5120
  v_mfma_f32_32x32x16_bf16 v[96:111], v[176:179], v[184:187], v[96:111]
  ds_read_b64_tr_b16 v[148:149], v19 offset:4096
  ds_read_b64_tr_b16 v[150:151], v19 offset:5120
  ds_read_b128 v[156:159], v16 offset:512
  v_mfma_f32_32x32x16_bf16 v[112:127], v[176:179], v[192:195], v[112:127]
  ds_read_b128 v[164:167], v16 offset:4608
  v_mfma_f32_32x32x16_bf16 v[64:79], v[172:175], v[188:191], v[64:79]
  v_mfma_f32_32x32x16_bf16 v[80:95], v[172:175], v[196:199], v[80:95]
  v_mfma_f32_32x32x16_bf16 v[96:111], v[180:183], v[188:191], v[96:111]
  v_mfma_f32_32x32x16_bf16 v[112:127], v[180:183], v[196:199], v[112:127]
  s_waitcnt lgkmcnt(0)
  ds_read_b64_tr_b16 v[168:169], v18 offset:8192
  ds_read_b64_tr_b16 v[170:171], v18 offset:9216
  v_mfma_f32_32x32x16_bf16 v[64:79], v[136:139], v[152:155], v[64:79]
  ds_read_b64_tr_b16 v[176:177], v19 offset:8192
  ds_read_b64_tr_b16 v[178:179], v19 offset:9216
  ds_read_b128 v[184:187], v16 offset:1024
  v_mfma_f32_32x32x16_bf16 v[80:95], v[136:139], v[160:163], v[80:95]
  ds_read_b128 v[192:195], v16 offset:5120
  ds_read_b64_tr_b16 v[172:173], v18 offset:12288
  ds_read_b64_tr_b16 v[174:175], v18 offset:13312
  v_mfma_f32_32x32x16_bf16 v[96:111], v[144:147], v[152:155], v[96:111]
  ds_read_b64_tr_b16 v[180:181], v19 offset:12288
  ds_read_b64_tr_b16 v[182:183], v19 offset:13312
  ds_read_b128 v[188:191], v16 offset:1536
  v_mfma_f32_32x32x16_bf16 v[112:127], v[144:147], v[160:163], v[112:127]
  ds_read_b128 v[196:199], v16 offset:5632
  v_mfma_f32_32x32x16_bf16 v[64:79], v[140:143], v[156:159], v[64:79]
  v_mfma_f32_32x32x16_bf16 v[80:95], v[140:143], v[164:167], v[80:95]
  v_mfma_f32_32x32x16_bf16 v[96:111], v[148:151], v[156:159], v[96:111]
  v_mfma_f32_32x32x16_bf16 v[112:127], v[148:151], v[164:167], v[112:127]
  s_add_u32 s26, s26, 16384
  s_cmp_eq_u32 s26, 131072
  s_cselect_b32 s26, 81920, s26
  s_add_u32 s27, s27, 16384
  s_cmp_eq_u32 s27, 81920
  s_cselect_b32 s27, 0, s27
  v_add_u32 v16, s26, v10
  v_add_u32 v18, s27, v12
  v_add_u32 v19, s27, v13
  s_add_u32 s25, s25, 1
  s_cmp_lt_u32 s25, 10
  s_waitcnt lgkmcnt(0)
  s_cbranch_scc1 L_mlp1_bloop
  s_barrier

  s_lshl_b32 s30, s23, 9
  s_add_u32 s30, s30, 161280
  v_lshl_add_u32 v5, v3, 3, s30
  ds_read_b64 v[38:39], v5
  ds_read_b64 v[40:41], v5 offset:256
  s_lshl_b32 s30, s24, 8
  s_add_u32 s30, s30, 162816
  v_lshl_add_u32 v6, v4, 4, s30
  s_lshl_b32 s31, s23, 7

  s_xor_b32 s32, s31, 0
  v_add_u32 v7, s32, v6
  ds_read_b128 v[224:227], v7 offset:0
  ds_read_b128 v[228:231], v7 offset:32
  ds_read_b128 v[232:235], v7 offset:64
  ds_read_b128 v[236:239], v7 offset:96
  ds_read_b128 v[136:139], v7 offset:512
  ds_read_b128 v[140:143], v7 offset:544
  ds_read_b128 v[144:147], v7 offset:576
  ds_read_b128 v[148:151], v7 offset:608
  s_xor_b32 s32, s31, 128
  v_add_u32 v7, s32, v6
  ds_read_b128 v[240:243], v7 offset:0
  ds_read_b128 v[244:247], v7 offset:32
  ds_read_b128 v[248:251], v7 offset:64
  ds_read_b128 v[252:255], v7 offset:96
  ds_read_b128 v[152:155], v7 offset:512
  ds_read_b128 v[156:159], v7 offset:544
  ds_read_b128 v[160:163], v7 offset:576
  ds_read_b128 v[164:167], v7 offset:608
  s_add_u32 s12, s60, 0x00000000
  s_addc_u32 s13, s61, 0
  s_mov_b32 s14, 0x00780000
  s_mov_b32 s15, 0x00020000

  s_cmp_eq_u32 s21, 13
  s_cselect_b32 s30, s24, 0
  s_cmp_eq_u32 s30, 1
  s_cbranch_scc1 L_c4_tail
  s_and_b32 s30, s20, 1
  s_lshl_b32 s30, s30, 3
  s_lshl_b32 s32, s23, 2
  s_add_u32 s30, s30, s32
  v_lshrrev_b32 v8, 4, v3
  v_add_u32 v8, s30, v8
  v_mul_u32_u24 v8, 14, v8
  v_add_u32 v8, s21, v8
  v_lshlrev_b32 v8, 15, v8
  v_lshl_add_u32 v8, v4, 8, v8
  v_and_b32 v9, 15, v3
  v_lshl_add_u32 v8, v9, 4, v8
  s_lshl_b32 s30, s62, 12
  s_lshl_b32 s32, s24, 11
  s_add_u32 s30, s30, s32
  v_add_u32 v46, s30, v8
  s_lshl_b32 s38, s23, 10

  v_mov_b32 v42, 0xc0135761
  v_mov_b32 v43, 0xbdd2d3e8
  v_mov_b32 v44, 1.0
  v_mov_b32 v45, 1.0

  v_mfma_f32_32x32x16_bf16 v[64:79], v[168:171], v[184:187], v[64:79]
  v_mfma_f32_32x32x16_bf16 v[80:95], v[168:171], v[192:195], v[80:95]
  v_mfma_f32_32x32x16_bf16 v[96:111], v[176:179], v[184:187], v[96:111]
  v_mfma_f32_32x32x16_bf16 v[112:127], v[176:179], v[192:195], v[112:127]
  v_mfma_f32_32x32x16_bf16 v[64:79], v[172:175], v[188:191], v[64:79]
  v_mfma_f32_32x32x16_bf16 v[80:95], v[172:175], v[196:199], v[80:95]
  v_mfma_f32_32x32x16_bf16 v[96:111], v[180:183], v[188:191], v[96:111]
  v_mfma_f32_32x32x16_bf16 v[112:127], v[180:183], v[196:199], v[112:127]
L_c4_epi:
  s_waitcnt lgkmcnt(0)
  s_nop 7
  v_pk_fma_f32 v[64:65], v[224:225], v[38:39], v[64:65] op_sel_hi:[1,0,1] neg_lo:[0,1,0] neg_hi:[0,1,0]
  v_pk_fma_f32 v[66:67], v[226:227], v[38:39], v[66:67] op_sel_hi:[1,0,1] neg_lo:[0,1,0] neg_hi:[0,1,0]
  v_pk_fma_f32 v[68:69], v[228:229], v[38:39], v[68:69] op_sel_hi:[1,0,1] neg_lo:[0,1,0] neg_hi:[0,1,0]
  v_pk_fma_f32 v[70:71], v[230:231], v[38:39], v[70:71] op_sel_hi:[1,0,1] neg_lo:[0,1,0] neg_hi:[0,1,0]
  v_pk_fma_f32 v[72:73], v[232:233], v[38:39], v[72:73] op_sel_hi:[1,0,1] neg_lo:[0,1,0] neg_hi:[0,1,0]
  v_pk_fma_f32 v[74:75], v[234:235], v[38:39], v[74:75] op_sel_hi:[1,0,1] neg_lo:[0,1,0] neg_hi:[0,1,0]
  v_pk_fma_f32 v[76:77], v[236:237], v[38:39], v[76:77] op_sel_hi:[1,0,1] neg_lo:[0,1,0] neg_hi:[0,1,0]
  v_pk_fma_f32 v[78:79], v[238:239], v[38:39], v[78:79] op_sel_hi:[1,0,1] neg_lo:[0,1,0] neg_hi:[0,1,0]
  v_pk_fma_f32 v[64:65], v[64:65], v[38:39], v[136:137] op_sel:[0,1,0] op_sel_hi:[1,1,1]
  v_pk_fma_f32 v[66:67], v[66:67], v[38:39], v[138:139] op_sel:[0,1,0] op_sel_hi:[1,1,1]
  v_pk_fma_f32 v[68:69], v[68:69], v[38:39], v[140:141] op_sel:[0,1,0] op_sel_hi:[1,1,1]
  v_pk_fma_f32 v[70:71], v[70:71], v[38:39], v[142:143] op_sel:[0,1,0] op_sel_hi:[1,1,1]
  v_pk_fma_f32 v[72:73], v[72:73], v[38:39], v[144:145] op_sel:[0,1,0] op_sel_hi:[1,1,1]
  v_pk_fma_f32 v[74:75], v[74:75], v[38:39], v[146:147] op_sel:[0,1,0] op_sel_hi:[1,1,1]
  v_pk_fma_f32 v[76:77], v[76:77], v[38:39], v[148:149] op_sel:[0,1,0] op_sel_hi:[1,1,1]
  v_pk_fma_f32 v[78:79], v[78:79], v[38:39], v[150:151] op_sel:[0,1,0] op_sel_hi:[1,1,1]
  v_pk_mul_f32 v[168:169], v[64:65], v[64:65]
  v_pk_mul_f32 v[170:171], v[66:67], v[66:67]
  v_pk_mul_f32 v[172:173], v[68:69], v[68:69]
  v_pk_mul_f32 v[174:175], v[70:71], v[70:71]
  v_pk_mul_f32 v[176:177], v[72:73], v[72:73]
  v_pk_mul_f32 v[178:179], v[74:75], v[74:75]
  v_pk_mul_f32 v[180:181], v[76:77], v[76:77]
  v_pk_mul_f32 v[182:183], v[78:79], v[78:79]
  v_pk_fma_f32 v[168:169], v[168:169], v[42:43], v[42:43] op_sel:[0,1,0] op_sel_hi:[1,1,0]
  v_pk_fma_f32 v[170:171], v[170:171], v[42:43], v[42:43] op_sel:[0,1,0] op_sel_hi:[1,1,0]
  v_pk_fma_f32 v[172:173], v[172:173], v[42:43], v[42:43] op_sel:[0,1,0] op_sel_hi:[1,1,0]
  v_pk_fma_f32 v[174:175], v[174:175], v[42:43], v[42:43] op_sel:[0,1,0] op_sel_hi:[1,1,0]
  v_pk_fma_f32 v[176:177], v[176:177], v[42:43], v[42:43] op_sel:[0,1,0] op_sel_hi:[1,1,0]
  v_pk_fma_f32 v[178:179], v[178:179], v[42:43], v[42:43] op_sel:[0,1,0] op_sel_hi:[1,1,0]
  v_pk_fma_f32 v[180:181], v[180:181], v[42:43], v[42:43] op_sel:[0,1,0] op_sel_hi:[1,1,0]
  v_pk_fma_f32 v[182:183], v[182:183], v[42:43], v[42:43] op_sel:[0,1,0] op_sel_hi:[1,1,0]
  v_pk_mul_f32 v[168:169], v[168:169], v[64:65]
  v_pk_mul_f32 v[170:171], v[170:171], v[66:67]
  v_pk_mul_f32 v[172:173], v[172:173], v[68:69]
  v_pk_mul_f32 v[174:175], v[174:175], v[70:71]
  v_pk_mul_f32 v[176:177], v[176:177], v[72:73]
  v_pk_mul_f32 v[178:179], v[178:179], v[74:75]
  v_pk_mul_f32 v[180:181], v[180:181], v[76:77]
  v_pk_mul_f32 v[182:183], v[182:183], v[78:79]
  v_exp_f32 v184, v168
  v_exp_f32 v185, v169
  v_exp_f32 v186, v170
  v_exp_f32 v187, v171
  v_exp_f32 v188, v172
  v_exp_f32 v189, v173
  v_exp_f32 v190, v174
  v_exp_f32 v191, v175
  v_exp_f32 v192, v176
  v_exp_f32 v193, v177
  v_exp_f32 v194, v178
  v_exp_f32 v195, v179
  v_exp_f32 v196, v180
  v_exp_f32 v197, v181
  v_exp_f32 v198, v182
  v_exp_f32 v199, v183
  v_pk_add_f32 v[184:185], v[184:185], v[44:45]
  v_pk_add_f32 v[186:187], v[186:187], v[44:45]
  v_pk_add_f32 v[188:189], v[188:189], v[44:45]
  v_pk_add_f32 v[190:191], v[190:191], v[44:45]
  v_pk_add_f32 v[192:193], v[192:193], v[44:45]
  v_pk_add_f32 v[194:195], v[194:195], v[44:45]
  v_pk_add_f32 v[196:197], v[196:197], v[44:45]
  v_pk_add_f32 v[198:199], v[198:199], v[44:45]
  v_rcp_f32 v184, v184
  v_rcp_f32 v185, v185
  v_rcp_f32 v186, v186
  v_rcp_f32 v187, v187
  v_rcp_f32 v188, v188
  v_rcp_f32 v189, v189
  v_rcp_f32 v190, v190
  v_rcp_f32 v191, v191
  v_rcp_f32 v192, v192
  v_rcp_f32 v193, v193
  v_rcp_f32 v194, v194
  v_rcp_f32 v195, v195
  v_rcp_f32 v196, v196
  v_rcp_f32 v197, v197
  v_rcp_f32 v198, v198
  v_rcp_f32 v199, v199
  v_pk_mul_f32 v[64:65], v[64:65], v[184:185]
  v_pk_mul_f32 v[66:67], v[66:67], v[186:187]
  v_pk_mul_f32 v[68:69], v[68:69], v[188:189]
  v_pk_mul_f32 v[70:71], v[70:71], v[190:191]
  v_pk_mul_f32 v[72:73], v[72:73], v[192:193]
  v_pk_mul_f32 v[74:75], v[74:75], v[194:195]
  v_pk_mul_f32 v[76:77], v[76:77], v[196:197]
  v_pk_mul_f32 v[78:79], v[78:79], v[198:199]
  v_cvt_pk_bf16_f32 v64, v64, v65
  v_cvt_pk_bf16_f32 v65, v66, v67
  v_cvt_pk_bf16_f32 v66, v68, v69
  v_cvt_pk_bf16_f32 v67, v70, v71
  v_cvt_pk_bf16_f32 v68, v72, v73
  v_cvt_pk_bf16_f32 v69, v74, v75
  v_cvt_pk_bf16_f32 v70, v76, v77
  v_cvt_pk_bf16_f32 v71, v78, v79
  s_xor_b32 s32, s38, 0
  s_add_u32 s32, s32, 0
  v_permlane32_swap_b32 v64, v66
  v_permlane32_swap_b32 v65, v67
  v_permlane32_swap_b32 v68, v70
  v_permlane32_swap_b32 v69, v71
  s_cmp_eq_u32 s46, 0
  s_cbranch_scc0 L_slow_14
  buffer_store_dwordx4 v[64:67], v46, s[12:15], s32 offen
  buffer_store_dwordx4 v[68:71], v46, s[12:15], s32 offen offset:512
L_back_14:
  v_pk_fma_f32 v[96:97], v[240:241], v[38:39], v[96:97] op_sel_hi:[1,0,1] neg_lo:[0,1,0] neg_hi:[0,1,0]
  v_pk_fma_f32 v[98:99], v[242:243], v[38:39], v[98:99] op_sel_hi:[1,0,1] neg_lo:[0,1,0] neg_hi:[0,1,0]
  v_pk_fma_f32 v[100:101], v[244:245], v[38:39], v[100:101] op_sel_hi:[1,0,1] neg_lo:[0,1,0] neg_hi:[0,1,0]
  v_pk_fma_f32 v[102:103], v[246:247], v[38:39], v[102:103] op_sel_hi:[1,0,1] neg_lo:[0,1,0] neg_hi:[0,1,0]
  v_pk_fma_f32 v[104:105], v[248:249], v[38:39], v[104:105] op_sel_hi:[1,0,1] neg_lo:[0,1,0] neg_hi:[0,1,0]
  v_pk_fma_f32 v[106:107], v[250:251], v[38:39], v[106:107] op_sel_hi:[1,0,1] neg_lo:[0,1,0] neg_hi:[0,1,0]
  v_pk_fma_f32 v[108:109], v[252:253], v[38:39], v[108:109] op_sel_hi:[1,0,1] neg_lo:[0,1,0] neg_hi:[0,1,0]
  v_pk_fma_f32 v[110:111], v[254:255], v[38:39], v[110:111] op_sel_hi:[1,0,1] neg_lo:[0,1,0] neg_hi:[0,1,0]
  v_pk_fma_f32 v[96:97], v[96:97], v[38:39], v[152:153] op_sel:[0,1,0] op_sel_hi:[1,1,1]
  v_pk_fma_f32 v[98:99], v[98:99], v[38:39], v[154:155] op_sel:[0,1,0] op_sel_hi:[1,1,1]
  v_pk_fma_f32 v[100:101], v[100:101], v[38:39], v[156:157] op_sel:[0,1,0] op_sel_hi:[1,1,1]
  v_pk_fma_f32 v[102:103], v[102:103], v[38:39], v[158:159] op_sel:[0,1,0] op_sel_hi:[1,1,1]
  v_pk_fma_f32 v[104:105], v[104:105], v[38:39], v[160:161] op_sel:[0,1,0] op_sel_hi:[1,1,1]
  v_pk_fma_f32 v[106:107], v[106:107], v[38:39], v[162:163] op_sel:[0,1,0] op_sel_hi:[1,1,1]
  v_pk_fma_f32 v[108:109], v[108:109], v[38:39], v[164:165] op_sel:[0,1,0] op_sel_hi:[1,1,1]
  v_pk_fma_f32 v[110:111], v[110:111], v[38:39], v[166:167] op_sel:[0,1,0] op_sel_hi:[1,1,1]
  v_pk_mul_f32 v[168:169], v[96:97], v[96:97]
  v_pk_mul_f32 v[170:171], v[98:99], v[98:99]
  v_pk_mul_f32 v[172:173], v[100:101], v[100:101]
  v_pk_mul_f32 v[174:175], v[102:103], v[102:103]
  v_pk_mul_f32 v[176:177], v[104:105], v[104:105]
  v_pk_mul_f32 v[178:179], v[106:107], v[106:107]
  v_pk_mul_f32 v[180:181], v[108:109], v[108:109]
  v_pk_mul_f32 v[182:183], v[110:111], v[110:111]
  v_pk_fma_f32 v[168:169], v[168:169], v[42:43], v[42:43] op_sel:[0,1,0] op_sel_hi:[1,1,0]
  v_pk_fma_f32 v[170:171], v[170:171], v[42:43], v[42:43] op_sel:[0,1,0] op_sel_hi:[1,1,0]
  v_pk_fma_f32 v[172:173], v[172:173], v[42:43], v[42:43] op_sel:[0,1,0] op_sel_hi:[1,1,0]
  v_pk_fma_f32 v[174:175], v[174:175], v[42:43], v[42:43] op_sel:[0,1,0] op_sel_hi:[1,1,0]
  v_pk_fma_f32 v[176:177], v[176:177], v[42:43], v[42:43] op_sel:[0,1,0] op_sel_hi:[1,1,0]
  v_pk_fma_f32 v[178:179], v[178:179], v[42:43], v[42:43] op_sel:[0,1,0] op_sel_hi:[1,1,0]
  v_pk_fma_f32 v[180:181], v[180:181], v[42:43], v[42:43] op_sel:[0,1,0] op_sel_hi:[1,1,0]
  v_pk_fma_f32 v[182:183], v[182:183], v[42:43], v[42:43] op_sel:[0,1,0] op_sel_hi:[1,1,0]
  v_pk_mul_f32 v[168:169], v[168:169], v[96:97]
  v_pk_mul_f32 v[170:171], v[170:171], v[98:99]
  v_pk_mul_f32 v[172:173], v[172:173], v[100:101]
  v_pk_mul_f32 v[174:175], v[174:175], v[102:103]
  v_pk_mul_f32 v[176:177], v[176:177], v[104:105]
  v_pk_mul_f32 v[178:179], v[178:179], v[106:107]
  v_pk_mul_f32 v[180:181], v[180:181], v[108:109]
  v_pk_mul_f32 v[182:183], v[182:183], v[110:111]
  v_exp_f32 v184, v168
  v_exp_f32 v185, v169
  v_exp_f32 v186, v170
  v_exp_f32 v187, v171
  v_exp_f32 v188, v172
  v_exp_f32 v189, v173
  v_exp_f32 v190, v174
  v_exp_f32 v191, v175
  v_exp_f32 v192, v176
  v_exp_f32 v193, v177
  v_exp_f32 v194, v178
  v_exp_f32 v195, v179
  v_exp_f32 v196, v180
  v_exp_f32 v197, v181
  v_exp_f32 v198, v182
  v_exp_f32 v199, v183
  v_pk_add_f32 v[184:185], v[184:185], v[44:45]
  v_pk_add_f32 v[186:187], v[186:187], v[44:45]
  v_pk_add_f32 v[188:189], v[188:189], v[44:45]
  v_pk_add_f32 v[190:191], v[190:191], v[44:45]
  v_pk_add_f32 v[192:193], v[192:193], v[44:45]
  v_pk_add_f32 v[194:195], v[194:195], v[44:45]
  v_pk_add_f32 v[196:197], v[196:197], v[44:45]
  v_pk_add_f32 v[198:199], v[198:199], v[44:45]
  v_rcp_f32 v184, v184
  v_rcp_f32 v185, v185
  v_rcp_f32 v186, v186
  v_rcp_f32 v187, v187
  v_rcp_f32 v188, v188
  v_rcp_f32 v189, v189
  v_rcp_f32 v190, v190
  v_rcp_f32 v191, v191
  v_rcp_f32 v192, v192
  v_rcp_f32 v193, v193
  v_rcp_f32 v194, v194
  v_rcp_f32 v195, v195
  v_rcp_f32 v196, v196
  v_rcp_f32 v197, v197
  v_rcp_f32 v198, v198
  v_rcp_f32 v199, v199
  v_pk_mul_f32 v[96:97], v[96:97], v[184:185]
  v_pk_mul_f32 v[98:99], v[98:99], v[186:187]
  v_pk_mul_f32 v[100:101], v[100:101], v[188:189]
  v_pk_mul_f32 v[102:103], v[102:103], v[190:191]
  v_pk_mul_f32 v[104:105], v[104:105], v[192:193]
  v_pk_mul_f32 v[106:107], v[106:107], v[194:195]
  v_pk_mul_f32 v[108:109], v[108:109], v[196:197]
  v_pk_mul_f32 v[110:111], v[110:111], v[198:199]
  v_cvt_pk_bf16_f32 v96, v96, v97
  v_cvt_pk_bf16_f32 v97, v98, v99
  v_cvt_pk_bf16_f32 v98, v100, v101
  v_cvt_pk_bf16_f32 v99, v102, v103
  v_cvt_pk_bf16_f32 v100, v104, v105
  v_cvt_pk_bf16_f32 v101, v106, v107
  v_cvt_pk_bf16_f32 v102, v108, v109
  v_cvt_pk_bf16_f32 v103, v110, v111
  s_xor_b32 s32, s38, 1024
  s_add_u32 s32, s32, 0
  v_permlane32_swap_b32 v96, v98
  v_permlane32_swap_b32 v97, v99
  v_permlane32_swap_b32 v100, v102
  v_permlane32_swap_b32 v101, v103
  s_cmp_eq_u32 s46, 0
  s_cbranch_scc0 L_slow_15
  buffer_store_dwordx4 v[96:99], v46, s[12:15], s32 offen
  buffer_store_dwordx4 v[100:103], v46, s[12:15], s32 offen offset:512
L_back_15:
  v_pk_fma_f32 v[80:81], v[224:225], v[40:41], v[80:81] op_sel_hi:[1,0,1] neg_lo:[0,1,0] neg_hi:[0,1,0]
  v_pk_fma_f32 v[82:83], v[226:227], v[40:41], v[82:83] op_sel_hi:[1,0,1] neg_lo:[0,1,0] neg_hi:[0,1,0]
  v_pk_fma_f32 v[84:85], v[228:229], v[40:41], v[84:85] op_sel_hi:[1,0,1] neg_lo:[0,1,0] neg_hi:[0,1,0]
  v_pk_fma_f32 v[86:87], v[230:231], v[40:41], v[86:87] op_sel_hi:[1,0,1] neg_lo:[0,1,0] neg_hi:[0,1,0]
  v_pk_fma_f32 v[88:89], v[232:233], v[40:41], v[88:89] op_sel_hi:[1,0,1] neg_lo:[0,1,0] neg_hi:[0,1,0]
  v_pk_fma_f32 v[90:91], v[234:235], v[40:41], v[90:91] op_sel_hi:[1,0,1] neg_lo:[0,1,0] neg_hi:[0,1,0]
  v_pk_fma_f32 v[92:93], v[236:237], v[40:41], v[92:93] op_sel_hi:[1,0,1] neg_lo:[0,1,0] neg_hi:[0,1,0]
  v_pk_fma_f32 v[94:95], v[238:239], v[40:41], v[94:95] op_sel_hi:[1,0,1] neg_lo:[0,1,0] neg_hi:[0,1,0]
  v_pk_fma_f32 v[80:81], v[80:81], v[40:41], v[136:137] op_sel:[0,1,0] op_sel_hi:[1,1,1]
  v_pk_fma_f32 v[82:83], v[82:83], v[40:41], v[138:139] op_sel:[0,1,0] op_sel_hi:[1,1,1]
  v_pk_fma_f32 v[84:85], v[84:85], v[40:41], v[140:141] op_sel:[0,1,0] op_sel_hi:[1,1,1]
  v_pk_fma_f32 v[86:87], v[86:87], v[40:41], v[142:143] op_sel:[0,1,0] op_sel_hi:[1,1,1]
  v_pk_fma_f32 v[88:89], v[88:89], v[40:41], v[144:145] op_sel:[0,1,0] op_sel_hi:[1,1,1]
  v_pk_fma_f32 v[90:91], v[90:91], v[40:41], v[146:147] op_sel:[0,1,0] op_sel_hi:[1,1,1]
  v_pk_fma_f32 v[92:93], v[92:93], v[40:41], v[148:149] op_sel:[0,1,0] op_sel_hi:[1,1,1]
  v_pk_fma_f32 v[94:95], v[94:95], v[40:41], v[150:151] op_sel:[0,1,0] op_sel_hi:[1,1,1]
  v_pk_mul_f32 v[168:169], v[80:81], v[80:81]
  v_pk_mul_f32 v[170:171], v[82:83], v[82:83]
  v_pk_mul_f32 v[172:173], v[84:85], v[84:85]
  v_pk_mul_f32 v[174:175], v[86:87], v[86:87]
  v_pk_mul_f32 v[176:177], v[88:89], v[88:89]
  v_pk_mul_f32 v[178:179], v[90:91], v[90:91]
  v_pk_mul_f32 v[180:181], v[92:93], v[92:93]
  v_pk_mul_f32 v[182:183], v[94:95], v[94:95]
  v_pk_fma_f32 v[168:169], v[168:169], v[42:43], v[42:43] op_sel:[0,1,0] op_sel_hi:[1,1,0]
  v_pk_fma_f32 v[170:171], v[170:171], v[42:43], v[42:43] op_sel:[0,1,0] op_sel_hi:[1,1,0]
  v_pk_fma_f32 v[172:173], v[172:173], v[42:43], v[42:43] op_sel:[0,1,0] op_sel_hi:[1,1,0]
  v_pk_fma_f32 v[174:175], v[174:175], v[42:43], v[42:43] op_sel:[0,1,0] op_sel_hi:[1,1,0]
  v_pk_fma_f32 v[176:177], v[176:177], v[42:43], v[42:43] op_sel:[0,1,0] op_sel_hi:[1,1,0]
  v_pk_fma_f32 v[178:179], v[178:179], v[42:43], v[42:43] op_sel:[0,1,0] op_sel_hi:[1,1,0]
  v_pk_fma_f32 v[180:181], v[180:181], v[42:43], v[42:43] op_sel:[0,1,0] op_sel_hi:[1,1,0]
  v_pk_fma_f32 v[182:183], v[182:183], v[42:43], v[42:43] op_sel:[0,1,0] op_sel_hi:[1,1,0]
  v_pk_mul_f32 v[168:169], v[168:169], v[80:81]
  v_pk_mul_f32 v[170:171], v[170:171], v[82:83]
  v_pk_mul_f32 v[172:173], v[172:173], v[84:85]
  v_pk_mul_f32 v[174:175], v[174:175], v[86:87]
  v_pk_mul_f32 v[176:177], v[176:177], v[88:89]
  v_pk_mul_f32 v[178:179], v[178:179], v[90:91]
  v_pk_mul_f32 v[180:181], v[180:181], v[92:93]
  v_pk_mul_f32 v[182:183], v[182:183], v[94:95]
  v_exp_f32 v184, v168
  v_exp_f32 v185, v169
  v_exp_f32 v186, v170
  v_exp_f32 v187, v171
  v_exp_f32 v188, v172
  v_exp_f32 v189, v173
  v_exp_f32 v190, v174
  v_exp_f32 v191, v175
  v_exp_f32 v192, v176
  v_exp_f32 v193, v177
  v_exp_f32 v194, v178
  v_exp_f32 v195, v179
  v_exp_f32 v196, v180
  v_exp_f32 v197, v181
  v_exp_f32 v198, v182
  v_exp_f32 v199, v183
  v_pk_add_f32 v[184:185], v[184:185], v[44:45]
  v_pk_add_f32 v[186:187], v[186:187], v[44:45]
  v_pk_add_f32 v[188:189], v[188:189], v[44:45]
  v_pk_add_f32 v[190:191], v[190:191], v[44:45]
  v_pk_add_f32 v[192:193], v[192:193], v[44:45]
  v_pk_add_f32 v[194:195], v[194:195], v[44:45]
  v_pk_add_f32 v[196:197], v[196:197], v[44:45]
  v_pk_add_f32 v[198:199], v[198:199], v[44:45]
  v_rcp_f32 v184, v184
  v_rcp_f32 v185, v185
  v_rcp_f32 v186, v186
  v_rcp_f32 v187, v187
  v_rcp_f32 v188, v188
  v_rcp_f32 v189, v189
  v_rcp_f32 v190, v190
  v_rcp_f32 v191, v191
  v_rcp_f32 v192, v192
  v_rcp_f32 v193, v193
  v_rcp_f32 v194, v194
  v_rcp_f32 v195, v195
  v_rcp_f32 v196, v196
  v_rcp_f32 v197, v197
  v_rcp_f32 v198, v198
  v_rcp_f32 v199, v199
  v_pk_mul_f32 v[80:81], v[80:81], v[184:185]
  v_pk_mul_f32 v[82:83], v[82:83], v[186:187]
  v_pk_mul_f32 v[84:85], v[84:85], v[188:189]
  v_pk_mul_f32 v[86:87], v[86:87], v[190:191]
  v_pk_mul_f32 v[88:89], v[88:89], v[192:193]
  v_pk_mul_f32 v[90:91], v[90:91], v[194:195]
  v_pk_mul_f32 v[92:93], v[92:93], v[196:197]
  v_pk_mul_f32 v[94:95], v[94:95], v[198:199]
  v_cvt_pk_bf16_f32 v80, v80, v81
  v_cvt_pk_bf16_f32 v81, v82, v83
  v_cvt_pk_bf16_f32 v82, v84, v85
  v_cvt_pk_bf16_f32 v83, v86, v87
  v_cvt_pk_bf16_f32 v84, v88, v89
  v_cvt_pk_bf16_f32 v85, v90, v91
  v_cvt_pk_bf16_f32 v86, v92, v93
  v_cvt_pk_bf16_f32 v87, v94, v95
  s_xor_b32 s32, s38, 0
  s_add_u32 s32, s32, 917504
  v_permlane32_swap_b32 v80, v82
  v_permlane32_swap_b32 v81, v83
  v_permlane32_swap_b32 v84, v86
  v_permlane32_swap_b32 v85, v87
  s_cmp_eq_u32 s46, 0
  s_cbranch_scc0 L_slow_16
  buffer_store_dwordx4 v[80:83], v46, s[12:15], s32 offen
  buffer_store_dwordx4 v[84:87], v46, s[12:15], s32 offen offset:512
L_back_16:
  v_pk_fma_f32 v[112:113], v[240:241], v[40:41], v[112:113] op_sel_hi:[1,0,1] neg_lo:[0,1,0] neg_hi:[0,1,0]
  v_pk_fma_f32 v[114:115], v[242:243], v[40:41], v[114:115] op_sel_hi:[1,0,1] neg_lo:[0,1,0] neg_hi:[0,1,0]
  v_pk_fma_f32 v[116:117], v[244:245], v[40:41], v[116:117] op_sel_hi:[1,0,1] neg_lo:[0,1,0] neg_hi:[0,1,0]
  v_pk_fma_f32 v[118:119], v[246:247], v[40:41], v[118:119] op_sel_hi:[1,0,1] neg_lo:[0,1,0] neg_hi:[0,1,0]
  v_pk_fma_f32 v[120:121], v[248:249], v[40:41], v[120:121] op_sel_hi:[1,0,1] neg_lo:[0,1,0] neg_hi:[0,1,0]
  v_pk_fma_f32 v[122:123], v[250:251], v[40:41], v[122:123] op_sel_hi:[1,0,1] neg_lo:[0,1,0] neg_hi:[0,1,0]
  v_pk_fma_f32 v[124:125], v[252:253], v[40:41], v[124:125] op_sel_hi:[1,0,1] neg_lo:[0,1,0] neg_hi:[0,1,0]
  v_pk_fma_f32 v[126:127], v[254:255], v[40:41], v[126:127] op_sel_hi:[1,0,1] neg_lo:[0,1,0] neg_hi:[0,1,0]
  v_pk_fma_f32 v[112:113], v[112:113], v[40:41], v[152:153] op_sel:[0,1,0] op_sel_hi:[1,1,1]
  v_pk_fma_f32 v[114:115], v[114:115], v[40:41], v[154:155] op_sel:[0,1,0] op_sel_hi:[1,1,1]
  v_pk_fma_f32 v[116:117], v[116:117], v[40:41], v[156:157] op_sel:[0,1,0] op_sel_hi:[1,1,1]
  v_pk_fma_f32 v[118:119], v[118:119], v[40:41], v[158:159] op_sel:[0,1,0] op_sel_hi:[1,1,1]
  v_pk_fma_f32 v[120:121], v[120:121], v[40:41], v[160:161] op_sel:[0,1,0] op_sel_hi:[1,1,1]
  v_pk_fma_f32 v[122:123], v[122:123], v[40:41], v[162:163] op_sel:[0,1,0] op_sel_hi:[1,1,1]
  v_pk_fma_f32 v[124:125], v[124:125], v[40:41], v[164:165] op_sel:[0,1,0] op_sel_hi:[1,1,1]
  v_pk_fma_f32 v[126:127], v[126:127], v[40:41], v[166:167] op_sel:[0,1,0] op_sel_hi:[1,1,1]
  v_pk_mul_f32 v[168:169], v[112:113], v[112:113]
  v_pk_mul_f32 v[170:171], v[114:115], v[114:115]
  v_pk_mul_f32 v[172:173], v[116:117], v[116:117]
  v_pk_mul_f32 v[174:175], v[118:119], v[118:119]
  v_pk_mul_f32 v[176:177], v[120:121], v[120:121]
  v_pk_mul_f32 v[178:179], v[122:123], v[122:123]
  v_pk_mul_f32 v[180:181], v[124:125], v[124:125]
  v_pk_mul_f32 v[182:183], v[126:127], v[126:127]
  v_pk_fma_f32 v[168:169], v[168:169], v[42:43], v[42:43] op_sel:[0,1,0] op_sel_hi:[1,1,0]
  v_pk_fma_f32 v[170:171], v[170:171], v[42:43], v[42:43] op_sel:[0,1,0] op_sel_hi:[1,1,0]
  v_pk_fma_f32 v[172:173], v[172:173], v[42:43], v[42:43] op_sel:[0,1,0] op_sel_hi:[1,1,0]
  v_pk_fma_f32 v[174:175], v[174:175], v[42:43], v[42:43] op_sel:[0,1,0] op_sel_hi:[1,1,0]
  v_pk_fma_f32 v[176:177], v[176:177], v[42:43], v[42:43] op_sel:[0,1,0] op_sel_hi:[1,1,0]
  v_pk_fma_f32 v[178:179], v[178:179], v[42:43], v[42:43] op_sel:[0,1,0] op_sel_hi:[1,1,0]
  v_pk_fma_f32 v[180:181], v[180:181], v[42:43], v[42:43] op_sel:[0,1,0] op_sel_hi:[1,1,0]
  v_pk_fma_f32 v[182:183], v[182:183], v[42:43], v[42:43] op_sel:[0,1,0] op_sel_hi:[1,1,0]
  v_pk_mul_f32 v[168:169], v[168:169], v[112:113]
  v_pk_mul_f32 v[170:171], v[170:171], v[114:115]
  v_pk_mul_f32 v[172:173], v[172:173], v[116:117]
  v_pk_mul_f32 v[174:175], v[174:175], v[118:119]
  v_pk_mul_f32 v[176:177], v[176:177], v[120:121]
  v_pk_mul_f32 v[178:179], v[178:179], v[122:123]
  v_pk_mul_f32 v[180:181], v[180:181], v[124:125]
  v_pk_mul_f32 v[182:183], v[182:183], v[126:127]
  v_exp_f32 v184, v168
  v_exp_f32 v185, v169
  v_exp_f32 v186, v170
  v_exp_f32 v187, v171
  v_exp_f32 v188, v172
  v_exp_f32 v189, v173
  v_exp_f32 v190, v174
  v_exp_f32 v191, v175
  v_exp_f32 v192, v176
  v_exp_f32 v193, v177
  v_exp_f32 v194, v178
  v_exp_f32 v195, v179
  v_exp_f32 v196, v180
  v_exp_f32 v197, v181
  v_exp_f32 v198, v182
  v_exp_f32 v199, v183
  v_pk_add_f32 v[184:185], v[184:185], v[44:45]
  v_pk_add_f32 v[186:187], v[186:187], v[44:45]
  v_pk_add_f32 v[188:189], v[188:189], v[44:45]
  v_pk_add_f32 v[190:191], v[190:191], v[44:45]
  v_pk_add_f32 v[192:193], v[192:193], v[44:45]
  v_pk_add_f32 v[194:195], v[194:195], v[44:45]
  v_pk_add_f32 v[196:197], v[196:197], v[44:45]
  v_pk_add_f32 v[198:199], v[198:199], v[44:45]
  v_rcp_f32 v184, v184
  v_rcp_f32 v185, v185
  v_rcp_f32 v186, v186
  v_rcp_f32 v187, v187
  v_rcp_f32 v188, v188
  v_rcp_f32 v189, v189
  v_rcp_f32 v190, v190
  v_rcp_f32 v191, v191
  v_rcp_f32 v192, v192
  v_rcp_f32 v193, v193
  v_rcp_f32 v194, v194
  v_rcp_f32 v195, v195
  v_rcp_f32 v196, v196
  v_rcp_f32 v197, v197
  v_rcp_f32 v198, v198
  v_rcp_f32 v199, v199
  v_pk_mul_f32 v[112:113], v[112:113], v[184:185]
  v_pk_mul_f32 v[114:115], v[114:115], v[186:187]
  v_pk_mul_f32 v[116:117], v[116:117], v[188:189]
  v_pk_mul_f32 v[118:119], v[118:119], v[190:191]
  v_pk_mul_f32 v[120:121], v[120:121], v[192:193]
  v_pk_mul_f32 v[122:123], v[122:123], v[194:195]
  v_pk_mul_f32 v[124:125], v[124:125], v[196:197]
  v_pk_mul_f32 v[126:127], v[126:127], v[198:199]
  v_cvt_pk_bf16_f32 v112, v112, v113
  v_cvt_pk_bf16_f32 v113, v114, v115
  v_cvt_pk_bf16_f32 v114, v116, v117
  v_cvt_pk_bf16_f32 v115, v118, v119
  v_cvt_pk_bf16_f32 v116, v120, v121
  v_cvt_pk_bf16_f32 v117, v122, v123
  v_cvt_pk_bf16_f32 v118, v124, v125
  v_cvt_pk_bf16_f32 v119, v126, v127
  s_xor_b32 s32, s38, 1024
  s_add_u32 s32, s32, 917504
  v_permlane32_swap_b32 v112, v114
  v_permlane32_swap_b32 v113, v115
  v_permlane32_swap_b32 v116, v118
  v_permlane32_swap_b32 v117, v119
  s_cmp_eq_u32 s46, 0
  s_cbranch_scc0 L_slow_17
  buffer_store_dwordx4 v[112:115], v46, s[12:15], s32 offen
  buffer_store_dwordx4 v[116:119], v46, s[12:15], s32 offen offset:512
L_back_17:
  s_branch L_c4_tail
L_c4_idle:
L_c4_tail:

  s_mul_i32 s30, s63, 43
  s_lshr_b32 s21, s30, 7
  s_mul_i32 s30, s21, 3
  s_sub_u32 s30, s63, s30
  s_mul_i32 s30, s30, 6
  s_lshl_b32 s20, s62, 4
  s_add_u32 s39, s20, 16
  s_add_u32 s20, s20, s30
  s_cmp_ge_u32 s63, 30
  s_cselect_b32 s21, 15, s21

  v_and_b32 v2, 63, v0
  v_and_b32 v3, 15, v2
  v_lshrrev_b32 v4, 4, v2
  s_and_b32 s23, s22, 1
  s_lshr_b32 s24, s22, 1
  s_lshl_b32 s30, s21, 3
  s_lshl_b32 s32, s24, 2
  s_add_u32 s30, s30, s32
  s_mul_i32 s32, s23, 3
  s_add_u32 s31, s20, s32
  v_and_b32 v5, 1, v4
  v_lshrrev_b32 v6, 1, v4
  v_lshl_add_u32 v5, v5, 1, v6
  s_mul_i32 s32, s31, 20480
  s_lshl_b32 s33, s30, 8
  s_add_u32 s32, s32, s33
  v_lshlrev_b32 v23, 8, v5
  v_lshl_add_u32 v23, v3, 4, v23
  v_add_u32 v23, s32, v23

  s_lshl_b32 s32, s31, 4
  v_add_u32 v7, s32, v3
  v_mul_u32_u24 v7, 1280, v7
  v_add_u32 v5, s30, v5
  v_lshl_add_u32 v26, v5, 4, v7
  s_lshl_b32 s33, s21, 7
  s_lshl_b32 s32, s24, 6
  s_add_u32 s33, s33, s32
  v_lshl_add_u32 v24, v4, 3, s33

  s_mul_i32 s30, s23, 6144
  v_lshlrev_b32 v6, 4, v2
  v_add_u32 v10, s30, v6
  v_lshrrev_b32 v5, 2, v3
  v_and_b32 v6, 3, v3
  v_lshrrev_b32 v7, 1, v5
  v_and_b32 v9, 1, v4
  v_lshl_or_b32 v7, v9, 1, v7
  v_lshl_add_u32 v8, v4, 3, v5
  v_lshlrev_b32 v8, 7, v8
  v_lshl_add_u32 v8, v6, 3, v8
  s_lshl_b32 s30, s24, 1

  s_add_u32 s32, s30, 0
  v_xor_b32 v9, s32, v7
  v_lshl_add_u32 v12, v9, 5, v8

  s_add_u32 s32, s30, 1
  v_xor_b32 v9, s32, v7
  v_lshl_add_u32 v13, v9, 5, v8

  s_waitcnt vmcnt(0) lgkmcnt(0)
  s_barrier
  s_cmp_eq_u32 s22, 0
  s_cbranch_scc0 L_c4_nosig

  s_mul_i32 s3, s96, 6
  s_add_u32 s3, s3, 4
  s_lshl_b32 s3, s3, 3
  s_add_u32 s3, s3, s62
  s_lshl_b32 s3, s3, 7
  s_add_u32 s3, s3, 0x07000000

  s_lshl_b32 s30, s63, 2
  s_add_u32 s30, s30, s3
  v_mov_b32 v6, s30
  v_mov_b32 v7, s101
  s_mov_b64 exec, 1

  s_cmp_eq_u32 s46, 0
  s_cbranch_scc0 L_c4_sigg
  global_store_dword v6, v7, s[60:61]
  s_branch L_c4_sigd
L_c4_sigg:
  global_store_dword v6, v7, s[60:61] sc1
L_c4_sigd:

  s_mov_b64 exec, -1
L_c4_nosig:
  s_cmp_eq_u32 s22, 0
  s_cbranch_scc0 L_c4_nopoll
  s_cmp_lg_u32 s97, 0
  s_cbranch_scc1 L_c4_nopoll

  s_mul_i32 s3, s96, 6
  s_add_u32 s3, s3, 4
  s_lshl_b32 s3, s3, 3
  s_add_u32 s3, s3, s62
  s_lshl_b32 s3, s3, 7
  s_add_u32 s3, s3, 0x07000000

  v_and_b32 v6, 63, v0
  v_lshl_add_u32 v6, v6, 2, s3
  s_mov_b32 s3, 400000
  s_mov_b32 exec_lo, 0x0fffffff
  s_mov_b32 exec_hi, 0
L_c4_poll:
  global_load_dword v7, v6, s[60:61] sc1
  s_waitcnt vmcnt(0)
  v_cmp_ne_u32 vcc, s101, v7
  s_cbranch_vccz L_c4_ok
  s_sub_u32 s3, s3, 1
  s_cmp_eq_u32 s3, 0
  s_cbranch_scc0 L_c4_poll
  s_mov_b32 s97, 1
L_c4_ok:
  s_mov_b64 exec, -1
L_c4_nopoll:

  s_cmp_eq_u32 s21, 15
  s_cbranch_scc1 L_ce_11
  s_add_u32 s12, s60, 0x00b00000
  s_addc_u32 s13, s61, 0
  s_mul_i32 s14, s39, 20480
  s_mov_b32 s15, 0x00020000
  s_mov_b32 s33, 0
  buffer_load_dwordx4 v[176:179], v23, s[12:15], s33 offen sc1
  s_mov_b32 s33, 20480
  buffer_load_dwordx4 v[180:183], v23, s[12:15], s33 offen sc1
  s_mov_b32 s33, 40960
  buffer_load_dwordx4 v[184:187], v23, s[12:15], s33 offen sc1
  s_add_u32 s16, s54, 0x00000000
  s_addc_u32 s17, s55, 0
  s_mov_b32 s18, 0x00000500
  s_mov_b32 s19, 0x00020000
  buffer_load_dwordx2 v[188:189], v24, s[16:19], 0 offen offset:0
  buffer_load_dwordx2 v[190:191], v24, s[16:19], 0 offen offset:32
  s_add_u32 s16, s60, 0x00e00000
  s_addc_u32 s17, s61, 0
  s_mov_b32 s18, 0x00050000
  s_mov_b32 s19, 0x00020000
  s_cmp_eq_u32 s96, 1
  s_cbranch_scc0 L_cef_12
  s_add_u32 s12, s56, 0x00000000
  s_addc_u32 s13, s57, 0
  s_mul_i32 s14, s39, 20480
  s_mov_b32 s15, 0x00020000
L_cef_12:

  s_mul_i32 s31, s23, 3
  s_add_u32 s31, s31, s20
  s_lshl_b32 s30, s21, 1
  s_add_u32 s30, s30, s24
  s_lshl_b32 s30, s30, 14
  v_and_b32 v5, 1, v4
  v_add_u32 v5, s31, v5
  v_lshl_add_u32 v6, v5, 4, v3
  v_lshlrev_b32 v6, 2, v6
  v_lshrrev_b32 v7, 1, v4
  v_lshl_add_u32 v6, v7, 13, v6
  v_add_u32 v27, s30, v6
  v_cmp_gt_u32 s[36:37], s39, v5

L_ce_11:
  s_barrier

  s_cmp_eq_u32 s21, 15
  s_cbranch_scc0 L_c5_act
  s_cmp_eq_u32 s96, 1
  s_cbranch_scc1 L_end

  s_branch L_c5_tail
L_c5_act:

  s_mul_i32 s31, s23, 3
  s_add_u32 s31, s31, s20
  s_mov_b32 s26, 0
  s_mov_b32 s27, 65792

  v_add_u32 v18, 65792, v12
  v_add_u32 v19, 65792, v13
  v_add_u32 v20, 131328, v12
  v_add_u32 v21, 131328, v13
  s_barrier
  ds_read_b64_tr_b16 v[96:97], v18 offset:0
  ds_read_b64_tr_b16 v[98:99], v18 offset:512
  ds_read_b64_tr_b16 v[100:101], v19 offset:0
  ds_read_b64_tr_b16 v[102:103], v19 offset:512
  ds_read_b128 v[104:107], v10 offset:0
  ds_read_b128 v[108:111], v10 offset:2048
  ds_read_b128 v[112:115], v10 offset:4096
  ds_read_b64_tr_b16 v[116:117], v18 offset:4096
  ds_read_b64_tr_b16 v[118:119], v18 offset:4608
  ds_read_b64_tr_b16 v[120:121], v19 offset:4096
  ds_read_b64_tr_b16 v[122:123], v19 offset:4608
  ds_read_b128 v[124:127], v10 offset:1024
  ds_read_b128 v[128:131], v10 offset:3072
  ds_read_b128 v[132:135], v10 offset:5120
  s_barrier
  ds_read_b64_tr_b16 v[136:137], v18 offset:8192
  ds_read_b64_tr_b16 v[138:139], v18 offset:8704
  ds_read_b64_tr_b16 v[140:141], v19 offset:8192
  s_waitcnt lgkmcnt(10)
  v_mfma_f32_16x16x32_bf16 v[64:67], v[96:99], v[104:107], 0
  ds_read_b64_tr_b16 v[142:143], v19 offset:8704
  v_mfma_f32_16x16x32_bf16 v[68:71], v[96:99], v[108:111], 0
  ds_read_b128 v[144:147], v10 offset:12288
  v_mfma_f32_16x16x32_bf16 v[72:75], v[96:99], v[112:115], 0
  ds_read_b128 v[148:151], v10 offset:14336
  v_mfma_f32_16x16x32_bf16 v[76:79], v[100:103], v[104:107], 0
  ds_read_b128 v[152:155], v10 offset:16384
  v_mfma_f32_16x16x32_bf16 v[80:83], v[100:103], v[108:111], 0
  ds_read_b64_tr_b16 v[156:157], v18 offset:12288
  v_mfma_f32_16x16x32_bf16 v[84:87], v[100:103], v[112:115], 0
  ds_read_b64_tr_b16 v[158:159], v18 offset:12800
  s_waitcnt lgkmcnt(9)
  v_mfma_f32_16x16x32_bf16 v[64:67], v[116:119], v[124:127], v[64:67]
  ds_read_b64_tr_b16 v[160:161], v19 offset:12288
  v_mfma_f32_16x16x32_bf16 v[68:71], v[116:119], v[128:131], v[68:71]
  ds_read_b64_tr_b16 v[162:163], v19 offset:12800
  v_mfma_f32_16x16x32_bf16 v[72:75], v[116:119], v[132:135], v[72:75]
  ds_read_b128 v[164:167], v10 offset:13312
  v_mfma_f32_16x16x32_bf16 v[76:79], v[120:123], v[124:127], v[76:79]
  ds_read_b128 v[168:171], v10 offset:15360
  v_mfma_f32_16x16x32_bf16 v[80:83], v[120:123], v[128:131], v[80:83]
  ds_read_b128 v[172:175], v10 offset:17408
  v_mfma_f32_16x16x32_bf16 v[84:87], v[120:123], v[132:135], v[84:87]
  s_waitcnt vmcnt(0)
  v_permlane16_swap_b32 v176, v178
  v_permlane16_swap_b32 v177, v179
  v_permlane16_swap_b32 v180, v182
  v_permlane16_swap_b32 v181, v183
  v_permlane16_swap_b32 v184, v186
  v_permlane16_swap_b32 v185, v187
  v_lshlrev_b32 v216, 16, v188
  v_and_b32 v217, 0xffff0000, v188
  v_lshlrev_b32 v218, 16, v189
  v_and_b32 v219, 0xffff0000, v189
  v_lshlrev_b32 v220, 16, v190
  v_and_b32 v221, 0xffff0000, v190
  v_lshlrev_b32 v222, 16, v191
  v_and_b32 v223, 0xffff0000, v191
  v_lshlrev_b32 v192, 16, v176
  v_and_b32 v193, 0xffff0000, v176
  v_lshlrev_b32 v194, 16, v177
  v_and_b32 v195, 0xffff0000, v177
  v_lshlrev_b32 v196, 16, v180
  v_and_b32 v197, 0xffff0000, v180
  v_lshlrev_b32 v198, 16, v181
  v_and_b32 v199, 0xffff0000, v181
  v_lshlrev_b32 v200, 16, v184
  v_and_b32 v201, 0xffff0000, v184
  v_lshlrev_b32 v202, 16, v185
  v_and_b32 v203, 0xffff0000, v185
  v_lshlrev_b32 v204, 16, v178
  v_and_b32 v205, 0xffff0000, v178
  v_lshlrev_b32 v206, 16, v179
  v_and_b32 v207, 0xffff0000, v179
  v_lshlrev_b32 v208, 16, v182
  v_and_b32 v209, 0xffff0000, v182
  v_lshlrev_b32 v210, 16, v183
  v_and_b32 v211, 0xffff0000, v183
  v_lshlrev_b32 v212, 16, v186
  v_and_b32 v213, 0xffff0000, v186
  v_lshlrev_b32 v214, 16, v187
  v_and_b32 v215, 0xffff0000, v187
  v_pk_add_f32 v[192:193], v[192:193], v[216:217]
  v_pk_add_f32 v[194:195], v[194:195], v[218:219]
  v_pk_add_f32 v[196:197], v[196:197], v[216:217]
  v_pk_add_f32 v[198:199], v[198:199], v[218:219]
  v_pk_add_f32 v[200:201], v[200:201], v[216:217]
  v_pk_add_f32 v[202:203], v[202:203], v[218:219]
  v_pk_add_f32 v[204:205], v[204:205], v[220:221]
  v_pk_add_f32 v[206:207], v[206:207], v[222:223]
  v_pk_add_f32 v[208:209], v[208:209], v[220:221]
  v_pk_add_f32 v[210:211], v[210:211], v[222:223]
  v_pk_add_f32 v[212:213], v[212:213], v[220:221]
  v_pk_add_f32 v[214:215], v[214:215], v[222:223]
  s_barrier
  ds_read_b64_tr_b16 v[96:97], v18 offset:16384
  ds_read_b64_tr_b16 v[98:99], v18 offset:16896
  ds_read_b64_tr_b16 v[100:101], v19 offset:16384
  s_waitcnt lgkmcnt(10)
  v_mfma_f32_16x16x32_bf16 v[64:67], v[136:139], v[144:147], v[64:67]
  ds_read_b64_tr_b16 v[102:103], v19 offset:16896
  v_mfma_f32_16x16x32_bf16 v[68:71], v[136:139], v[148:151], v[68:71]
  ds_read_b128 v[104:107], v10 offset:24576
  v_mfma_f32_16x16x32_bf16 v[72:75], v[136:139], v[152:155], v[72:75]
  ds_read_b128 v[108:111], v10 offset:26624
  v_mfma_f32_16x16x32_bf16 v[76:79], v[140:143], v[144:147], v[76:79]
  ds_read_b128 v[112:115], v10 offset:28672
  v_mfma_f32_16x16x32_bf16 v[80:83], v[140:143], v[148:151], v[80:83]
  ds_read_b64_tr_b16 v[116:117], v18 offset:20480
  v_mfma_f32_16x16x32_bf16 v[84:87], v[140:143], v[152:155], v[84:87]
  ds_read_b64_tr_b16 v[118:119], v18 offset:20992
  s_waitcnt lgkmcnt(9)
  v_mfma_f32_16x16x32_bf16 v[64:67], v[156:159], v[164:167], v[64:67]
  ds_read_b64_tr_b16 v[120:121], v19 offset:20480
  v_mfma_f32_16x16x32_bf16 v[68:71], v[156:159], v[168:171], v[68:71]
  ds_read_b64_tr_b16 v[122:123], v19 offset:20992
  v_mfma_f32_16x16x32_bf16 v[72:75], v[156:159], v[172:175], v[72:75]
  ds_read_b128 v[124:127], v10 offset:25600
  v_mfma_f32_16x16x32_bf16 v[76:79], v[160:163], v[164:167], v[76:79]
  ds_read_b128 v[128:131], v10 offset:27648
  v_mfma_f32_16x16x32_bf16 v[80:83], v[160:163], v[168:171], v[80:83]
  ds_read_b128 v[132:135], v10 offset:29696
  v_mfma_f32_16x16x32_bf16 v[84:87], v[160:163], v[172:175], v[84:87]
  s_barrier
  ds_read_b64_tr_b16 v[136:137], v18 offset:24576
  ds_read_b64_tr_b16 v[138:139], v18 offset:25088
  ds_read_b64_tr_b16 v[140:141], v19 offset:24576
  s_waitcnt lgkmcnt(10)
  v_mfma_f32_16x16x32_bf16 v[64:67], v[96:99], v[104:107], v[64:67]
  ds_read_b64_tr_b16 v[142:143], v19 offset:25088
  v_mfma_f32_16x16x32_bf16 v[68:71], v[96:99], v[108:111], v[68:71]
  ds_read_b128 v[144:147], v10 offset:36864
  v_mfma_f32_16x16x32_bf16 v[72:75], v[96:99], v[112:115], v[72:75]
  ds_read_b128 v[148:151], v10 offset:38912
  v_mfma_f32_16x16x32_bf16 v[76:79], v[100:103], v[104:107], v[76:79]
  ds_read_b128 v[152:155], v10 offset:40960
  v_mfma_f32_16x16x32_bf16 v[80:83], v[100:103], v[108:111], v[80:83]
  ds_read_b64_tr_b16 v[156:157], v18 offset:28672
  v_mfma_f32_16x16x32_bf16 v[84:87], v[100:103], v[112:115], v[84:87]
  ds_read_b64_tr_b16 v[158:159], v18 offset:29184
  s_waitcnt lgkmcnt(9)
  v_mfma_f32_16x16x32_bf16 v[64:67], v[116:119], v[124:127], v[64:67]
  ds_read_b64_tr_b16 v[160:161], v19 offset:28672
  v_mfma_f32_16x16x32_bf16 v[68:71], v[116:119], v[128:131], v[68:71]
  ds_read_b64_tr_b16 v[162:163], v19 offset:29184
  v_mfma_f32_16x16x32_bf16 v[72:75], v[116:119], v[132:135], v[72:75]
  ds_read_b128 v[164:167], v10 offset:37888
  v_mfma_f32_16x16x32_bf16 v[76:79], v[120:123], v[124:127], v[76:79]
  ds_read_b128 v[168:171], v10 offset:39936
  v_mfma_f32_16x16x32_bf16 v[80:83], v[120:123], v[128:131], v[80:83]
  ds_read_b128 v[172:175], v10 offset:41984
  v_mfma_f32_16x16x32_bf16 v[84:87], v[120:123], v[132:135], v[84:87]
  s_barrier
  ds_read_b64_tr_b16 v[96:97], v18 offset:32768
  ds_read_b64_tr_b16 v[98:99], v18 offset:33280
  ds_read_b64_tr_b16 v[100:101], v19 offset:32768
  s_waitcnt lgkmcnt(10)
  v_mfma_f32_16x16x32_bf16 v[64:67], v[136:139], v[144:147], v[64:67]
  ds_read_b64_tr_b16 v[102:103], v19 offset:33280
  v_mfma_f32_16x16x32_bf16 v[68:71], v[136:139], v[148:151], v[68:71]
  ds_read_b128 v[104:107], v10 offset:49152
  v_mfma_f32_16x16x32_bf16 v[72:75], v[136:139], v[152:155], v[72:75]
  ds_read_b128 v[108:111], v10 offset:51200
  v_mfma_f32_16x16x32_bf16 v[76:79], v[140:143], v[144:147], v[76:79]
  ds_read_b128 v[112:115], v10 offset:53248
  v_mfma_f32_16x16x32_bf16 v[80:83], v[140:143], v[148:151], v[80:83]
  ds_read_b64_tr_b16 v[116:117], v18 offset:36864
  v_mfma_f32_16x16x32_bf16 v[84:87], v[140:143], v[152:155], v[84:87]
  ds_read_b64_tr_b16 v[118:119], v18 offset:37376
  s_waitcnt lgkmcnt(9)
  v_mfma_f32_16x16x32_bf16 v[64:67], v[156:159], v[164:167], v[64:67]
  ds_read_b64_tr_b16 v[120:121], v19 offset:36864
  v_mfma_f32_16x16x32_bf16 v[68:71], v[156:159], v[168:171], v[68:71]
  ds_read_b64_tr_b16 v[122:123], v19 offset:37376
  v_mfma_f32_16x16x32_bf16 v[72:75], v[156:159], v[172:175], v[72:75]
  ds_read_b128 v[124:127], v10 offset:50176
  v_mfma_f32_16x16x32_bf16 v[76:79], v[160:163], v[164:167], v[76:79]
  ds_read_b128 v[128:131], v10 offset:52224
  v_mfma_f32_16x16x32_bf16 v[80:83], v[160:163], v[168:171], v[80:83]
  ds_read_b128 v[132:135], v10 offset:54272
  v_mfma_f32_16x16x32_bf16 v[84:87], v[160:163], v[172:175], v[84:87]
  s_barrier
  ds_read_b64_tr_b16 v[136:137], v18 offset:40960
  ds_read_b64_tr_b16 v[138:139], v18 offset:41472
  ds_read_b64_tr_b16 v[140:141], v19 offset:40960
  s_waitcnt lgkmcnt(10)
  v_mfma_f32_16x16x32_bf16 v[64:67], v[96:99], v[104:107], v[64:67]
  ds_read_b64_tr_b16 v[142:143], v19 offset:41472
  v_mfma_f32_16x16x32_bf16 v[68:71], v[96:99], v[108:111], v[68:71]
  ds_read_b128 v[144:147], v10 offset:0
  v_mfma_f32_16x16x32_bf16 v[72:75], v[96:99], v[112:115], v[72:75]
  ds_read_b128 v[148:151], v10 offset:2048
  v_mfma_f32_16x16x32_bf16 v[76:79], v[100:103], v[104:107], v[76:79]
  ds_read_b128 v[152:155], v10 offset:4096
  v_mfma_f32_16x16x32_bf16 v[80:83], v[100:103], v[108:111], v[80:83]
  ds_read_b64_tr_b16 v[156:157], v18 offset:45056
  v_mfma_f32_16x16x32_bf16 v[84:87], v[100:103], v[112:115], v[84:87]
  ds_read_b64_tr_b16 v[158:159], v18 offset:45568
  s_waitcnt lgkmcnt(9)
  v_mfma_f32_16x16x32_bf16 v[64:67], v[116:119], v[124:127], v[64:67]
  ds_read_b64_tr_b16 v[160:161], v19 offset:45056
  v_mfma_f32_16x16x32_bf16 v[68:71], v[116:119], v[128:131], v[68:71]
  ds_read_b64_tr_b16 v[162:163], v19 offset:45568
  v_mfma_f32_16x16x32_bf16 v[72:75], v[116:119], v[132:135], v[72:75]
  ds_read_b128 v[164:167], v10 offset:1024
  v_mfma_f32_16x16x32_bf16 v[76:79], v[120:123], v[124:127], v[76:79]
  ds_read_b128 v[168:171], v10 offset:3072
  v_mfma_f32_16x16x32_bf16 v[80:83], v[120:123], v[128:131], v[80:83]
  ds_read_b128 v[172:175], v10 offset:5120
  v_mfma_f32_16x16x32_bf16 v[84:87], v[120:123], v[132:135], v[84:87]
  s_barrier
  ds_read_b64_tr_b16 v[96:97], v18 offset:49152
  ds_read_b64_tr_b16 v[98:99], v18 offset:49664
  ds_read_b64_tr_b16 v[100:101], v19 offset:49152
  s_waitcnt lgkmcnt(10)
  v_mfma_f32_16x16x32_bf16 v[64:67], v[136:139], v[144:147], v[64:67]
  ds_read_b64_tr_b16 v[102:103], v19 offset:49664
  v_mfma_f32_16x16x32_bf16 v[68:71], v[136:139], v[148:151], v[68:71]
  ds_read_b128 v[104:107], v10 offset:12288
  v_mfma_f32_16x16x32_bf16 v[72:75], v[136:139], v[152:155], v[72:75]
  ds_read_b128 v[108:111], v10 offset:14336
  v_mfma_f32_16x16x32_bf16 v[76:79], v[140:143], v[144:147], v[76:79]
  ds_read_b128 v[112:115], v10 offset:16384
  v_mfma_f32_16x16x32_bf16 v[80:83], v[140:143], v[148:151], v[80:83]
  ds_read_b64_tr_b16 v[116:117], v18 offset:53248
  v_mfma_f32_16x16x32_bf16 v[84:87], v[140:143], v[152:155], v[84:87]
  ds_read_b64_tr_b16 v[118:119], v18 offset:53760
  s_waitcnt lgkmcnt(9)
  v_mfma_f32_16x16x32_bf16 v[64:67], v[156:159], v[164:167], v[64:67]
  ds_read_b64_tr_b16 v[120:121], v19 offset:53248
  v_mfma_f32_16x16x32_bf16 v[68:71], v[156:159], v[168:171], v[68:71]
  ds_read_b64_tr_b16 v[122:123], v19 offset:53760
  v_mfma_f32_16x16x32_bf16 v[72:75], v[156:159], v[172:175], v[72:75]
  ds_read_b128 v[124:127], v10 offset:13312
  v_mfma_f32_16x16x32_bf16 v[76:79], v[160:163], v[164:167], v[76:79]
  ds_read_b128 v[128:131], v10 offset:15360
  v_mfma_f32_16x16x32_bf16 v[80:83], v[160:163], v[168:171], v[80:83]
  ds_read_b128 v[132:135], v10 offset:17408
  v_mfma_f32_16x16x32_bf16 v[84:87], v[160:163], v[172:175], v[84:87]
  s_barrier
  ds_read_b64_tr_b16 v[136:137], v18 offset:57344
  ds_read_b64_tr_b16 v[138:139], v18 offset:57856
  ds_read_b64_tr_b16 v[140:141], v19 offset:57344
  s_waitcnt lgkmcnt(10)
  v_mfma_f32_16x16x32_bf16 v[64:67], v[96:99], v[104:107], v[64:67]
  ds_read_b64_tr_b16 v[142:143], v19 offset:57856
  v_mfma_f32_16x16x32_bf16 v[68:71], v[96:99], v[108:111], v[68:71]
  ds_read_b128 v[144:147], v10 offset:24576
  v_mfma_f32_16x16x32_bf16 v[72:75], v[96:99], v[112:115], v[72:75]
  ds_read_b128 v[148:151], v10 offset:26624
  v_mfma_f32_16x16x32_bf16 v[76:79], v[100:103], v[104:107], v[76:79]
  ds_read_b128 v[152:155], v10 offset:28672
  v_mfma_f32_16x16x32_bf16 v[80:83], v[100:103], v[108:111], v[80:83]
  ds_read_b64_tr_b16 v[156:157], v18 offset:61440
  v_mfma_f32_16x16x32_bf16 v[84:87], v[100:103], v[112:115], v[84:87]
  ds_read_b64_tr_b16 v[158:159], v18 offset:61952
  s_waitcnt lgkmcnt(9)
  v_mfma_f32_16x16x32_bf16 v[64:67], v[116:119], v[124:127], v[64:67]
  ds_read_b64_tr_b16 v[160:161], v19 offset:61440
  v_mfma_f32_16x16x32_bf16 v[68:71], v[116:119], v[128:131], v[68:71]
  ds_read_b64_tr_b16 v[162:163], v19 offset:61952
  v_mfma_f32_16x16x32_bf16 v[72:75], v[116:119], v[132:135], v[72:75]
  ds_read_b128 v[164:167], v10 offset:25600
  v_mfma_f32_16x16x32_bf16 v[76:79], v[120:123], v[124:127], v[76:79]
  ds_read_b128 v[168:171], v10 offset:27648
  v_mfma_f32_16x16x32_bf16 v[80:83], v[120:123], v[128:131], v[80:83]
  ds_read_b128 v[172:175], v10 offset:29696
  v_mfma_f32_16x16x32_bf16 v[84:87], v[120:123], v[132:135], v[84:87]
  s_barrier
  ds_read_b64_tr_b16 v[96:97], v20 offset:0
  ds_read_b64_tr_b16 v[98:99], v20 offset:512
  ds_read_b64_tr_b16 v[100:101], v21 offset:0
  s_waitcnt lgkmcnt(10)
  v_mfma_f32_16x16x32_bf16 v[64:67], v[136:139], v[144:147], v[64:67]
  ds_read_b64_tr_b16 v[102:103], v21 offset:512
  v_mfma_f32_16x16x32_bf16 v[68:71], v[136:139], v[148:151], v[68:71]
  ds_read_b128 v[104:107], v10 offset:36864
  v_mfma_f32_16x16x32_bf16 v[72:75], v[136:139], v[152:155], v[72:75]
  ds_read_b128 v[108:111], v10 offset:38912
  v_mfma_f32_16x16x32_bf16 v[76:79], v[140:143], v[144:147], v[76:79]
  ds_read_b128 v[112:115], v10 offset:40960
  v_mfma_f32_16x16x32_bf16 v[80:83], v[140:143], v[148:151], v[80:83]
  ds_read_b64_tr_b16 v[116:117], v20 offset:4096
  v_mfma_f32_16x16x32_bf16 v[84:87], v[140:143], v[152:155], v[84:87]
  ds_read_b64_tr_b16 v[118:119], v20 offset:4608
  s_waitcnt lgkmcnt(9)
  v_mfma_f32_16x16x32_bf16 v[64:67], v[156:159], v[164:167], v[64:67]
  ds_read_b64_tr_b16 v[120:121], v21 offset:4096
  v_mfma_f32_16x16x32_bf16 v[68:71], v[156:159], v[168:171], v[68:71]
  ds_read_b64_tr_b16 v[122:123], v21 offset:4608
  v_mfma_f32_16x16x32_bf16 v[72:75], v[156:159], v[172:175], v[72:75]
  ds_read_b128 v[124:127], v10 offset:37888
  v_mfma_f32_16x16x32_bf16 v[76:79], v[160:163], v[164:167], v[76:79]
  ds_read_b128 v[128:131], v10 offset:39936
  v_mfma_f32_16x16x32_bf16 v[80:83], v[160:163], v[168:171], v[80:83]
  ds_read_b128 v[132:135], v10 offset:41984
  v_mfma_f32_16x16x32_bf16 v[84:87], v[160:163], v[172:175], v[84:87]
  s_barrier
  ds_read_b64_tr_b16 v[136:137], v20 offset:8192
  ds_read_b64_tr_b16 v[138:139], v20 offset:8704
  ds_read_b64_tr_b16 v[140:141], v21 offset:8192
  s_waitcnt lgkmcnt(10)
  v_mfma_f32_16x16x32_bf16 v[64:67], v[96:99], v[104:107], v[64:67]
  ds_read_b64_tr_b16 v[142:143], v21 offset:8704
  v_mfma_f32_16x16x32_bf16 v[68:71], v[96:99], v[108:111], v[68:71]
  ds_read_b128 v[144:147], v10 offset:49152
  v_mfma_f32_16x16x32_bf16 v[72:75], v[96:99], v[112:115], v[72:75]
  ds_read_b128 v[148:151], v10 offset:51200
  v_mfma_f32_16x16x32_bf16 v[76:79], v[100:103], v[104:107], v[76:79]
  ds_read_b128 v[152:155], v10 offset:53248
  v_mfma_f32_16x16x32_bf16 v[80:83], v[100:103], v[108:111], v[80:83]
  ds_read_b64_tr_b16 v[156:157], v20 offset:12288
  v_mfma_f32_16x16x32_bf16 v[84:87], v[100:103], v[112:115], v[84:87]
  ds_read_b64_tr_b16 v[158:159], v20 offset:12800
  s_waitcnt lgkmcnt(9)
  v_mfma_f32_16x16x32_bf16 v[64:67], v[116:119], v[124:127], v[64:67]
  ds_read_b64_tr_b16 v[160:161], v21 offset:12288
  v_mfma_f32_16x16x32_bf16 v[68:71], v[116:119], v[128:131], v[68:71]
  ds_read_b64_tr_b16 v[162:163], v21 offset:12800
  v_mfma_f32_16x16x32_bf16 v[72:75], v[116:119], v[132:135], v[72:75]
  ds_read_b128 v[164:167], v10 offset:50176
  v_mfma_f32_16x16x32_bf16 v[76:79], v[120:123], v[124:127], v[76:79]
  ds_read_b128 v[168:171], v10 offset:52224
  v_mfma_f32_16x16x32_bf16 v[80:83], v[120:123], v[128:131], v[80:83]
  ds_read_b128 v[172:175], v10 offset:54272
  v_mfma_f32_16x16x32_bf16 v[84:87], v[120:123], v[132:135], v[84:87]
  s_barrier
  ds_read_b64_tr_b16 v[96:97], v20 offset:16384
  ds_read_b64_tr_b16 v[98:99], v20 offset:16896
  ds_read_b64_tr_b16 v[100:101], v21 offset:16384
  s_waitcnt lgkmcnt(10)
  v_mfma_f32_16x16x32_bf16 v[64:67], v[136:139], v[144:147], v[64:67]
  ds_read_b64_tr_b16 v[102:103], v21 offset:16896
  v_mfma_f32_16x16x32_bf16 v[68:71], v[136:139], v[148:151], v[68:71]
  ds_read_b128 v[104:107], v10 offset:0
  v_mfma_f32_16x16x32_bf16 v[72:75], v[136:139], v[152:155], v[72:75]
  ds_read_b128 v[108:111], v10 offset:2048
  v_mfma_f32_16x16x32_bf16 v[76:79], v[140:143], v[144:147], v[76:79]
  ds_read_b128 v[112:115], v10 offset:4096
  v_mfma_f32_16x16x32_bf16 v[80:83], v[140:143], v[148:151], v[80:83]
  ds_read_b64_tr_b16 v[116:117], v20 offset:20480
  v_mfma_f32_16x16x32_bf16 v[84:87], v[140:143], v[152:155], v[84:87]
  ds_read_b64_tr_b16 v[118:119], v20 offset:20992
  s_waitcnt lgkmcnt(9)
  v_mfma_f32_16x16x32_bf16 v[64:67], v[156:159], v[164:167], v[64:67]
  ds_read_b64_tr_b16 v[120:121], v21 offset:20480
  v_mfma_f32_16x16x32_bf16 v[68:71], v[156:159], v[168:171], v[68:71]
  ds_read_b64_tr_b16 v[122:123], v21 offset:20992
  v_mfma_f32_16x16x32_bf16 v[72:75], v[156:159], v[172:175], v[72:75]
  ds_read_b128 v[124:127], v10 offset:1024
  v_mfma_f32_16x16x32_bf16 v[76:79], v[160:163], v[164:167], v[76:79]
  ds_read_b128 v[128:131], v10 offset:3072
  v_mfma_f32_16x16x32_bf16 v[80:83], v[160:163], v[168:171], v[80:83]
  ds_read_b128 v[132:135], v10 offset:5120
  v_mfma_f32_16x16x32_bf16 v[84:87], v[160:163], v[172:175], v[84:87]
  s_barrier
  ds_read_b64_tr_b16 v[136:137], v18 offset:0
  ds_read_b64_tr_b16 v[138:139], v18 offset:512
  ds_read_b64_tr_b16 v[140:141], v19 offset:0
  s_waitcnt lgkmcnt(10)
  v_mfma_f32_16x16x32_bf16 v[64:67], v[96:99], v[104:107], v[64:67]
  ds_read_b64_tr_b16 v[142:143], v19 offset:512
  v_mfma_f32_16x16x32_bf16 v[68:71], v[96:99], v[108:111], v[68:71]
  ds_read_b128 v[144:147], v10 offset:12288
  v_mfma_f32_16x16x32_bf16 v[72:75], v[96:99], v[112:115], v[72:75]
  ds_read_b128 v[148:151], v10 offset:14336
  v_mfma_f32_16x16x32_bf16 v[76:79], v[100:103], v[104:107], v[76:79]
  ds_read_b128 v[152:155], v10 offset:16384
  v_mfma_f32_16x16x32_bf16 v[80:83], v[100:103], v[108:111], v[80:83]
  ds_read_b64_tr_b16 v[156:157], v18 offset:4096
  v_mfma_f32_16x16x32_bf16 v[84:87], v[100:103], v[112:115], v[84:87]
  ds_read_b64_tr_b16 v[158:159], v18 offset:4608
  s_waitcnt lgkmcnt(9)
  v_mfma_f32_16x16x32_bf16 v[64:67], v[116:119], v[124:127], v[64:67]
  ds_read_b64_tr_b16 v[160:161], v19 offset:4096
  v_mfma_f32_16x16x32_bf16 v[68:71], v[116:119], v[128:131], v[68:71]
  ds_read_b64_tr_b16 v[162:163], v19 offset:4608
  v_mfma_f32_16x16x32_bf16 v[72:75], v[116:119], v[132:135], v[72:75]
  ds_read_b128 v[164:167], v10 offset:13312
  v_mfma_f32_16x16x32_bf16 v[76:79], v[120:123], v[124:127], v[76:79]
  ds_read_b128 v[168:171], v10 offset:15360
  v_mfma_f32_16x16x32_bf16 v[80:83], v[120:123], v[128:131], v[80:83]
  ds_read_b128 v[172:175], v10 offset:17408
  v_mfma_f32_16x16x32_bf16 v[84:87], v[120:123], v[132:135], v[84:87]
  s_barrier
  ds_read_b64_tr_b16 v[96:97], v18 offset:8192
  ds_read_b64_tr_b16 v[98:99], v18 offset:8704
  ds_read_b64_tr_b16 v[100:101], v19 offset:8192
  s_waitcnt lgkmcnt(10)
  v_mfma_f32_16x16x32_bf16 v[64:67], v[136:139], v[144:147], v[64:67]
  ds_read_b64_tr_b16 v[102:103], v19 offset:8704
  v_mfma_f32_16x16x32_bf16 v[68:71], v[136:139], v[148:151], v[68:71]
  ds_read_b128 v[104:107], v10 offset:24576
  v_mfma_f32_16x16x32_bf16 v[72:75], v[136:139], v[152:155], v[72:75]
  ds_read_b128 v[108:111], v10 offset:26624
  v_mfma_f32_16x16x32_bf16 v[76:79], v[140:143], v[144:147], v[76:79]
  ds_read_b128 v[112:115], v10 offset:28672
  v_mfma_f32_16x16x32_bf16 v[80:83], v[140:143], v[148:151], v[80:83]
  ds_read_b64_tr_b16 v[116:117], v18 offset:12288
  v_mfma_f32_16x16x32_bf16 v[84:87], v[140:143], v[152:155], v[84:87]
  ds_read_b64_tr_b16 v[118:119], v18 offset:12800
  s_waitcnt lgkmcnt(9)
  v_mfma_f32_16x16x32_bf16 v[64:67], v[156:159], v[164:167], v[64:67]
  ds_read_b64_tr_b16 v[120:121], v19 offset:12288
  v_mfma_f32_16x16x32_bf16 v[68:71], v[156:159], v[168:171], v[68:71]
  ds_read_b64_tr_b16 v[122:123], v19 offset:12800
  v_mfma_f32_16x16x32_bf16 v[72:75], v[156:159], v[172:175], v[72:75]
  ds_read_b128 v[124:127], v10 offset:25600
  v_mfma_f32_16x16x32_bf16 v[76:79], v[160:163], v[164:167], v[76:79]
  ds_read_b128 v[128:131], v10 offset:27648
  v_mfma_f32_16x16x32_bf16 v[80:83], v[160:163], v[168:171], v[80:83]
  ds_read_b128 v[132:135], v10 offset:29696
  v_mfma_f32_16x16x32_bf16 v[84:87], v[160:163], v[172:175], v[84:87]
  s_barrier
  ds_read_b64_tr_b16 v[136:137], v18 offset:16384
  ds_read_b64_tr_b16 v[138:139], v18 offset:16896
  ds_read_b64_tr_b16 v[140:141], v19 offset:16384
  s_waitcnt lgkmcnt(10)
  v_mfma_f32_16x16x32_bf16 v[64:67], v[96:99], v[104:107], v[64:67]
  ds_read_b64_tr_b16 v[142:143], v19 offset:16896
  v_mfma_f32_16x16x32_bf16 v[68:71], v[96:99], v[108:111], v[68:71]
  ds_read_b128 v[144:147], v10 offset:36864
  v_mfma_f32_16x16x32_bf16 v[72:75], v[96:99], v[112:115], v[72:75]
  ds_read_b128 v[148:151], v10 offset:38912
  v_mfma_f32_16x16x32_bf16 v[76:79], v[100:103], v[104:107], v[76:79]
  ds_read_b128 v[152:155], v10 offset:40960
  v_mfma_f32_16x16x32_bf16 v[80:83], v[100:103], v[108:111], v[80:83]
  ds_read_b64_tr_b16 v[156:157], v18 offset:20480
  v_mfma_f32_16x16x32_bf16 v[84:87], v[100:103], v[112:115], v[84:87]
  ds_read_b64_tr_b16 v[158:159], v18 offset:20992
  s_waitcnt lgkmcnt(9)
  v_mfma_f32_16x16x32_bf16 v[64:67], v[116:119], v[124:127], v[64:67]
  ds_read_b64_tr_b16 v[160:161], v19 offset:20480
  v_mfma_f32_16x16x32_bf16 v[68:71], v[116:119], v[128:131], v[68:71]
  ds_read_b64_tr_b16 v[162:163], v19 offset:20992
  v_mfma_f32_16x16x32_bf16 v[72:75], v[116:119], v[132:135], v[72:75]
  ds_read_b128 v[164:167], v10 offset:37888
  v_mfma_f32_16x16x32_bf16 v[76:79], v[120:123], v[124:127], v[76:79]
  ds_read_b128 v[168:171], v10 offset:39936
  v_mfma_f32_16x16x32_bf16 v[80:83], v[120:123], v[128:131], v[80:83]
  ds_read_b128 v[172:175], v10 offset:41984
  v_mfma_f32_16x16x32_bf16 v[84:87], v[120:123], v[132:135], v[84:87]
  s_barrier
  ds_read_b64_tr_b16 v[96:97], v18 offset:24576
  ds_read_b64_tr_b16 v[98:99], v18 offset:25088
  ds_read_b64_tr_b16 v[100:101], v19 offset:24576
  s_waitcnt lgkmcnt(10)
  v_mfma_f32_16x16x32_bf16 v[64:67], v[136:139], v[144:147], v[64:67]
  ds_read_b64_tr_b16 v[102:103], v19 offset:25088
  v_mfma_f32_16x16x32_bf16 v[68:71], v[136:139], v[148:151], v[68:71]
  ds_read_b128 v[104:107], v10 offset:49152
  v_mfma_f32_16x16x32_bf16 v[72:75], v[136:139], v[152:155], v[72:75]
  ds_read_b128 v[108:111], v10 offset:51200
  v_mfma_f32_16x16x32_bf16 v[76:79], v[140:143], v[144:147], v[76:79]
  ds_read_b128 v[112:115], v10 offset:53248
  v_mfma_f32_16x16x32_bf16 v[80:83], v[140:143], v[148:151], v[80:83]
  ds_read_b64_tr_b16 v[116:117], v18 offset:28672
  v_mfma_f32_16x16x32_bf16 v[84:87], v[140:143], v[152:155], v[84:87]
  ds_read_b64_tr_b16 v[118:119], v18 offset:29184
  s_waitcnt lgkmcnt(9)
  v_mfma_f32_16x16x32_bf16 v[64:67], v[156:159], v[164:167], v[64:67]
  ds_read_b64_tr_b16 v[120:121], v19 offset:28672
  v_mfma_f32_16x16x32_bf16 v[68:71], v[156:159], v[168:171], v[68:71]
  ds_read_b64_tr_b16 v[122:123], v19 offset:29184
  v_mfma_f32_16x16x32_bf16 v[72:75], v[156:159], v[172:175], v[72:75]
  ds_read_b128 v[124:127], v10 offset:50176
  v_mfma_f32_16x16x32_bf16 v[76:79], v[160:163], v[164:167], v[76:79]
  ds_read_b128 v[128:131], v10 offset:52224
  v_mfma_f32_16x16x32_bf16 v[80:83], v[160:163], v[168:171], v[80:83]
  ds_read_b128 v[132:135], v10 offset:54272
  v_mfma_f32_16x16x32_bf16 v[84:87], v[160:163], v[172:175], v[84:87]
  s_barrier
  ds_read_b64_tr_b16 v[136:137], v18 offset:32768
  ds_read_b64_tr_b16 v[138:139], v18 offset:33280
  ds_read_b64_tr_b16 v[140:141], v19 offset:32768
  s_waitcnt lgkmcnt(10)
  v_mfma_f32_16x16x32_bf16 v[64:67], v[96:99], v[104:107], v[64:67]
  ds_read_b64_tr_b16 v[142:143], v19 offset:33280
  v_mfma_f32_16x16x32_bf16 v[68:71], v[96:99], v[108:111], v[68:71]
  ds_read_b128 v[144:147], v10 offset:0
  v_mfma_f32_16x16x32_bf16 v[72:75], v[96:99], v[112:115], v[72:75]
  ds_read_b128 v[148:151], v10 offset:2048
  v_mfma_f32_16x16x32_bf16 v[76:79], v[100:103], v[104:107], v[76:79]
  ds_read_b128 v[152:155], v10 offset:4096
  v_mfma_f32_16x16x32_bf16 v[80:83], v[100:103], v[108:111], v[80:83]
  ds_read_b64_tr_b16 v[156:157], v18 offset:36864
  v_mfma_f32_16x16x32_bf16 v[84:87], v[100:103], v[112:115], v[84:87]
  ds_read_b64_tr_b16 v[158:159], v18 offset:37376
  s_waitcnt lgkmcnt(9)
  v_mfma_f32_16x16x32_bf16 v[64:67], v[116:119], v[124:127], v[64:67]
  ds_read_b64_tr_b16 v[160:161], v19 offset:36864
  v_mfma_f32_16x16x32_bf16 v[68:71], v[116:119], v[128:131], v[68:71]
  ds_read_b64_tr_b16 v[162:163], v19 offset:37376
  v_mfma_f32_16x16x32_bf16 v[72:75], v[116:119], v[132:135], v[72:75]
  ds_read_b128 v[164:167], v10 offset:1024
  v_mfma_f32_16x16x32_bf16 v[76:79], v[120:123], v[124:127], v[76:79]
  ds_read_b128 v[168:171], v10 offset:3072
  v_mfma_f32_16x16x32_bf16 v[80:83], v[120:123], v[128:131], v[80:83]
  ds_read_b128 v[172:175], v10 offset:5120
  v_mfma_f32_16x16x32_bf16 v[84:87], v[120:123], v[132:135], v[84:87]
  s_barrier
  ds_read_b64_tr_b16 v[96:97], v18 offset:40960
  ds_read_b64_tr_b16 v[98:99], v18 offset:41472
  ds_read_b64_tr_b16 v[100:101], v19 offset:40960
  s_waitcnt lgkmcnt(10)
  v_mfma_f32_16x16x32_bf16 v[64:67], v[136:139], v[144:147], v[64:67]
  ds_read_b64_tr_b16 v[102:103], v19 offset:41472
  v_mfma_f32_16x16x32_bf16 v[68:71], v[136:139], v[148:151], v[68:71]
  ds_read_b128 v[104:107], v10 offset:12288
  v_mfma_f32_16x16x32_bf16 v[72:75], v[136:139], v[152:155], v[72:75]
  ds_read_b128 v[108:111], v10 offset:14336
  v_mfma_f32_16x16x32_bf16 v[76:79], v[140:143], v[144:147], v[76:79]
  ds_read_b128 v[112:115], v10 offset:16384
  v_mfma_f32_16x16x32_bf16 v[80:83], v[140:143], v[148:151], v[80:83]
  ds_read_b64_tr_b16 v[116:117], v18 offset:45056
  v_mfma_f32_16x16x32_bf16 v[84:87], v[140:143], v[152:155], v[84:87]
  ds_read_b64_tr_b16 v[118:119], v18 offset:45568
  s_waitcnt lgkmcnt(9)
  v_mfma_f32_16x16x32_bf16 v[64:67], v[156:159], v[164:167], v[64:67]
  ds_read_b64_tr_b16 v[120:121], v19 offset:45056
  v_mfma_f32_16x16x32_bf16 v[68:71], v[156:159], v[168:171], v[68:71]
  ds_read_b64_tr_b16 v[122:123], v19 offset:45568
  v_mfma_f32_16x16x32_bf16 v[72:75], v[156:159], v[172:175], v[72:75]
  ds_read_b128 v[124:127], v10 offset:13312
  v_mfma_f32_16x16x32_bf16 v[76:79], v[160:163], v[164:167], v[76:79]
  ds_read_b128 v[128:131], v10 offset:15360
  v_mfma_f32_16x16x32_bf16 v[80:83], v[160:163], v[168:171], v[80:83]
  ds_read_b128 v[132:135], v10 offset:17408
  v_mfma_f32_16x16x32_bf16 v[84:87], v[160:163], v[172:175], v[84:87]
  s_barrier
  ds_read_b64_tr_b16 v[136:137], v18 offset:49152
  ds_read_b64_tr_b16 v[138:139], v18 offset:49664
  ds_read_b64_tr_b16 v[140:141], v19 offset:49152
  s_waitcnt lgkmcnt(10)
  v_mfma_f32_16x16x32_bf16 v[64:67], v[96:99], v[104:107], v[64:67]
  ds_read_b64_tr_b16 v[142:143], v19 offset:49664
  v_mfma_f32_16x16x32_bf16 v[68:71], v[96:99], v[108:111], v[68:71]
  ds_read_b128 v[144:147], v10 offset:24576
  v_mfma_f32_16x16x32_bf16 v[72:75], v[96:99], v[112:115], v[72:75]
  ds_read_b128 v[148:151], v10 offset:26624
  v_mfma_f32_16x16x32_bf16 v[76:79], v[100:103], v[104:107], v[76:79]
  ds_read_b128 v[152:155], v10 offset:28672
  v_mfma_f32_16x16x32_bf16 v[80:83], v[100:103], v[108:111], v[80:83]
  ds_read_b64_tr_b16 v[156:157], v18 offset:53248
  v_mfma_f32_16x16x32_bf16 v[84:87], v[100:103], v[112:115], v[84:87]
  ds_read_b64_tr_b16 v[158:159], v18 offset:53760
  s_waitcnt lgkmcnt(9)
  v_mfma_f32_16x16x32_bf16 v[64:67], v[116:119], v[124:127], v[64:67]
  ds_read_b64_tr_b16 v[160:161], v19 offset:53248
  v_mfma_f32_16x16x32_bf16 v[68:71], v[116:119], v[128:131], v[68:71]
  ds_read_b64_tr_b16 v[162:163], v19 offset:53760
  v_mfma_f32_16x16x32_bf16 v[72:75], v[116:119], v[132:135], v[72:75]
  ds_read_b128 v[164:167], v10 offset:25600
  v_mfma_f32_16x16x32_bf16 v[76:79], v[120:123], v[124:127], v[76:79]
  ds_read_b128 v[168:171], v10 offset:27648
  v_mfma_f32_16x16x32_bf16 v[80:83], v[120:123], v[128:131], v[80:83]
  ds_read_b128 v[172:175], v10 offset:29696
  v_mfma_f32_16x16x32_bf16 v[84:87], v[120:123], v[132:135], v[84:87]
  s_barrier
  ds_read_b64_tr_b16 v[96:97], v18 offset:57344
  ds_read_b64_tr_b16 v[98:99], v18 offset:57856
  ds_read_b64_tr_b16 v[100:101], v19 offset:57344
  s_waitcnt lgkmcnt(10)
  v_mfma_f32_16x16x32_bf16 v[64:67], v[136:139], v[144:147], v[64:67]
  ds_read_b64_tr_b16 v[102:103], v19 offset:57856
  v_mfma_f32_16x16x32_bf16 v[68:71], v[136:139], v[148:151], v[68:71]
  ds_read_b128 v[104:107], v10 offset:36864
  v_mfma_f32_16x16x32_bf16 v[72:75], v[136:139], v[152:155], v[72:75]
  ds_read_b128 v[108:111], v10 offset:38912
  v_mfma_f32_16x16x32_bf16 v[76:79], v[140:143], v[144:147], v[76:79]
  ds_read_b128 v[112:115], v10 offset:40960
  v_mfma_f32_16x16x32_bf16 v[80:83], v[140:143], v[148:151], v[80:83]
  ds_read_b64_tr_b16 v[116:117], v18 offset:61440
  v_mfma_f32_16x16x32_bf16 v[84:87], v[140:143], v[152:155], v[84:87]
  ds_read_b64_tr_b16 v[118:119], v18 offset:61952
  s_waitcnt lgkmcnt(9)
  v_mfma_f32_16x16x32_bf16 v[64:67], v[156:159], v[164:167], v[64:67]
  ds_read_b64_tr_b16 v[120:121], v19 offset:61440
  v_mfma_f32_16x16x32_bf16 v[68:71], v[156:159], v[168:171], v[68:71]
  ds_read_b64_tr_b16 v[122:123], v19 offset:61952
  v_mfma_f32_16x16x32_bf16 v[72:75], v[156:159], v[172:175], v[72:75]
  ds_read_b128 v[124:127], v10 offset:37888
  v_mfma_f32_16x16x32_bf16 v[76:79], v[160:163], v[164:167], v[76:79]
  ds_read_b128 v[128:131], v10 offset:39936
  v_mfma_f32_16x16x32_bf16 v[80:83], v[160:163], v[168:171], v[80:83]
  ds_read_b128 v[132:135], v10 offset:41984
  v_mfma_f32_16x16x32_bf16 v[84:87], v[160:163], v[172:175], v[84:87]
  s_barrier
  ds_read_b64_tr_b16 v[136:137], v20 offset:0
  ds_read_b64_tr_b16 v[138:139], v20 offset:512
  ds_read_b64_tr_b16 v[140:141], v21 offset:0
  s_waitcnt lgkmcnt(10)
  v_mfma_f32_16x16x32_bf16 v[64:67], v[96:99], v[104:107], v[64:67]
  ds_read_b64_tr_b16 v[142:143], v21 offset:512
  v_mfma_f32_16x16x32_bf16 v[68:71], v[96:99], v[108:111], v[68:71]
  ds_read_b128 v[144:147], v10 offset:49152
  v_mfma_f32_16x16x32_bf16 v[72:75], v[96:99], v[112:115], v[72:75]
  ds_read_b128 v[148:151], v10 offset:51200
  v_mfma_f32_16x16x32_bf16 v[76:79], v[100:103], v[104:107], v[76:79]
  ds_read_b128 v[152:155], v10 offset:53248
  v_mfma_f32_16x16x32_bf16 v[80:83], v[100:103], v[108:111], v[80:83]
  ds_read_b64_tr_b16 v[156:157], v20 offset:4096
  v_mfma_f32_16x16x32_bf16 v[84:87], v[100:103], v[112:115], v[84:87]
  ds_read_b64_tr_b16 v[158:159], v20 offset:4608
  s_waitcnt lgkmcnt(9)
  v_mfma_f32_16x16x32_bf16 v[64:67], v[116:119], v[124:127], v[64:67]
  ds_read_b64_tr_b16 v[160:161], v21 offset:4096
  v_mfma_f32_16x16x32_bf16 v[68:71], v[116:119], v[128:131], v[68:71]
  ds_read_b64_tr_b16 v[162:163], v21 offset:4608
  v_mfma_f32_16x16x32_bf16 v[72:75], v[116:119], v[132:135], v[72:75]
  ds_read_b128 v[164:167], v10 offset:50176
  v_mfma_f32_16x16x32_bf16 v[76:79], v[120:123], v[124:127], v[76:79]
  ds_read_b128 v[168:171], v10 offset:52224
  v_mfma_f32_16x16x32_bf16 v[80:83], v[120:123], v[128:131], v[80:83]
  ds_read_b128 v[172:175], v10 offset:54272
  v_mfma_f32_16x16x32_bf16 v[84:87], v[120:123], v[132:135], v[84:87]
  s_barrier
  ds_read_b64_tr_b16 v[96:97], v20 offset:8192
  ds_read_b64_tr_b16 v[98:99], v20 offset:8704
  ds_read_b64_tr_b16 v[100:101], v21 offset:8192
  s_waitcnt lgkmcnt(10)
  v_mfma_f32_16x16x32_bf16 v[64:67], v[136:139], v[144:147], v[64:67]
  ds_read_b64_tr_b16 v[102:103], v21 offset:8704
  v_mfma_f32_16x16x32_bf16 v[68:71], v[136:139], v[148:151], v[68:71]
  ds_read_b128 v[104:107], v10 offset:0
  v_mfma_f32_16x16x32_bf16 v[72:75], v[136:139], v[152:155], v[72:75]
  ds_read_b128 v[108:111], v10 offset:2048
  v_mfma_f32_16x16x32_bf16 v[76:79], v[140:143], v[144:147], v[76:79]
  ds_read_b128 v[112:115], v10 offset:4096
  v_mfma_f32_16x16x32_bf16 v[80:83], v[140:143], v[148:151], v[80:83]
  ds_read_b64_tr_b16 v[116:117], v20 offset:12288
  v_mfma_f32_16x16x32_bf16 v[84:87], v[140:143], v[152:155], v[84:87]
  ds_read_b64_tr_b16 v[118:119], v20 offset:12800
  s_waitcnt lgkmcnt(9)
  v_mfma_f32_16x16x32_bf16 v[64:67], v[156:159], v[164:167], v[64:67]
  ds_read_b64_tr_b16 v[120:121], v21 offset:12288
  v_mfma_f32_16x16x32_bf16 v[68:71], v[156:159], v[168:171], v[68:71]
  ds_read_b64_tr_b16 v[122:123], v21 offset:12800
  v_mfma_f32_16x16x32_bf16 v[72:75], v[156:159], v[172:175], v[72:75]
  ds_read_b128 v[124:127], v10 offset:1024
  v_mfma_f32_16x16x32_bf16 v[76:79], v[160:163], v[164:167], v[76:79]
  ds_read_b128 v[128:131], v10 offset:3072
  v_mfma_f32_16x16x32_bf16 v[80:83], v[160:163], v[168:171], v[80:83]
  ds_read_b128 v[132:135], v10 offset:5120
  v_mfma_f32_16x16x32_bf16 v[84:87], v[160:163], v[172:175], v[84:87]
  s_barrier
  ds_read_b64_tr_b16 v[136:137], v20 offset:16384
  ds_read_b64_tr_b16 v[138:139], v20 offset:16896
  ds_read_b64_tr_b16 v[140:141], v21 offset:16384
  s_waitcnt lgkmcnt(10)
  v_mfma_f32_16x16x32_bf16 v[64:67], v[96:99], v[104:107], v[64:67]
  ds_read_b64_tr_b16 v[142:143], v21 offset:16896
  v_mfma_f32_16x16x32_bf16 v[68:71], v[96:99], v[108:111], v[68:71]
  ds_read_b128 v[144:147], v10 offset:12288
  v_mfma_f32_16x16x32_bf16 v[72:75], v[96:99], v[112:115], v[72:75]
  ds_read_b128 v[148:151], v10 offset:14336
  v_mfma_f32_16x16x32_bf16 v[76:79], v[100:103], v[104:107], v[76:79]
  ds_read_b128 v[152:155], v10 offset:16384
  v_mfma_f32_16x16x32_bf16 v[80:83], v[100:103], v[108:111], v[80:83]
  ds_read_b64_tr_b16 v[156:157], v20 offset:20480
  v_mfma_f32_16x16x32_bf16 v[84:87], v[100:103], v[112:115], v[84:87]
  ds_read_b64_tr_b16 v[158:159], v20 offset:20992
  s_waitcnt lgkmcnt(9)
  v_mfma_f32_16x16x32_bf16 v[64:67], v[116:119], v[124:127], v[64:67]
  ds_read_b64_tr_b16 v[160:161], v21 offset:20480
  v_mfma_f32_16x16x32_bf16 v[68:71], v[116:119], v[128:131], v[68:71]
  ds_read_b64_tr_b16 v[162:163], v21 offset:20992
  v_mfma_f32_16x16x32_bf16 v[72:75], v[116:119], v[132:135], v[72:75]
  ds_read_b128 v[164:167], v10 offset:13312
  v_mfma_f32_16x16x32_bf16 v[76:79], v[120:123], v[124:127], v[76:79]
  ds_read_b128 v[168:171], v10 offset:15360
  v_mfma_f32_16x16x32_bf16 v[80:83], v[120:123], v[128:131], v[80:83]
  ds_read_b128 v[172:175], v10 offset:17408
  v_mfma_f32_16x16x32_bf16 v[84:87], v[120:123], v[132:135], v[84:87]
  s_barrier
  ds_read_b64_tr_b16 v[96:97], v18 offset:0
  ds_read_b64_tr_b16 v[98:99], v18 offset:512
  ds_read_b64_tr_b16 v[100:101], v19 offset:0
  s_waitcnt lgkmcnt(10)
  v_mfma_f32_16x16x32_bf16 v[64:67], v[136:139], v[144:147], v[64:67]
  ds_read_b64_tr_b16 v[102:103], v19 offset:512
  v_mfma_f32_16x16x32_bf16 v[68:71], v[136:139], v[148:151], v[68:71]
  ds_read_b128 v[104:107], v10 offset:24576
  v_mfma_f32_16x16x32_bf16 v[72:75], v[136:139], v[152:155], v[72:75]
  ds_read_b128 v[108:111], v10 offset:26624
  v_mfma_f32_16x16x32_bf16 v[76:79], v[140:143], v[144:147], v[76:79]
  ds_read_b128 v[112:115], v10 offset:28672
  v_mfma_f32_16x16x32_bf16 v[80:83], v[140:143], v[148:151], v[80:83]
  ds_read_b64_tr_b16 v[116:117], v18 offset:4096
  v_mfma_f32_16x16x32_bf16 v[84:87], v[140:143], v[152:155], v[84:87]
  ds_read_b64_tr_b16 v[118:119], v18 offset:4608
  s_waitcnt lgkmcnt(9)
  v_mfma_f32_16x16x32_bf16 v[64:67], v[156:159], v[164:167], v[64:67]
  ds_read_b64_tr_b16 v[120:121], v19 offset:4096
  v_mfma_f32_16x16x32_bf16 v[68:71], v[156:159], v[168:171], v[68:71]
  ds_read_b64_tr_b16 v[122:123], v19 offset:4608
  v_mfma_f32_16x16x32_bf16 v[72:75], v[156:159], v[172:175], v[72:75]
  ds_read_b128 v[124:127], v10 offset:25600
  v_mfma_f32_16x16x32_bf16 v[76:79], v[160:163], v[164:167], v[76:79]
  ds_read_b128 v[128:131], v10 offset:27648
  v_mfma_f32_16x16x32_bf16 v[80:83], v[160:163], v[168:171], v[80:83]
  ds_read_b128 v[132:135], v10 offset:29696
  v_mfma_f32_16x16x32_bf16 v[84:87], v[160:163], v[172:175], v[84:87]
  s_barrier
  ds_read_b64_tr_b16 v[136:137], v18 offset:8192
  ds_read_b64_tr_b16 v[138:139], v18 offset:8704
  ds_read_b64_tr_b16 v[140:141], v19 offset:8192
  s_waitcnt lgkmcnt(10)
  v_mfma_f32_16x16x32_bf16 v[64:67], v[96:99], v[104:107], v[64:67]
  ds_read_b64_tr_b16 v[142:143], v19 offset:8704
  v_mfma_f32_16x16x32_bf16 v[68:71], v[96:99], v[108:111], v[68:71]
  ds_read_b128 v[144:147], v10 offset:36864
  v_mfma_f32_16x16x32_bf16 v[72:75], v[96:99], v[112:115], v[72:75]
  ds_read_b128 v[148:151], v10 offset:38912
  v_mfma_f32_16x16x32_bf16 v[76:79], v[100:103], v[104:107], v[76:79]
  ds_read_b128 v[152:155], v10 offset:40960
  v_mfma_f32_16x16x32_bf16 v[80:83], v[100:103], v[108:111], v[80:83]
  ds_read_b64_tr_b16 v[156:157], v18 offset:12288
  v_mfma_f32_16x16x32_bf16 v[84:87], v[100:103], v[112:115], v[84:87]
  ds_read_b64_tr_b16 v[158:159], v18 offset:12800
  s_waitcnt lgkmcnt(9)
  v_mfma_f32_16x16x32_bf16 v[64:67], v[116:119], v[124:127], v[64:67]
  ds_read_b64_tr_b16 v[160:161], v19 offset:12288
  v_mfma_f32_16x16x32_bf16 v[68:71], v[116:119], v[128:131], v[68:71]
  ds_read_b64_tr_b16 v[162:163], v19 offset:12800
  v_mfma_f32_16x16x32_bf16 v[72:75], v[116:119], v[132:135], v[72:75]
  ds_read_b128 v[164:167], v10 offset:37888
  v_mfma_f32_16x16x32_bf16 v[76:79], v[120:123], v[124:127], v[76:79]
  ds_read_b128 v[168:171], v10 offset:39936
  v_mfma_f32_16x16x32_bf16 v[80:83], v[120:123], v[128:131], v[80:83]
  ds_read_b128 v[172:175], v10 offset:41984
  v_mfma_f32_16x16x32_bf16 v[84:87], v[120:123], v[132:135], v[84:87]
  s_barrier
  ds_read_b64_tr_b16 v[96:97], v18 offset:16384
  ds_read_b64_tr_b16 v[98:99], v18 offset:16896
  ds_read_b64_tr_b16 v[100:101], v19 offset:16384
  s_waitcnt lgkmcnt(10)
  v_mfma_f32_16x16x32_bf16 v[64:67], v[136:139], v[144:147], v[64:67]
  ds_read_b64_tr_b16 v[102:103], v19 offset:16896
  v_mfma_f32_16x16x32_bf16 v[68:71], v[136:139], v[148:151], v[68:71]
  ds_read_b128 v[104:107], v10 offset:49152
  v_mfma_f32_16x16x32_bf16 v[72:75], v[136:139], v[152:155], v[72:75]
  ds_read_b128 v[108:111], v10 offset:51200
  v_mfma_f32_16x16x32_bf16 v[76:79], v[140:143], v[144:147], v[76:79]
  ds_read_b128 v[112:115], v10 offset:53248
  v_mfma_f32_16x16x32_bf16 v[80:83], v[140:143], v[148:151], v[80:83]
  ds_read_b64_tr_b16 v[116:117], v18 offset:20480
  v_mfma_f32_16x16x32_bf16 v[84:87], v[140:143], v[152:155], v[84:87]
  ds_read_b64_tr_b16 v[118:119], v18 offset:20992
  s_waitcnt lgkmcnt(9)
  v_mfma_f32_16x16x32_bf16 v[64:67], v[156:159], v[164:167], v[64:67]
  ds_read_b64_tr_b16 v[120:121], v19 offset:20480
  v_mfma_f32_16x16x32_bf16 v[68:71], v[156:159], v[168:171], v[68:71]
  ds_read_b64_tr_b16 v[122:123], v19 offset:20992
  v_mfma_f32_16x16x32_bf16 v[72:75], v[156:159], v[172:175], v[72:75]
  ds_read_b128 v[124:127], v10 offset:50176
  v_mfma_f32_16x16x32_bf16 v[76:79], v[160:163], v[164:167], v[76:79]
  ds_read_b128 v[128:131], v10 offset:52224
  v_mfma_f32_16x16x32_bf16 v[80:83], v[160:163], v[168:171], v[80:83]
  ds_read_b128 v[132:135], v10 offset:54272
  v_mfma_f32_16x16x32_bf16 v[84:87], v[160:163], v[172:175], v[84:87]
  s_barrier
  ds_read_b64_tr_b16 v[136:137], v18 offset:24576
  ds_read_b64_tr_b16 v[138:139], v18 offset:25088
  ds_read_b64_tr_b16 v[140:141], v19 offset:24576
  s_waitcnt lgkmcnt(10)
  v_mfma_f32_16x16x32_bf16 v[64:67], v[96:99], v[104:107], v[64:67]
  ds_read_b64_tr_b16 v[142:143], v19 offset:25088
  v_mfma_f32_16x16x32_bf16 v[68:71], v[96:99], v[108:111], v[68:71]
  ds_read_b128 v[144:147], v10 offset:0
  v_mfma_f32_16x16x32_bf16 v[72:75], v[96:99], v[112:115], v[72:75]
  ds_read_b128 v[148:151], v10 offset:2048
  v_mfma_f32_16x16x32_bf16 v[76:79], v[100:103], v[104:107], v[76:79]
  ds_read_b128 v[152:155], v10 offset:4096
  v_mfma_f32_16x16x32_bf16 v[80:83], v[100:103], v[108:111], v[80:83]
  ds_read_b64_tr_b16 v[156:157], v18 offset:28672
  v_mfma_f32_16x16x32_bf16 v[84:87], v[100:103], v[112:115], v[84:87]
  ds_read_b64_tr_b16 v[158:159], v18 offset:29184
  s_waitcnt lgkmcnt(9)
  v_mfma_f32_16x16x32_bf16 v[64:67], v[116:119], v[124:127], v[64:67]
  ds_read_b64_tr_b16 v[160:161], v19 offset:28672
  v_mfma_f32_16x16x32_bf16 v[68:71], v[116:119], v[128:131], v[68:71]
  ds_read_b64_tr_b16 v[162:163], v19 offset:29184
  v_mfma_f32_16x16x32_bf16 v[72:75], v[116:119], v[132:135], v[72:75]
  ds_read_b128 v[164:167], v10 offset:1024
  v_mfma_f32_16x16x32_bf16 v[76:79], v[120:123], v[124:127], v[76:79]
  ds_read_b128 v[168:171], v10 offset:3072
  v_mfma_f32_16x16x32_bf16 v[80:83], v[120:123], v[128:131], v[80:83]
  ds_read_b128 v[172:175], v10 offset:5120
  v_mfma_f32_16x16x32_bf16 v[84:87], v[120:123], v[132:135], v[84:87]
  s_barrier
  ds_read_b64_tr_b16 v[96:97], v18 offset:32768
  ds_read_b64_tr_b16 v[98:99], v18 offset:33280
  ds_read_b64_tr_b16 v[100:101], v19 offset:32768
  s_waitcnt lgkmcnt(10)
  v_mfma_f32_16x16x32_bf16 v[64:67], v[136:139], v[144:147], v[64:67]
  ds_read_b64_tr_b16 v[102:103], v19 offset:33280
  v_mfma_f32_16x16x32_bf16 v[68:71], v[136:139], v[148:151], v[68:71]
  ds_read_b128 v[104:107], v10 offset:12288
  v_mfma_f32_16x16x32_bf16 v[72:75], v[136:139], v[152:155], v[72:75]
  ds_read_b128 v[108:111], v10 offset:14336
  v_mfma_f32_16x16x32_bf16 v[76:79], v[140:143], v[144:147], v[76:79]
  ds_read_b128 v[112:115], v10 offset:16384
  v_mfma_f32_16x16x32_bf16 v[80:83], v[140:143], v[148:151], v[80:83]
  ds_read_b64_tr_b16 v[116:117], v18 offset:36864
  v_mfma_f32_16x16x32_bf16 v[84:87], v[140:143], v[152:155], v[84:87]
  ds_read_b64_tr_b16 v[118:119], v18 offset:37376
  s_waitcnt lgkmcnt(9)
  v_mfma_f32_16x16x32_bf16 v[64:67], v[156:159], v[164:167], v[64:67]
  ds_read_b64_tr_b16 v[120:121], v19 offset:36864
  v_mfma_f32_16x16x32_bf16 v[68:71], v[156:159], v[168:171], v[68:71]
  ds_read_b64_tr_b16 v[122:123], v19 offset:37376
  v_mfma_f32_16x16x32_bf16 v[72:75], v[156:159], v[172:175], v[72:75]
  ds_read_b128 v[124:127], v10 offset:13312
  v_mfma_f32_16x16x32_bf16 v[76:79], v[160:163], v[164:167], v[76:79]
  ds_read_b128 v[128:131], v10 offset:15360
  v_mfma_f32_16x16x32_bf16 v[80:83], v[160:163], v[168:171], v[80:83]
  ds_read_b128 v[132:135], v10 offset:17408
  v_mfma_f32_16x16x32_bf16 v[84:87], v[160:163], v[172:175], v[84:87]
  s_waitcnt lgkmcnt(0)
  s_barrier
  v_mfma_f32_16x16x32_bf16 v[64:67], v[96:99], v[104:107], v[64:67]
  v_mfma_f32_16x16x32_bf16 v[68:71], v[96:99], v[108:111], v[68:71]
  v_mfma_f32_16x16x32_bf16 v[72:75], v[96:99], v[112:115], v[72:75]
  v_mfma_f32_16x16x32_bf16 v[76:79], v[100:103], v[104:107], v[76:79]
  v_mfma_f32_16x16x32_bf16 v[80:83], v[100:103], v[108:111], v[80:83]
  v_mfma_f32_16x16x32_bf16 v[84:87], v[100:103], v[112:115], v[84:87]
  v_mfma_f32_16x16x32_bf16 v[64:67], v[116:119], v[124:127], v[64:67]
  v_mfma_f32_16x16x32_bf16 v[68:71], v[116:119], v[128:131], v[68:71]
  v_mfma_f32_16x16x32_bf16 v[72:75], v[116:119], v[132:135], v[72:75]
  v_mfma_f32_16x16x32_bf16 v[76:79], v[120:123], v[124:127], v[76:79]
  v_mfma_f32_16x16x32_bf16 v[80:83], v[120:123], v[128:131], v[80:83]
  v_mfma_f32_16x16x32_bf16 v[84:87], v[120:123], v[132:135], v[84:87]
  s_nop 3
  v_pk_add_f32 v[64:65], v[64:65], v[192:193]
  v_pk_add_f32 v[66:67], v[66:67], v[194:195]
  v_pk_add_f32 v[76:77], v[76:77], v[204:205]
  v_pk_add_f32 v[78:79], v[78:79], v[206:207]
  v_pk_add_f32 v[68:69], v[68:69], v[196:197]
  v_pk_add_f32 v[70:71], v[70:71], v[198:199]
  v_pk_add_f32 v[80:81], v[80:81], v[208:209]
  v_pk_add_f32 v[82:83], v[82:83], v[210:211]
  v_pk_add_f32 v[72:73], v[72:73], v[200:201]
  v_pk_add_f32 v[74:75], v[74:75], v[202:203]
  v_pk_add_f32 v[84:85], v[84:85], v[212:213]
  v_pk_add_f32 v[86:87], v[86:87], v[214:215]
  v_cvt_pk_bf16_f32 v224, v64, v65
  v_cvt_pk_bf16_f32 v225, v66, v67
  v_cvt_pk_bf16_f32 v226, v76, v77
  v_cvt_pk_bf16_f32 v227, v78, v79
  v_cvt_pk_bf16_f32 v228, v68, v69
  v_cvt_pk_bf16_f32 v229, v70, v71
  v_cvt_pk_bf16_f32 v230, v80, v81
  v_cvt_pk_bf16_f32 v231, v82, v83
  v_cvt_pk_bf16_f32 v232, v72, v73
  v_cvt_pk_bf16_f32 v233, v74, v75
  v_cvt_pk_bf16_f32 v234, v84, v85
  v_cvt_pk_bf16_f32 v235, v86, v87
  s_nop 1
  v_permlane16_swap_b32 v224, v226
  v_permlane16_swap_b32 v225, v227
  v_permlane16_swap_b32 v228, v230
  v_permlane16_swap_b32 v229, v231
  v_permlane16_swap_b32 v232, v234
  v_permlane16_swap_b32 v233, v235
  s_cmp_eq_u32 s96, 1
  s_cbranch_scc1 L_c5_final
  s_mov_b32 s32, 20480
  s_mov_b32 s33, 40960
  s_cmp_eq_u32 s46, 0
  s_cbranch_scc0 L_slow_18
  buffer_store_dwordx4 v[224:227], v23, s[12:15], 0 offen
  buffer_store_dwordx4 v[228:231], v23, s[12:15], s32 offen
  buffer_store_dwordx4 v[232:235], v23, s[12:15], s33 offen
L_back_18:
  v_pk_add_f32 v[96:97], v[64:65], v[66:67]
  v_pk_mul_f32 v[98:99], v[64:65], v[64:65]
  v_pk_add_f32 v[100:101], v[68:69], v[70:71]
  v_pk_mul_f32 v[102:103], v[68:69], v[68:69]
  v_pk_add_f32 v[104:105], v[72:73], v[74:75]
  v_pk_mul_f32 v[106:107], v[72:73], v[72:73]
  v_pk_add_f32 v[96:97], v[96:97], v[76:77]
  v_pk_fma_f32 v[98:99], v[66:67], v[66:67], v[98:99]
  v_pk_add_f32 v[100:101], v[100:101], v[80:81]
  v_pk_fma_f32 v[102:103], v[70:71], v[70:71], v[102:103]
  v_pk_add_f32 v[104:105], v[104:105], v[84:85]
  v_pk_fma_f32 v[106:107], v[74:75], v[74:75], v[106:107]
  v_pk_add_f32 v[96:97], v[96:97], v[78:79]
  v_pk_fma_f32 v[98:99], v[76:77], v[76:77], v[98:99]
  v_pk_add_f32 v[100:101], v[100:101], v[82:83]
  v_pk_fma_f32 v[102:103], v[80:81], v[80:81], v[102:103]
  v_pk_add_f32 v[104:105], v[104:105], v[86:87]
  v_pk_fma_f32 v[106:107], v[84:85], v[84:85], v[106:107]
  v_pk_fma_f32 v[98:99], v[78:79], v[78:79], v[98:99]
  v_add_f32 v96, v96, v97
  v_pk_fma_f32 v[102:103], v[82:83], v[82:83], v[102:103]
  v_add_f32 v100, v100, v101
  v_pk_fma_f32 v[106:107], v[86:87], v[86:87], v[106:107]
  v_add_f32 v104, v104, v105
  v_add_f32 v98, v98, v99
  v_add_f32 v102, v102, v103
  v_add_f32 v106, v106, v107
  s_nop 1
  v_permlane32_swap_b32 v96, v98
  v_permlane32_swap_b32 v100, v102
  v_permlane32_swap_b32 v104, v106
  s_nop 1
  v_add_f32 v96, v96, v98
  v_add_f32 v100, v100, v102
  v_add_f32 v104, v104, v106
  v_mov_b32 v105, v104
  s_nop 1
  v_permlane16_swap_b32 v96, v100
  v_permlane16_swap_b32 v104, v105

  s_nop 1
  v_add_f32 v96, v96, v100
  v_add_f32 v104, v104, v105
  s_and_saveexec_b64 s[34:35], s[36:37]

  s_cmp_eq_u32 s46, 0
  s_cbranch_scc0 L_slow_19
  buffer_store_dword v96, v27, s[16:19], 0 offen
L_back_19:

  s_mov_b64 exec, s[34:35]
  s_add_u32 s32, s31, 2
  s_cmp_lt_u32 s32, s39
  s_cbranch_scc0 L_mlp2_nost
  s_mov_b32 exec_lo, 0x0000ffff
  s_mov_b32 exec_hi, 0x0000ffff

  s_cmp_eq_u32 s46, 0
  s_cbranch_scc0 L_slow_20
  buffer_store_dword v104, v27, s[16:19], 0 offen offset:128
L_back_20:
  s_mov_b64 exec, -1
L_mlp2_nost:
L_c5_tail:

  s_and_b32 s30, s63, 1
  s_lshl_b32 s20, s62, 1
  s_add_u32 s20, s20, s30
  s_lshr_b32 s21, s63, 1
  s_cmp_ge_u32 s63, 30
  s_cselect_b32 s21, 15, s21

  v_and_b32 v2, 63, v0
  v_and_b32 v3, 31, v2
  v_lshrrev_b32 v4, 5, v2
  s_and_b32 s23, s22, 1
  s_lshr_b32 s24, s22, 1
  v_and_b32 v5, 15, v2
  v_lshrrev_b32 v6, 2, v5
  v_and_b32 v7, 3, v5
  v_lshl_add_u32 v8, v4, 3, v6
  v_lshlrev_b32 v8, 8, v8
  v_lshl_add_u32 v8, v7, 3, v8
  v_bfe_u32 v9, v2, 4, 1
  v_lshl_add_u32 v8, v9, 5, v8
  s_lshl_b32 s30, s24, 1

  s_xor_b32 s32, s23, 0
  s_add_u32 s32, s32, s30
  v_xor_b32 v9, s32, v6
  v_lshl_add_u32 v12, v9, 6, v8

  s_xor_b32 s32, s23, 1
  s_add_u32 s32, s32, s30
  v_xor_b32 v9, s32, v6
  v_lshl_add_u32 v13, v9, 6, v8

  v_lshrrev_b32 v5, 4, v3
  v_lshlrev_b32 v5, 11, v5
  v_and_b32 v6, 15, v3
  v_lshl_add_u32 v5, v6, 4, v5
  v_lshl_add_u32 v5, v4, 8, v5
  s_lshl_b32 s30, s23, 13
  v_add_u32 v10, s30, v5

  s_waitcnt vmcnt(0) lgkmcnt(0)
  s_barrier
  s_cmp_eq_u32 s22, 0
  s_cbranch_scc0 L_c5_nosig

  s_mul_i32 s3, s96, 6
  s_add_u32 s3, s3, 5
  s_lshl_b32 s3, s3, 3
  s_add_u32 s3, s3, s62
  s_lshl_b32 s3, s3, 7
  s_add_u32 s3, s3, 0x07000000

  s_lshl_b32 s30, s63, 2
  s_add_u32 s30, s30, s3
  v_mov_b32 v6, s30
  v_mov_b32 v7, s101
  s_mov_b64 exec, 1

  s_cmp_eq_u32 s46, 0
  s_cbranch_scc0 L_c5_sigg
  global_store_dword v6, v7, s[60:61]
  s_branch L_c5_sigd
L_c5_sigg:
  global_store_dword v6, v7, s[60:61] sc1
L_c5_sigd:

  s_mov_b64 exec, -1
L_c5_nosig:
  s_cmp_eq_u32 s22, 0
  s_cbranch_scc0 L_c5_nopoll
  s_cmp_lg_u32 s97, 0
  s_cbranch_scc1 L_c5_nopoll

  s_mul_i32 s3, s96, 6
  s_add_u32 s3, s3, 5
  s_lshl_b32 s3, s3, 3
  s_add_u32 s3, s3, s62
  s_lshl_b32 s3, s3, 7
  s_add_u32 s3, s3, 0x07000000

  v_and_b32 v6, 63, v0
  v_lshl_add_u32 v6, v6, 2, s3
  s_mov_b32 s3, 400000
  s_mov_b32 exec_lo, 0x3fffffff
  s_mov_b32 exec_hi, 0
L_c5_poll:
  global_load_dword v7, v6, s[60:61] sc1
  s_waitcnt vmcnt(0)
  v_cmp_ne_u32 vcc, s101, v7
  s_cbranch_vccz L_c5_ok
  s_sub_u32 s3, s3, 1
  s_cmp_eq_u32 s3, 0
  s_cbranch_scc0 L_c5_poll
  s_mov_b32 s97, 1
L_c5_ok:
  s_mov_b64 exec, -1
L_c5_nopoll:

  s_barrier

  s_add_u32 s96, s96, 1
  s_add_u32 s47, s47, 0x00600000
  s_branch L_c_layer
L_c5_final:

  s_mov_b32 s32, 20480
  s_mov_b32 s33, 40960
  buffer_store_dwordx4 v[224:227], v26, s[12:15], 0 offen
  buffer_store_dwordx4 v[228:231], v26, s[12:15], s32 offen
  buffer_store_dwordx4 v[232:235], v26, s[12:15], s33 offen

  s_branch L_end
L_loader:

  s_waitcnt lgkmcnt(0)
  s_mov_b32 s46, 1
  s_mov_b32 s47, 0

  s_and_b32 s30, s63, 1
  s_lshl_b32 s20, s62, 1
  s_add_u32 s20, s20, s30
  s_lshr_b32 s21, s63, 1
  s_cmp_ge_u32 s63, 30
  s_cselect_b32 s21, 15, s21

  v_and_b32 v2, 63, v0
  v_lshrrev_b32 v4, 4, v2
  s_sub_u32 s23, s22, 4
  s_lshl_b32 s34, s23, 12
  s_lshl_b32 s30, s23, 4
  v_add_u32 v5, s30, v4
  v_bfe_u32 v6, v2, 2, 2
  v_xor_b32 v6, v6, v4
  v_and_b32 v7, 3, v2
  v_lshlrev_b32 v7, 4, v7
  v_lshl_add_u32 v7, v6, 6, v7
  s_lshl_b32 s31, s21, 8
  v_add_u32 v7, s31, v7

  v_add_u32 v8, 0, v5
  v_mul_u32_u24 v8, 3840, v8
  v_add_u32 v8, v7, v8
  v_subrev_u32 v14, 0, v8

  v_add_u32 v8, 4, v5
  v_mul_u32_u24 v8, 3840, v8
  v_add_u32 v8, v7, v8
  v_subrev_u32 v15, 1024, v8

  v_add_u32 v8, 8, v5
  v_mul_u32_u24 v8, 3840, v8
  v_add_u32 v8, v7, v8
  v_subrev_u32 v16, 2048, v8

  v_add_u32 v8, 12, v5
  v_mul_u32_u24 v8, 3840, v8
  v_add_u32 v8, v7, v8
  v_subrev_u32 v17, 3072, v8

  s_add_u32 s8, s42, 0x00000000
  s_addc_u32 s9, s43, 0
  s_mov_b32 s10, 0x00258000
  s_mov_b32 s11, 0x00020000
  s_cmp_eq_u32 s21, 15
  s_cbranch_scc1 L_l1_idle0

  s_lshl_b32 s30, s20, 7
  s_lshl_b32 s31, s23, 5
  s_add_u32 s30, s30, s31
  v_lshrrev_b32 v5, 3, v2
  v_add_u32 v5, s30, v5
  v_and_b32 v6, 7, v2

  v_add_u32 v7, 0, v5
  v_mul_u32_u24 v7, 1280, v7
  v_or_b32 v8, 0, v4
  v_xor_b32 v8, v6, v8
  v_lshl_add_u32 v7, v8, 4, v7
  v_subrev_u32 v10, 0, v7

  v_add_u32 v7, 8, v5
  v_mul_u32_u24 v7, 1280, v7
  v_or_b32 v8, 4, v4
  v_xor_b32 v8, v6, v8
  v_lshl_add_u32 v7, v8, 4, v7
  v_subrev_u32 v11, 1024, v7

  v_add_u32 v7, 16, v5
  v_mul_u32_u24 v7, 1280, v7
  v_or_b32 v8, 0, v4
  v_xor_b32 v8, v6, v8
  v_lshl_add_u32 v7, v8, 4, v7
  v_subrev_u32 v12, 2048, v7

  v_add_u32 v7, 24, v5
  v_mul_u32_u24 v7, 1280, v7
  v_or_b32 v8, 4, v4
  v_xor_b32 v8, v6, v8
  v_lshl_add_u32 v7, v8, 4, v7
  v_subrev_u32 v13, 3072, v7

  s_add_u32 s4, s40, 0x00000000
  s_addc_u32 s5, s41, 0
  s_mov_b32 s6, 0x00280000
  s_mov_b32 s7, 0x00020000

  s_mov_b32 s27, 0
  s_mov_b32 s28, 0
  s_mov_b32 s26, 81920
  s_mov_b32 s33, 0
  v_lshlrev_b32 v18, 4, v2
  v_add_u32 v18, s34, v18

  v_and_b32 v5, 15, v2
  v_lshrrev_b32 v6, 1, v5
  v_xor_b32 v6, v4, v6
  v_lshlrev_b32 v6, 4, v6
  v_lshl_add_u32 v6, v5, 7, v6
  v_add_u32 v21, s34, v6
  s_lshl_b32 s30, s20, 3
  s_lshl_b32 s31, s23, 1
  s_add_u32 s30, s30, s31
  s_mul_i32 s30, s30, 20480
  v_lshl_add_u32 v20, v2, 4, s30

  s_add_u32 s12, s60, 0x00b00000
  s_addc_u32 s13, s61, 0
  s_mov_b32 s14, 0x00280000
  s_mov_b32 s15, 0x00020000
  s_add_u32 m0, s34, 81920
  s_mov_b32 s27, 0
  buffer_load_dwordx4 v10, s[4:7], s27 offen offset:0 lds
  buffer_load_dwordx4 v11, s[4:7], s27 offen offset:1024 lds
  buffer_load_dwordx4 v12, s[4:7], s27 offen offset:2048 lds
  buffer_load_dwordx4 v13, s[4:7], s27 offen offset:3072 lds
  s_add_u32 m0, s34, 0
  s_mov_b32 s28, 0
  buffer_load_dwordx4 v14, s[8:11], s28 offen offset:0 lds
  buffer_load_dwordx4 v15, s[8:11], s28 offen offset:1024 lds
  buffer_load_dwordx4 v16, s[8:11], s28 offen offset:2048 lds
  buffer_load_dwordx4 v17, s[8:11], s28 offen offset:3072 lds
  s_add_u32 m0, s34, 98304
  s_mov_b32 s27, 128
  buffer_load_dwordx4 v10, s[4:7], s27 offen offset:0 lds
  buffer_load_dwordx4 v11, s[4:7], s27 offen offset:1024 lds
  buffer_load_dwordx4 v12, s[4:7], s27 offen offset:2048 lds
  buffer_load_dwordx4 v13, s[4:7], s27 offen offset:3072 lds
  s_add_u32 m0, s34, 16384
  s_mov_b32 s28, 245760
  buffer_load_dwordx4 v14, s[8:11], s28 offen offset:0 lds
  buffer_load_dwordx4 v15, s[8:11], s28 offen offset:1024 lds
  buffer_load_dwordx4 v16, s[8:11], s28 offen offset:2048 lds
  buffer_load_dwordx4 v17, s[8:11], s28 offen offset:3072 lds
  s_waitcnt vmcnt(8)
  s_barrier
  s_add_u32 m0, s34, 114688
  s_mov_b32 s27, 256
  buffer_load_dwordx4 v10, s[4:7], s27 offen offset:0 lds
  buffer_load_dwordx4 v11, s[4:7], s27 offen offset:1024 lds
  buffer_load_dwordx4 v12, s[4:7], s27 offen offset:2048 lds
  buffer_load_dwordx4 v13, s[4:7], s27 offen offset:3072 lds
  s_add_u32 m0, s34, 32768
  s_mov_b32 s28, 491520
  buffer_load_dwordx4 v14, s[8:11], s28 offen offset:0 lds
  buffer_load_dwordx4 v15, s[8:11], s28 offen offset:1024 lds
  buffer_load_dwordx4 v16, s[8:11], s28 offen offset:2048 lds
  buffer_load_dwordx4 v17, s[8:11], s28 offen offset:3072 lds

  s_cmp_eq_u32 s33, s21
  s_cbranch_scc0 L_qf_nc1
  v_add_u32 v6, s26, v21
  v_xor_b32 v7, 64, v6
  ds_read_b128 v[72:75], v6
  ds_read_b128 v[76:79], v7
  ds_read_b128 v[80:83], v6 offset:2048
  ds_read_b128 v[84:87], v7 offset:2048
  s_lshl_b32 s31, s33, 11
  s_add_u32 s30, s31, 20480
  s_waitcnt lgkmcnt(0)
  buffer_store_dwordx4 v[72:75], v20, s[12:15], s31 offen sc1
  buffer_store_dwordx4 v[76:79], v20, s[12:15], s31 offen offset:1024 sc1
  buffer_store_dwordx4 v[80:83], v20, s[12:15], s30 offen sc1
  buffer_store_dwordx4 v[84:87], v20, s[12:15], s30 offen offset:1024 sc1
L_qf_nc1:
  s_add_u32 s33, s33, 1

  s_add_u32 s26, s26, 16384
  s_cmp_eq_u32 s26, 131072
  s_cselect_b32 s26, 81920, s26
  s_waitcnt vmcnt(8)
  s_barrier
  s_add_u32 m0, s34, 81920
  s_mov_b32 s27, 384
  buffer_load_dwordx4 v10, s[4:7], s27 offen offset:0 lds
  buffer_load_dwordx4 v11, s[4:7], s27 offen offset:1024 lds
  buffer_load_dwordx4 v12, s[4:7], s27 offen offset:2048 lds
  buffer_load_dwordx4 v13, s[4:7], s27 offen offset:3072 lds
  s_add_u32 m0, s34, 49152
  s_mov_b32 s28, 737280
  buffer_load_dwordx4 v14, s[8:11], s28 offen offset:0 lds
  buffer_load_dwordx4 v15, s[8:11], s28 offen offset:1024 lds
  buffer_load_dwordx4 v16, s[8:11], s28 offen offset:2048 lds
  buffer_load_dwordx4 v17, s[8:11], s28 offen offset:3072 lds

  s_cmp_eq_u32 s33, s21
  s_cbranch_scc0 L_qf_nc2
  v_add_u32 v6, s26, v21
  v_xor_b32 v7, 64, v6
  ds_read_b128 v[72:75], v6
  ds_read_b128 v[76:79], v7
  ds_read_b128 v[80:83], v6 offset:2048
  ds_read_b128 v[84:87], v7 offset:2048
  s_lshl_b32 s31, s33, 11
  s_add_u32 s30, s31, 20480
  s_waitcnt lgkmcnt(0)
  buffer_store_dwordx4 v[72:75], v20, s[12:15], s31 offen sc1
  buffer_store_dwordx4 v[76:79], v20, s[12:15], s31 offen offset:1024 sc1
  buffer_store_dwordx4 v[80:83], v20, s[12:15], s30 offen sc1
  buffer_store_dwordx4 v[84:87], v20, s[12:15], s30 offen offset:1024 sc1
L_qf_nc2:
  s_add_u32 s33, s33, 1

  s_add_u32 s26, s26, 16384
  s_cmp_eq_u32 s26, 131072
  s_cselect_b32 s26, 81920, s26
  s_waitcnt vmcnt(8)
  s_barrier
  s_add_u32 m0, s34, 98304
  s_mov_b32 s27, 512
  buffer_load_dwordx4 v10, s[4:7], s27 offen offset:0 lds
  buffer_load_dwordx4 v11, s[4:7], s27 offen offset:1024 lds
  buffer_load_dwordx4 v12, s[4:7], s27 offen offset:2048 lds
  buffer_load_dwordx4 v13, s[4:7], s27 offen offset:3072 lds
  s_add_u32 m0, s34, 65536
  s_mov_b32 s28, 983040
  buffer_load_dwordx4 v14, s[8:11], s28 offen offset:0 lds
  buffer_load_dwordx4 v15, s[8:11], s28 offen offset:1024 lds
  buffer_load_dwordx4 v16, s[8:11], s28 offen offset:2048 lds
  buffer_load_dwordx4 v17, s[8:11], s28 offen offset:3072 lds

  s_cmp_eq_u32 s33, s21
  s_cbranch_scc0 L_qf_nc3
  v_add_u32 v6, s26, v21
  v_xor_b32 v7, 64, v6
  ds_read_b128 v[72:75], v6
  ds_read_b128 v[76:79], v7
  ds_read_b128 v[80:83], v6 offset:2048
  ds_read_b128 v[84:87], v7 offset:2048
  s_lshl_b32 s31, s33, 11
  s_add_u32 s30, s31, 20480
  s_waitcnt lgkmcnt(0)
  buffer_store_dwordx4 v[72:75], v20, s[12:15], s31 offen sc1
  buffer_store_dwordx4 v[76:79], v20, s[12:15], s31 offen offset:1024 sc1
  buffer_store_dwordx4 v[80:83], v20, s[12:15], s30 offen sc1
  buffer_store_dwordx4 v[84:87], v20, s[12:15], s30 offen offset:1024 sc1
L_qf_nc3:
  s_add_u32 s33, s33, 1

  s_add_u32 s26, s26, 16384
  s_cmp_eq_u32 s26, 131072
  s_cselect_b32 s26, 81920, s26
  s_waitcnt vmcnt(8)
  s_barrier
  s_add_u32 m0, s34, 114688
  s_mov_b32 s27, 640
  buffer_load_dwordx4 v10, s[4:7], s27 offen offset:0 lds
  buffer_load_dwordx4 v11, s[4:7], s27 offen offset:1024 lds
  buffer_load_dwordx4 v12, s[4:7], s27 offen offset:2048 lds
  buffer_load_dwordx4 v13, s[4:7], s27 offen offset:3072 lds
  s_add_u32 m0, s34, 0
  s_mov_b32 s28, 1228800
  buffer_load_dwordx4 v14, s[8:11], s28 offen offset:0 lds
  buffer_load_dwordx4 v15, s[8:11], s28 offen offset:1024 lds
  buffer_load_dwordx4 v16, s[8:11], s28 offen offset:2048 lds
  buffer_load_dwordx4 v17, s[8:11], s28 offen offset:3072 lds

  s_cmp_eq_u32 s33, s21
  s_cbranch_scc0 L_qf_nc4
  v_add_u32 v6, s26, v21
  v_xor_b32 v7, 64, v6
  ds_read_b128 v[72:75], v6
  ds_read_b128 v[76:79], v7
  ds_read_b128 v[80:83], v6 offset:2048
  ds_read_b128 v[84:87], v7 offset:2048
  s_lshl_b32 s31, s33, 11
  s_add_u32 s30, s31, 20480
  s_waitcnt lgkmcnt(0)
  buffer_store_dwordx4 v[72:75], v20, s[12:15], s31 offen sc1
  buffer_store_dwordx4 v[76:79], v20, s[12:15], s31 offen offset:1024 sc1
  buffer_store_dwordx4 v[80:83], v20, s[12:15], s30 offen sc1
  buffer_store_dwordx4 v[84:87], v20, s[12:15], s30 offen offset:1024 sc1
L_qf_nc4:
  s_add_u32 s33, s33, 1

  s_add_u32 s26, s26, 16384
  s_cmp_eq_u32 s26, 131072
  s_cselect_b32 s26, 81920, s26
  s_waitcnt vmcnt(8)
  s_barrier
  s_add_u32 m0, s34, 81920
  s_mov_b32 s27, 768
  buffer_load_dwordx4 v10, s[4:7], s27 offen offset:0 lds
  buffer_load_dwordx4 v11, s[4:7], s27 offen offset:1024 lds
  buffer_load_dwordx4 v12, s[4:7], s27 offen offset:2048 lds
  buffer_load_dwordx4 v13, s[4:7], s27 offen offset:3072 lds
  s_add_u32 m0, s34, 16384
  s_mov_b32 s28, 1474560
  buffer_load_dwordx4 v14, s[8:11], s28 offen offset:0 lds
  buffer_load_dwordx4 v15, s[8:11], s28 offen offset:1024 lds
  buffer_load_dwordx4 v16, s[8:11], s28 offen offset:2048 lds
  buffer_load_dwordx4 v17, s[8:11], s28 offen offset:3072 lds

  s_cmp_eq_u32 s33, s21
  s_cbranch_scc0 L_qf_nc5
  v_add_u32 v6, s26, v21
  v_xor_b32 v7, 64, v6
  ds_read_b128 v[72:75], v6
  ds_read_b128 v[76:79], v7
  ds_read_b128 v[80:83], v6 offset:2048
  ds_read_b128 v[84:87], v7 offset:2048
  s_lshl_b32 s31, s33, 11
  s_add_u32 s30, s31, 20480
  s_waitcnt lgkmcnt(0)
  buffer_store_dwordx4 v[72:75], v20, s[12:15], s31 offen sc1
  buffer_store_dwordx4 v[76:79], v20, s[12:15], s31 offen offset:1024 sc1
  buffer_store_dwordx4 v[80:83], v20, s[12:15], s30 offen sc1
  buffer_store_dwordx4 v[84:87], v20, s[12:15], s30 offen offset:1024 sc1
L_qf_nc5:
  s_add_u32 s33, s33, 1

  s_add_u32 s26, s26, 16384
  s_cmp_eq_u32 s26, 131072
  s_cselect_b32 s26, 81920, s26
  s_waitcnt vmcnt(8)
  s_barrier
  s_add_u32 m0, s34, 98304
  s_mov_b32 s27, 896
  buffer_load_dwordx4 v10, s[4:7], s27 offen offset:0 lds
  buffer_load_dwordx4 v11, s[4:7], s27 offen offset:1024 lds
  buffer_load_dwordx4 v12, s[4:7], s27 offen offset:2048 lds
  buffer_load_dwordx4 v13, s[4:7], s27 offen offset:3072 lds
  s_add_u32 m0, s34, 32768
  s_mov_b32 s28, 1720320
  buffer_load_dwordx4 v14, s[8:11], s28 offen offset:0 lds
  buffer_load_dwordx4 v15, s[8:11], s28 offen offset:1024 lds
  buffer_load_dwordx4 v16, s[8:11], s28 offen offset:2048 lds
  buffer_load_dwordx4 v17, s[8:11], s28 offen offset:3072 lds

  s_cmp_eq_u32 s33, s21
  s_cbranch_scc0 L_qf_nc6
  v_add_u32 v6, s26, v21
  v_xor_b32 v7, 64, v6
  ds_read_b128 v[72:75], v6
  ds_read_b128 v[76:79], v7
  ds_read_b128 v[80:83], v6 offset:2048
  ds_read_b128 v[84:87], v7 offset:2048
  s_lshl_b32 s31, s33, 11
  s_add_u32 s30, s31, 20480
  s_waitcnt lgkmcnt(0)
  buffer_store_dwordx4 v[72:75], v20, s[12:15], s31 offen sc1
  buffer_store_dwordx4 v[76:79], v20, s[12:15], s31 offen offset:1024 sc1
  buffer_store_dwordx4 v[80:83], v20, s[12:15], s30 offen sc1
  buffer_store_dwordx4 v[84:87], v20, s[12:15], s30 offen offset:1024 sc1
L_qf_nc6:
  s_add_u32 s33, s33, 1

  s_add_u32 s26, s26, 16384
  s_cmp_eq_u32 s26, 131072
  s_cselect_b32 s26, 81920, s26
  s_waitcnt vmcnt(8)
  s_barrier
  s_add_u32 m0, s34, 114688
  s_mov_b32 s27, 1024
  buffer_load_dwordx4 v10, s[4:7], s27 offen offset:0 lds
  buffer_load_dwordx4 v11, s[4:7], s27 offen offset:1024 lds
  buffer_load_dwordx4 v12, s[4:7], s27 offen offset:2048 lds
  buffer_load_dwordx4 v13, s[4:7], s27 offen offset:3072 lds
  s_add_u32 m0, s34, 49152
  s_mov_b32 s28, 1966080
  buffer_load_dwordx4 v14, s[8:11], s28 offen offset:0 lds
  buffer_load_dwordx4 v15, s[8:11], s28 offen offset:1024 lds
  buffer_load_dwordx4 v16, s[8:11], s28 offen offset:2048 lds
  buffer_load_dwordx4 v17, s[8:11], s28 offen offset:3072 lds

  s_cmp_eq_u32 s33, s21
  s_cbranch_scc0 L_qf_nc7
  v_add_u32 v6, s26, v21
  v_xor_b32 v7, 64, v6
  ds_read_b128 v[72:75], v6
  ds_read_b128 v[76:79], v7
  ds_read_b128 v[80:83], v6 offset:2048
  ds_read_b128 v[84:87], v7 offset:2048
  s_lshl_b32 s31, s33, 11
  s_add_u32 s30, s31, 20480
  s_waitcnt lgkmcnt(0)
  buffer_store_dwordx4 v[72:75], v20, s[12:15], s31 offen sc1
  buffer_store_dwordx4 v[76:79], v20, s[12:15], s31 offen offset:1024 sc1
  buffer_store_dwordx4 v[80:83], v20, s[12:15], s30 offen sc1
  buffer_store_dwordx4 v[84:87], v20, s[12:15], s30 offen offset:1024 sc1
L_qf_nc7:
  s_add_u32 s33, s33, 1

  s_add_u32 s26, s26, 16384
  s_cmp_eq_u32 s26, 131072
  s_cselect_b32 s26, 81920, s26
  s_waitcnt vmcnt(8)
  s_barrier
  s_add_u32 m0, s34, 81920
  s_mov_b32 s27, 1152
  buffer_load_dwordx4 v10, s[4:7], s27 offen offset:0 lds
  buffer_load_dwordx4 v11, s[4:7], s27 offen offset:1024 lds
  buffer_load_dwordx4 v12, s[4:7], s27 offen offset:2048 lds
  buffer_load_dwordx4 v13, s[4:7], s27 offen offset:3072 lds
  s_add_u32 m0, s34, 65536
  s_mov_b32 s28, 2211840
  buffer_load_dwordx4 v14, s[8:11], s28 offen offset:0 lds
  buffer_load_dwordx4 v15, s[8:11], s28 offen offset:1024 lds
  buffer_load_dwordx4 v16, s[8:11], s28 offen offset:2048 lds
  buffer_load_dwordx4 v17, s[8:11], s28 offen offset:3072 lds

  s_cmp_eq_u32 s33, s21
  s_cbranch_scc0 L_qf_nc8
  v_add_u32 v6, s26, v21
  v_xor_b32 v7, 64, v6
  ds_read_b128 v[72:75], v6
  ds_read_b128 v[76:79], v7
  ds_read_b128 v[80:83], v6 offset:2048
  ds_read_b128 v[84:87], v7 offset:2048
  s_lshl_b32 s31, s33, 11
  s_add_u32 s30, s31, 20480
  s_waitcnt lgkmcnt(0)
  buffer_store_dwordx4 v[72:75], v20, s[12:15], s31 offen sc1
  buffer_store_dwordx4 v[76:79], v20, s[12:15], s31 offen offset:1024 sc1
  buffer_store_dwordx4 v[80:83], v20, s[12:15], s30 offen sc1
  buffer_store_dwordx4 v[84:87], v20, s[12:15], s30 offen offset:1024 sc1
L_qf_nc8:
  s_add_u32 s33, s33, 1

  s_add_u32 s26, s26, 16384
  s_cmp_eq_u32 s26, 131072
  s_cselect_b32 s26, 81920, s26
  s_waitcnt vmcnt(8)
  s_barrier

  s_cmp_eq_u32 s33, s21
  s_cbranch_scc0 L_qf_nc9
  v_add_u32 v6, s26, v21
  v_xor_b32 v7, 64, v6
  ds_read_b128 v[72:75], v6
  ds_read_b128 v[76:79], v7
  ds_read_b128 v[80:83], v6 offset:2048
  ds_read_b128 v[84:87], v7 offset:2048
  s_lshl_b32 s31, s33, 11
  s_add_u32 s30, s31, 20480
  s_waitcnt lgkmcnt(0)
  buffer_store_dwordx4 v[72:75], v20, s[12:15], s31 offen sc1
  buffer_store_dwordx4 v[76:79], v20, s[12:15], s31 offen offset:1024 sc1
  buffer_store_dwordx4 v[80:83], v20, s[12:15], s30 offen sc1
  buffer_store_dwordx4 v[84:87], v20, s[12:15], s30 offen offset:1024 sc1
L_qf_nc9:
  s_add_u32 s33, s33, 1

  s_add_u32 s26, s26, 16384
  s_cmp_eq_u32 s26, 131072
  s_cselect_b32 s26, 81920, s26
  s_waitcnt vmcnt(0)
  s_barrier

  s_cmp_eq_u32 s33, s21
  s_cbranch_scc0 L_qf_nc10
  v_add_u32 v6, s26, v21
  v_xor_b32 v7, 64, v6
  ds_read_b128 v[72:75], v6
  ds_read_b128 v[76:79], v7
  ds_read_b128 v[80:83], v6 offset:2048
  ds_read_b128 v[84:87], v7 offset:2048
  s_lshl_b32 s31, s33, 11
  s_add_u32 s30, s31, 20480
  s_waitcnt lgkmcnt(0)
  buffer_store_dwordx4 v[72:75], v20, s[12:15], s31 offen sc1
  buffer_store_dwordx4 v[76:79], v20, s[12:15], s31 offen offset:1024 sc1
  buffer_store_dwordx4 v[80:83], v20, s[12:15], s30 offen sc1
  buffer_store_dwordx4 v[84:87], v20, s[12:15], s30 offen offset:1024 sc1
L_qf_nc10:
  s_add_u32 s33, s33, 1

  s_add_u32 s26, s26, 16384
  s_cmp_eq_u32 s26, 131072
  s_cselect_b32 s26, 81920, s26
  s_mov_b32 s64, 0xffffffff
  s_mov_b32 s65, 0xfffffff0
  s_mov_b32 s66, 0xfffffffe
  s_mov_b32 s67, 0xffffffe0
  s_mov_b32 s68, 0xfffffffc
  s_mov_b32 s69, 0xffffffc0
  s_mov_b32 s70, 0xfffffff8
  s_mov_b32 s71, 0xffffff80
  s_mov_b32 s72, 0xffffff00
  s_mov_b32 s73, 0xfffff000
  s_mov_b32 s74, 0xfffffe00
  s_mov_b32 s75, 0xffffe000
  s_mov_b32 s76, 0xfffffc00
  s_mov_b32 s77, 0xffffc000
  s_mov_b32 s78, 0xfffff800
  s_mov_b32 s79, 0xffff8000
  s_mov_b32 s80, 0xffff0000
  s_mov_b32 s81, 0xfff00000
  s_mov_b32 s82, 0xfffe0000
  s_mov_b32 s83, 0xffe00000
  s_mov_b32 s84, 0xfffc0000
  s_mov_b32 s85, 0xffc00000
  s_mov_b32 s86, 0xfff80000
  s_mov_b32 s87, 0xff800000
  s_mov_b32 s88, 0xff000000
  s_mov_b32 s89, 0xf0000000
  s_mov_b32 s90, 0xfe000000
  s_mov_b32 s91, 0xe0000000
  s_mov_b32 s92, 0xfc000000
  s_mov_b32 s93, 0xc0000000
  s_mov_b32 s94, 0xf8000000
  s_mov_b32 s95, 0x80000000
  s_cmp_eq_u32 s22, 7
  s_cbranch_scc0 L_l1_notab

  v_mov_b32 v6, 160020
  ds_read_b32 v7, v6
  v_and_b32 v5, 31, v0
  v_lshlrev_b32 v8, 2, v5
  s_lshl_b32 s35, s62, 7
  s_add_u32 s35, s35, 0x06f00000
  v_add_u32 v8, s35, v8
  s_mov_b32 s25, 400000
  s_waitcnt lgkmcnt(0)
  v_readfirstlane_b32 s38, v7
  s_nop 3
  s_mov_b32 s101, s38
L_tab_tpoll:
  global_load_dword v9, v8, s[60:61] sc1
  s_waitcnt vmcnt(0)
  v_xor_b32 v10, s38, v9
  v_subrev_u32 v11, 1, v10
  v_cmp_lt_u32 vcc, 15, v11
  s_cmp_eq_u64 vcc, 0
  s_cbranch_scc1 L_tab_tok
  s_sleep 2
  s_sub_u32 s25, s25, 1
  s_cmp_eq_u32 s25, 0
  s_cbranch_scc0 L_tab_tpoll
  s_mov_b32 s35, 3
  s_branch L_tab_tw
L_tab_tok:
  s_getreg_b32 s35, hwreg(HW_REG_XCC_ID)
  s_and_b32 s35, s35, 15
  v_cmp_ne_u32 vcc, s35, v11
  s_cmp_eq_u64 vcc, 0
  s_cselect_b32 s35, 0, 1
L_tab_tw:
  v_mov_b32 v6, 160016
  v_mov_b32 v7, s35
  ds_write_b32 v6, v7
  s_waitcnt lgkmcnt(0)

  s_and_b32 s38, s63, 1
  s_add_u32 s38, s38, 30
  s_lshl_b32 s38, 1, s38
  s_cmp_eq_u32 s22, 7
  s_cbranch_scc0 L_fst_nopoll
  s_cmp_lg_u32 s97, 0
  s_cbranch_scc1 L_fst_nopoll

  s_lshl_b32 s3, s62, 7
  s_add_u32 s3, s3, 0x07003000

  v_and_b32 v6, 63, v0
  v_lshl_add_u32 v6, v6, 2, s3
  s_mov_b32 s3, 400000
  s_mov_b32 exec_lo, s38
  s_mov_b32 exec_hi, 0
L_fst_poll:
  global_load_dword v7, v6, s[60:61] sc1
  s_waitcnt vmcnt(0)
  v_cmp_ne_u32 vcc, s101, v7
  s_cbranch_vccz L_fst_ok
  s_sub_u32 s3, s3, 1
  s_cmp_eq_u32 s3, 0
  s_cbranch_scc0 L_fst_poll
  s_mov_b32 s97, 1
L_fst_ok:
  s_mov_b64 exec, -1
L_fst_nopoll:

  s_add_u32 s12, s60, 0x00f00000
  s_addc_u32 s13, s61, 0
  s_mov_b32 s14, 0x00004000
  s_mov_b32 s15, 0x00020000

  v_and_b32 v5, 63, v0
  v_lshlrev_b32 v5, 4, v5
  s_lshl_b32 s30, s20, 10
  s_mov_b32 m0, 161280
  s_nop 0
  buffer_load_dwordx4 v5, s[12:15], s30 offen sc1 lds
  s_waitcnt vmcnt(0)

  s_branch L_l1_notab
L_l1_idle0:

  v_and_b32 v2, 63, v0
  s_lshl_b32 s30, s20, 7
  s_lshl_b32 s31, s22, 4
  s_add_u32 s30, s30, s31
  v_lshrrev_b32 v5, 3, v2
  v_add_u32 v5, s30, v5
  v_mul_u32_u24 v6, 1280, v5
  v_and_b32 v7, 7, v2
  v_lshl_add_u32 v6, v7, 4, v6

  s_add_u32 s4, s40, 0x00000000
  s_addc_u32 s5, s41, 0
  s_mov_b32 s6, 0x00280000
  s_mov_b32 s7, 0x00020000
  buffer_load_dwordx4 v[64:67], v6, s[4:7], 0 offen offset:0
  buffer_load_dwordx4 v[68:71], v6, s[4:7], 0 offen offset:128
  buffer_load_dwordx4 v[72:75], v6, s[4:7], 0 offen offset:256
  buffer_load_dwordx4 v[76:79], v6, s[4:7], 0 offen offset:384
  buffer_load_dwordx4 v[80:83], v6, s[4:7], 0 offen offset:512
  buffer_load_dwordx4 v[84:87], v6, s[4:7], 0 offen offset:640
  buffer_load_dwordx4 v[88:91], v6, s[4:7], 0 offen offset:768
  buffer_load_dwordx4 v[92:95], v6, s[4:7], 0 offen offset:896
  buffer_load_dwordx4 v[96:99], v6, s[4:7], 0 offen offset:1024
  buffer_load_dwordx4 v[100:103], v6, s[4:7], 0 offen offset:1152
  s_mov_b32 s31, 10240
  buffer_load_dwordx4 v[104:107], v6, s[4:7], s31 offen offset:0
  s_mov_b32 s31, 10240
  buffer_load_dwordx4 v[108:111], v6, s[4:7], s31 offen offset:128
  s_mov_b32 s31, 10240
  buffer_load_dwordx4 v[112:115], v6, s[4:7], s31 offen offset:256
  s_mov_b32 s31, 10240
  buffer_load_dwordx4 v[116:119], v6, s[4:7], s31 offen offset:384
  s_mov_b32 s31, 10240
  buffer_load_dwordx4 v[120:123], v6, s[4:7], s31 offen offset:512
  s_mov_b32 s31, 10240
  buffer_load_dwordx4 v[124:127], v6, s[4:7], s31 offen offset:640
  s_mov_b32 s31, 10240
  buffer_load_dwordx4 v[128:131], v6, s[4:7], s31 offen offset:768
  s_mov_b32 s31, 10240
  buffer_load_dwordx4 v[132:135], v6, s[4:7], s31 offen offset:896
  s_mov_b32 s31, 10240
  buffer_load_dwordx4 v[136:139], v6, s[4:7], s31 offen offset:1024
  s_mov_b32 s31, 10240
  buffer_load_dwordx4 v[140:143], v6, s[4:7], s31 offen offset:1152
  v_mov_b32 v24, 0
  v_mov_b32 v25, 0
  v_mov_b32 v26, 0
  v_mov_b32 v27, 0
  v_mov_b32 v28, 0
  v_mov_b32 v29, 0
  v_mov_b32 v30, 0
  v_mov_b32 v31, 0
  s_waitcnt vmcnt(19)
  v_lshlrev_b32 v40, 16, v64
  v_and_b32 v41, 0xffff0000, v64
  v_pk_add_f32 v[24:25], v[24:25], v[40:41]
  v_pk_fma_f32 v[26:27], v[40:41], v[40:41], v[26:27]
  v_lshlrev_b32 v42, 16, v65
  v_and_b32 v43, 0xffff0000, v65
  v_pk_add_f32 v[24:25], v[24:25], v[42:43]
  v_pk_fma_f32 v[26:27], v[42:43], v[42:43], v[26:27]
  v_lshlrev_b32 v44, 16, v66
  v_and_b32 v45, 0xffff0000, v66
  v_pk_add_f32 v[24:25], v[24:25], v[44:45]
  v_pk_fma_f32 v[26:27], v[44:45], v[44:45], v[26:27]
  v_lshlrev_b32 v46, 16, v67
  v_and_b32 v47, 0xffff0000, v67
  v_pk_add_f32 v[24:25], v[24:25], v[46:47]
  v_pk_fma_f32 v[26:27], v[46:47], v[46:47], v[26:27]
  s_waitcnt vmcnt(18)
  v_lshlrev_b32 v40, 16, v68
  v_and_b32 v41, 0xffff0000, v68
  v_pk_add_f32 v[24:25], v[24:25], v[40:41]
  v_pk_fma_f32 v[26:27], v[40:41], v[40:41], v[26:27]
  v_lshlrev_b32 v42, 16, v69
  v_and_b32 v43, 0xffff0000, v69
  v_pk_add_f32 v[24:25], v[24:25], v[42:43]
  v_pk_fma_f32 v[26:27], v[42:43], v[42:43], v[26:27]
  v_lshlrev_b32 v44, 16, v70
  v_and_b32 v45, 0xffff0000, v70
  v_pk_add_f32 v[24:25], v[24:25], v[44:45]
  v_pk_fma_f32 v[26:27], v[44:45], v[44:45], v[26:27]
  v_lshlrev_b32 v46, 16, v71
  v_and_b32 v47, 0xffff0000, v71
  v_pk_add_f32 v[24:25], v[24:25], v[46:47]
  v_pk_fma_f32 v[26:27], v[46:47], v[46:47], v[26:27]
  s_waitcnt vmcnt(17)
  v_lshlrev_b32 v40, 16, v72
  v_and_b32 v41, 0xffff0000, v72
  v_pk_add_f32 v[24:25], v[24:25], v[40:41]
  v_pk_fma_f32 v[26:27], v[40:41], v[40:41], v[26:27]
  v_lshlrev_b32 v42, 16, v73
  v_and_b32 v43, 0xffff0000, v73
  v_pk_add_f32 v[24:25], v[24:25], v[42:43]
  v_pk_fma_f32 v[26:27], v[42:43], v[42:43], v[26:27]
  v_lshlrev_b32 v44, 16, v74
  v_and_b32 v45, 0xffff0000, v74
  v_pk_add_f32 v[24:25], v[24:25], v[44:45]
  v_pk_fma_f32 v[26:27], v[44:45], v[44:45], v[26:27]
  v_lshlrev_b32 v46, 16, v75
  v_and_b32 v47, 0xffff0000, v75
  v_pk_add_f32 v[24:25], v[24:25], v[46:47]
  v_pk_fma_f32 v[26:27], v[46:47], v[46:47], v[26:27]
  s_waitcnt vmcnt(16)
  v_lshlrev_b32 v40, 16, v76
  v_and_b32 v41, 0xffff0000, v76
  v_pk_add_f32 v[24:25], v[24:25], v[40:41]
  v_pk_fma_f32 v[26:27], v[40:41], v[40:41], v[26:27]
  v_lshlrev_b32 v42, 16, v77
  v_and_b32 v43, 0xffff0000, v77
  v_pk_add_f32 v[24:25], v[24:25], v[42:43]
  v_pk_fma_f32 v[26:27], v[42:43], v[42:43], v[26:27]
  v_lshlrev_b32 v44, 16, v78
  v_and_b32 v45, 0xffff0000, v78
  v_pk_add_f32 v[24:25], v[24:25], v[44:45]
  v_pk_fma_f32 v[26:27], v[44:45], v[44:45], v[26:27]
  v_lshlrev_b32 v46, 16, v79
  v_and_b32 v47, 0xffff0000, v79
  v_pk_add_f32 v[24:25], v[24:25], v[46:47]
  v_pk_fma_f32 v[26:27], v[46:47], v[46:47], v[26:27]
  s_waitcnt vmcnt(15)
  v_lshlrev_b32 v40, 16, v80
  v_and_b32 v41, 0xffff0000, v80
  v_pk_add_f32 v[24:25], v[24:25], v[40:41]
  v_pk_fma_f32 v[26:27], v[40:41], v[40:41], v[26:27]
  v_lshlrev_b32 v42, 16, v81
  v_and_b32 v43, 0xffff0000, v81
  v_pk_add_f32 v[24:25], v[24:25], v[42:43]
  v_pk_fma_f32 v[26:27], v[42:43], v[42:43], v[26:27]
  v_lshlrev_b32 v44, 16, v82
  v_and_b32 v45, 0xffff0000, v82
  v_pk_add_f32 v[24:25], v[24:25], v[44:45]
  v_pk_fma_f32 v[26:27], v[44:45], v[44:45], v[26:27]
  v_lshlrev_b32 v46, 16, v83
  v_and_b32 v47, 0xffff0000, v83
  v_pk_add_f32 v[24:25], v[24:25], v[46:47]
  v_pk_fma_f32 v[26:27], v[46:47], v[46:47], v[26:27]
  s_waitcnt vmcnt(14)
  v_lshlrev_b32 v40, 16, v84
  v_and_b32 v41, 0xffff0000, v84
  v_pk_add_f32 v[24:25], v[24:25], v[40:41]
  v_pk_fma_f32 v[26:27], v[40:41], v[40:41], v[26:27]
  v_lshlrev_b32 v42, 16, v85
  v_and_b32 v43, 0xffff0000, v85
  v_pk_add_f32 v[24:25], v[24:25], v[42:43]
  v_pk_fma_f32 v[26:27], v[42:43], v[42:43], v[26:27]
  v_lshlrev_b32 v44, 16, v86
  v_and_b32 v45, 0xffff0000, v86
  v_pk_add_f32 v[24:25], v[24:25], v[44:45]
  v_pk_fma_f32 v[26:27], v[44:45], v[44:45], v[26:27]
  v_lshlrev_b32 v46, 16, v87
  v_and_b32 v47, 0xffff0000, v87
  v_pk_add_f32 v[24:25], v[24:25], v[46:47]
  v_pk_fma_f32 v[26:27], v[46:47], v[46:47], v[26:27]
  s_waitcnt vmcnt(13)
  v_lshlrev_b32 v40, 16, v88
  v_and_b32 v41, 0xffff0000, v88
  v_pk_add_f32 v[24:25], v[24:25], v[40:41]
  v_pk_fma_f32 v[26:27], v[40:41], v[40:41], v[26:27]
  v_lshlrev_b32 v42, 16, v89
  v_and_b32 v43, 0xffff0000, v89
  v_pk_add_f32 v[24:25], v[24:25], v[42:43]
  v_pk_fma_f32 v[26:27], v[42:43], v[42:43], v[26:27]
  v_lshlrev_b32 v44, 16, v90
  v_and_b32 v45, 0xffff0000, v90
  v_pk_add_f32 v[24:25], v[24:25], v[44:45]
  v_pk_fma_f32 v[26:27], v[44:45], v[44:45], v[26:27]
  v_lshlrev_b32 v46, 16, v91
  v_and_b32 v47, 0xffff0000, v91
  v_pk_add_f32 v[24:25], v[24:25], v[46:47]
  v_pk_fma_f32 v[26:27], v[46:47], v[46:47], v[26:27]
  s_waitcnt vmcnt(12)
  v_lshlrev_b32 v40, 16, v92
  v_and_b32 v41, 0xffff0000, v92
  v_pk_add_f32 v[24:25], v[24:25], v[40:41]
  v_pk_fma_f32 v[26:27], v[40:41], v[40:41], v[26:27]
  v_lshlrev_b32 v42, 16, v93
  v_and_b32 v43, 0xffff0000, v93
  v_pk_add_f32 v[24:25], v[24:25], v[42:43]
  v_pk_fma_f32 v[26:27], v[42:43], v[42:43], v[26:27]
  v_lshlrev_b32 v44, 16, v94
  v_and_b32 v45, 0xffff0000, v94
  v_pk_add_f32 v[24:25], v[24:25], v[44:45]
  v_pk_fma_f32 v[26:27], v[44:45], v[44:45], v[26:27]
  v_lshlrev_b32 v46, 16, v95
  v_and_b32 v47, 0xffff0000, v95
  v_pk_add_f32 v[24:25], v[24:25], v[46:47]
  v_pk_fma_f32 v[26:27], v[46:47], v[46:47], v[26:27]
  s_waitcnt vmcnt(11)
  v_lshlrev_b32 v40, 16, v96
  v_and_b32 v41, 0xffff0000, v96
  v_pk_add_f32 v[24:25], v[24:25], v[40:41]
  v_pk_fma_f32 v[26:27], v[40:41], v[40:41], v[26:27]
  v_lshlrev_b32 v42, 16, v97
  v_and_b32 v43, 0xffff0000, v97
  v_pk_add_f32 v[24:25], v[24:25], v[42:43]
  v_pk_fma_f32 v[26:27], v[42:43], v[42:43], v[26:27]
  v_lshlrev_b32 v44, 16, v98
  v_and_b32 v45, 0xffff0000, v98
  v_pk_add_f32 v[24:25], v[24:25], v[44:45]
  v_pk_fma_f32 v[26:27], v[44:45], v[44:45], v[26:27]
  v_lshlrev_b32 v46, 16, v99
  v_and_b32 v47, 0xffff0000, v99
  v_pk_add_f32 v[24:25], v[24:25], v[46:47]
  v_pk_fma_f32 v[26:27], v[46:47], v[46:47], v[26:27]
  s_waitcnt vmcnt(10)
  v_lshlrev_b32 v40, 16, v100
  v_and_b32 v41, 0xffff0000, v100
  v_pk_add_f32 v[24:25], v[24:25], v[40:41]
  v_pk_fma_f32 v[26:27], v[40:41], v[40:41], v[26:27]
  v_lshlrev_b32 v42, 16, v101
  v_and_b32 v43, 0xffff0000, v101
  v_pk_add_f32 v[24:25], v[24:25], v[42:43]
  v_pk_fma_f32 v[26:27], v[42:43], v[42:43], v[26:27]
  v_lshlrev_b32 v44, 16, v102
  v_and_b32 v45, 0xffff0000, v102
  v_pk_add_f32 v[24:25], v[24:25], v[44:45]
  v_pk_fma_f32 v[26:27], v[44:45], v[44:45], v[26:27]
  v_lshlrev_b32 v46, 16, v103
  v_and_b32 v47, 0xffff0000, v103
  v_pk_add_f32 v[24:25], v[24:25], v[46:47]
  v_pk_fma_f32 v[26:27], v[46:47], v[46:47], v[26:27]
  s_waitcnt vmcnt(9)
  v_lshlrev_b32 v40, 16, v104
  v_and_b32 v41, 0xffff0000, v104
  v_pk_add_f32 v[28:29], v[28:29], v[40:41]
  v_pk_fma_f32 v[30:31], v[40:41], v[40:41], v[30:31]
  v_lshlrev_b32 v42, 16, v105
  v_and_b32 v43, 0xffff0000, v105
  v_pk_add_f32 v[28:29], v[28:29], v[42:43]
  v_pk_fma_f32 v[30:31], v[42:43], v[42:43], v[30:31]
  v_lshlrev_b32 v44, 16, v106
  v_and_b32 v45, 0xffff0000, v106
  v_pk_add_f32 v[28:29], v[28:29], v[44:45]
  v_pk_fma_f32 v[30:31], v[44:45], v[44:45], v[30:31]
  v_lshlrev_b32 v46, 16, v107
  v_and_b32 v47, 0xffff0000, v107
  v_pk_add_f32 v[28:29], v[28:29], v[46:47]
  v_pk_fma_f32 v[30:31], v[46:47], v[46:47], v[30:31]
  s_waitcnt vmcnt(8)
  v_lshlrev_b32 v40, 16, v108
  v_and_b32 v41, 0xffff0000, v108
  v_pk_add_f32 v[28:29], v[28:29], v[40:41]
  v_pk_fma_f32 v[30:31], v[40:41], v[40:41], v[30:31]
  v_lshlrev_b32 v42, 16, v109
  v_and_b32 v43, 0xffff0000, v109
  v_pk_add_f32 v[28:29], v[28:29], v[42:43]
  v_pk_fma_f32 v[30:31], v[42:43], v[42:43], v[30:31]
  v_lshlrev_b32 v44, 16, v110
  v_and_b32 v45, 0xffff0000, v110
  v_pk_add_f32 v[28:29], v[28:29], v[44:45]
  v_pk_fma_f32 v[30:31], v[44:45], v[44:45], v[30:31]
  v_lshlrev_b32 v46, 16, v111
  v_and_b32 v47, 0xffff0000, v111
  v_pk_add_f32 v[28:29], v[28:29], v[46:47]
  v_pk_fma_f32 v[30:31], v[46:47], v[46:47], v[30:31]
  s_waitcnt vmcnt(7)
  v_lshlrev_b32 v40, 16, v112
  v_and_b32 v41, 0xffff0000, v112
  v_pk_add_f32 v[28:29], v[28:29], v[40:41]
  v_pk_fma_f32 v[30:31], v[40:41], v[40:41], v[30:31]
  v_lshlrev_b32 v42, 16, v113
  v_and_b32 v43, 0xffff0000, v113
  v_pk_add_f32 v[28:29], v[28:29], v[42:43]
  v_pk_fma_f32 v[30:31], v[42:43], v[42:43], v[30:31]
  v_lshlrev_b32 v44, 16, v114
  v_and_b32 v45, 0xffff0000, v114
  v_pk_add_f32 v[28:29], v[28:29], v[44:45]
  v_pk_fma_f32 v[30:31], v[44:45], v[44:45], v[30:31]
  v_lshlrev_b32 v46, 16, v115
  v_and_b32 v47, 0xffff0000, v115
  v_pk_add_f32 v[28:29], v[28:29], v[46:47]
  v_pk_fma_f32 v[30:31], v[46:47], v[46:47], v[30:31]
  s_waitcnt vmcnt(6)
  v_lshlrev_b32 v40, 16, v116
  v_and_b32 v41, 0xffff0000, v116
  v_pk_add_f32 v[28:29], v[28:29], v[40:41]
  v_pk_fma_f32 v[30:31], v[40:41], v[40:41], v[30:31]
  v_lshlrev_b32 v42, 16, v117
  v_and_b32 v43, 0xffff0000, v117
  v_pk_add_f32 v[28:29], v[28:29], v[42:43]
  v_pk_fma_f32 v[30:31], v[42:43], v[42:43], v[30:31]
  v_lshlrev_b32 v44, 16, v118
  v_and_b32 v45, 0xffff0000, v118
  v_pk_add_f32 v[28:29], v[28:29], v[44:45]
  v_pk_fma_f32 v[30:31], v[44:45], v[44:45], v[30:31]
  v_lshlrev_b32 v46, 16, v119
  v_and_b32 v47, 0xffff0000, v119
  v_pk_add_f32 v[28:29], v[28:29], v[46:47]
  v_pk_fma_f32 v[30:31], v[46:47], v[46:47], v[30:31]
  s_waitcnt vmcnt(5)
  v_lshlrev_b32 v40, 16, v120
  v_and_b32 v41, 0xffff0000, v120
  v_pk_add_f32 v[28:29], v[28:29], v[40:41]
  v_pk_fma_f32 v[30:31], v[40:41], v[40:41], v[30:31]
  v_lshlrev_b32 v42, 16, v121
  v_and_b32 v43, 0xffff0000, v121
  v_pk_add_f32 v[28:29], v[28:29], v[42:43]
  v_pk_fma_f32 v[30:31], v[42:43], v[42:43], v[30:31]
  v_lshlrev_b32 v44, 16, v122
  v_and_b32 v45, 0xffff0000, v122
  v_pk_add_f32 v[28:29], v[28:29], v[44:45]
  v_pk_fma_f32 v[30:31], v[44:45], v[44:45], v[30:31]
  v_lshlrev_b32 v46, 16, v123
  v_and_b32 v47, 0xffff0000, v123
  v_pk_add_f32 v[28:29], v[28:29], v[46:47]
  v_pk_fma_f32 v[30:31], v[46:47], v[46:47], v[30:31]
  s_waitcnt vmcnt(4)
  v_lshlrev_b32 v40, 16, v124
  v_and_b32 v41, 0xffff0000, v124
  v_pk_add_f32 v[28:29], v[28:29], v[40:41]
  v_pk_fma_f32 v[30:31], v[40:41], v[40:41], v[30:31]
  v_lshlrev_b32 v42, 16, v125
  v_and_b32 v43, 0xffff0000, v125
  v_pk_add_f32 v[28:29], v[28:29], v[42:43]
  v_pk_fma_f32 v[30:31], v[42:43], v[42:43], v[30:31]
  v_lshlrev_b32 v44, 16, v126
  v_and_b32 v45, 0xffff0000, v126
  v_pk_add_f32 v[28:29], v[28:29], v[44:45]
  v_pk_fma_f32 v[30:31], v[44:45], v[44:45], v[30:31]
  v_lshlrev_b32 v46, 16, v127
  v_and_b32 v47, 0xffff0000, v127
  v_pk_add_f32 v[28:29], v[28:29], v[46:47]
  v_pk_fma_f32 v[30:31], v[46:47], v[46:47], v[30:31]
  s_waitcnt vmcnt(3)
  v_lshlrev_b32 v40, 16, v128
  v_and_b32 v41, 0xffff0000, v128
  v_pk_add_f32 v[28:29], v[28:29], v[40:41]
  v_pk_fma_f32 v[30:31], v[40:41], v[40:41], v[30:31]
  v_lshlrev_b32 v42, 16, v129
  v_and_b32 v43, 0xffff0000, v129
  v_pk_add_f32 v[28:29], v[28:29], v[42:43]
  v_pk_fma_f32 v[30:31], v[42:43], v[42:43], v[30:31]
  v_lshlrev_b32 v44, 16, v130
  v_and_b32 v45, 0xffff0000, v130
  v_pk_add_f32 v[28:29], v[28:29], v[44:45]
  v_pk_fma_f32 v[30:31], v[44:45], v[44:45], v[30:31]
  v_lshlrev_b32 v46, 16, v131
  v_and_b32 v47, 0xffff0000, v131
  v_pk_add_f32 v[28:29], v[28:29], v[46:47]
  v_pk_fma_f32 v[30:31], v[46:47], v[46:47], v[30:31]
  s_waitcnt vmcnt(2)
  v_lshlrev_b32 v40, 16, v132
  v_and_b32 v41, 0xffff0000, v132
  v_pk_add_f32 v[28:29], v[28:29], v[40:41]
  v_pk_fma_f32 v[30:31], v[40:41], v[40:41], v[30:31]
  v_lshlrev_b32 v42, 16, v133
  v_and_b32 v43, 0xffff0000, v133
  v_pk_add_f32 v[28:29], v[28:29], v[42:43]
  v_pk_fma_f32 v[30:31], v[42:43], v[42:43], v[30:31]
  v_lshlrev_b32 v44, 16, v134
  v_and_b32 v45, 0xffff0000, v134
  v_pk_add_f32 v[28:29], v[28:29], v[44:45]
  v_pk_fma_f32 v[30:31], v[44:45], v[44:45], v[30:31]
  v_lshlrev_b32 v46, 16, v135
  v_and_b32 v47, 0xffff0000, v135
  v_pk_add_f32 v[28:29], v[28:29], v[46:47]
  v_pk_fma_f32 v[30:31], v[46:47], v[46:47], v[30:31]
  s_waitcnt vmcnt(1)
  v_lshlrev_b32 v40, 16, v136
  v_and_b32 v41, 0xffff0000, v136
  v_pk_add_f32 v[28:29], v[28:29], v[40:41]
  v_pk_fma_f32 v[30:31], v[40:41], v[40:41], v[30:31]
  v_lshlrev_b32 v42, 16, v137
  v_and_b32 v43, 0xffff0000, v137
  v_pk_add_f32 v[28:29], v[28:29], v[42:43]
  v_pk_fma_f32 v[30:31], v[42:43], v[42:43], v[30:31]
  v_lshlrev_b32 v44, 16, v138
  v_and_b32 v45, 0xffff0000, v138
  v_pk_add_f32 v[28:29], v[28:29], v[44:45]
  v_pk_fma_f32 v[30:31], v[44:45], v[44:45], v[30:31]
  v_lshlrev_b32 v46, 16, v139
  v_and_b32 v47, 0xffff0000, v139
  v_pk_add_f32 v[28:29], v[28:29], v[46:47]
  v_pk_fma_f32 v[30:31], v[46:47], v[46:47], v[30:31]
  s_waitcnt vmcnt(0)
  v_lshlrev_b32 v40, 16, v140
  v_and_b32 v41, 0xffff0000, v140
  v_pk_add_f32 v[28:29], v[28:29], v[40:41]
  v_pk_fma_f32 v[30:31], v[40:41], v[40:41], v[30:31]
  v_lshlrev_b32 v42, 16, v141
  v_and_b32 v43, 0xffff0000, v141
  v_pk_add_f32 v[28:29], v[28:29], v[42:43]
  v_pk_fma_f32 v[30:31], v[42:43], v[42:43], v[30:31]
  v_lshlrev_b32 v44, 16, v142
  v_and_b32 v45, 0xffff0000, v142
  v_pk_add_f32 v[28:29], v[28:29], v[44:45]
  v_pk_fma_f32 v[30:31], v[44:45], v[44:45], v[30:31]
  v_lshlrev_b32 v46, 16, v143
  v_and_b32 v47, 0xffff0000, v143
  v_pk_add_f32 v[28:29], v[28:29], v[46:47]
  v_pk_fma_f32 v[30:31], v[46:47], v[46:47], v[30:31]
  v_add_f32 v24, v24, v25
  v_add_f32 v26, v26, v27
  v_add_f32 v28, v28, v29
  v_add_f32 v30, v30, v31
  s_nop 1
  v_add_f32_dpp v24, v24, v24 quad_perm:[1,0,3,2] row_mask:0xf bank_mask:0xf
  v_add_f32_dpp v26, v26, v26 quad_perm:[1,0,3,2] row_mask:0xf bank_mask:0xf
  v_add_f32_dpp v28, v28, v28 quad_perm:[1,0,3,2] row_mask:0xf bank_mask:0xf
  v_add_f32_dpp v30, v30, v30 quad_perm:[1,0,3,2] row_mask:0xf bank_mask:0xf
  s_nop 1
  v_add_f32_dpp v24, v24, v24 quad_perm:[2,3,0,1] row_mask:0xf bank_mask:0xf
  v_add_f32_dpp v26, v26, v26 quad_perm:[2,3,0,1] row_mask:0xf bank_mask:0xf
  v_add_f32_dpp v28, v28, v28 quad_perm:[2,3,0,1] row_mask:0xf bank_mask:0xf
  v_add_f32_dpp v30, v30, v30 quad_perm:[2,3,0,1] row_mask:0xf bank_mask:0xf
  s_nop 1
  v_add_f32_dpp v24, v24, v24 row_half_mirror row_mask:0xf bank_mask:0xf
  v_add_f32_dpp v26, v26, v26 row_half_mirror row_mask:0xf bank_mask:0xf
  v_add_f32_dpp v28, v28, v28 row_half_mirror row_mask:0xf bank_mask:0xf
  v_add_f32_dpp v30, v30, v30 row_half_mirror row_mask:0xf bank_mask:0xf
  s_mov_b32 s30, 0x3acccccd
  s_mov_b32 s31, 0x3727c5ac
  v_mul_f32 v24, s30, v24
  v_mul_f32 v26, s30, v26
  v_mul_f32 v28, s30, v28
  v_mul_f32 v30, s30, v30
  v_fma_f32 v26, -v24, v24, v26
  v_fma_f32 v30, -v28, v28, v30
  v_max_f32 v26, 0, v26
  v_max_f32 v30, 0, v30
  v_add_f32 v26, s31, v26
  v_add_f32 v30, s31, v30
  v_rsq_f32 v25, v26
  v_rsq_f32 v29, v30
  s_add_u32 s12, s60, 0x00f00000
  s_addc_u32 s13, s61, 0
  s_mov_b32 s14, 0x00004000
  s_mov_b32 s15, 0x00020000

  v_lshlrev_b32 v5, 3, v5
  v_cmp_eq_u32 vcc, 0, v7
  s_nop 1
  s_and_saveexec_b64 s[36:37], vcc
  buffer_store_dwordx2 v[24:25], v5, s[12:15], 0 offen sc1
  buffer_store_dwordx2 v[28:29], v5, s[12:15], 0 offen offset:64 sc1
  s_mov_b64 exec, s[36:37]
  s_waitcnt vmcnt(0)
  s_barrier

  v_mov_b32 v6, 160020
  ds_read_b32 v7, v6
  s_waitcnt lgkmcnt(0)
  v_readfirstlane_b32 s101, v7
  s_nop 3

  s_cmp_eq_u32 s22, 0
  s_cbranch_scc0 L_ist2_nosig

  s_lshl_b32 s3, s62, 7
  s_add_u32 s3, s3, 0x07003000

  s_lshl_b32 s30, s63, 2
  s_add_u32 s30, s30, s3
  v_mov_b32 v6, s30
  v_mov_b32 v7, s101
  s_mov_b64 exec, 1

  global_store_dword v6, v7, s[60:61] sc1
  s_mov_b64 exec, -1
L_ist2_nosig:
  s_mov_b32 s64, 0xffffffff
  s_mov_b32 s65, 0xfffffff0
  s_mov_b32 s66, 0xfffffffe
  s_mov_b32 s67, 0xffffffe0
  s_mov_b32 s68, 0xfffffffc
  s_mov_b32 s69, 0xffffffc0
  s_mov_b32 s70, 0xfffffff8
  s_mov_b32 s71, 0xffffff80
  s_mov_b32 s72, 0xffffff00
  s_mov_b32 s73, 0xfffff000
  s_mov_b32 s74, 0xfffffe00
  s_mov_b32 s75, 0xffffe000
  s_mov_b32 s76, 0xfffffc00
  s_mov_b32 s77, 0xffffc000
  s_mov_b32 s78, 0xfffff800
  s_mov_b32 s79, 0xffff8000
  s_mov_b32 s80, 0xffff0000
  s_mov_b32 s81, 0xfff00000
  s_mov_b32 s82, 0xfffe0000
  s_mov_b32 s83, 0xffe00000
  s_mov_b32 s84, 0xfffc0000
  s_mov_b32 s85, 0xffc00000
  s_mov_b32 s86, 0xfff80000
  s_mov_b32 s87, 0xff800000
  s_mov_b32 s88, 0xff000000
  s_mov_b32 s89, 0xf0000000
  s_mov_b32 s90, 0xfe000000
  s_mov_b32 s91, 0xe0000000
  s_mov_b32 s92, 0xfc000000
  s_mov_b32 s93, 0xc0000000
  s_mov_b32 s94, 0xf8000000
  s_mov_b32 s95, 0x80000000
  s_cmp_eq_u32 s22, 7
  s_cbranch_scc0 L_l1_notab

  v_mov_b32 v6, 160020
  ds_read_b32 v7, v6
  v_and_b32 v5, 31, v0
  v_lshlrev_b32 v8, 2, v5
  s_lshl_b32 s35, s62, 7
  s_add_u32 s35, s35, 0x06f00000
  v_add_u32 v8, s35, v8
  s_mov_b32 s25, 400000
  s_waitcnt lgkmcnt(0)
  v_readfirstlane_b32 s38, v7
  s_nop 3
  s_mov_b32 s101, s38
L_tab2_tpoll:
  global_load_dword v9, v8, s[60:61] sc1
  s_waitcnt vmcnt(0)
  v_xor_b32 v10, s38, v9
  v_subrev_u32 v11, 1, v10
  v_cmp_lt_u32 vcc, 15, v11
  s_cmp_eq_u64 vcc, 0
  s_cbranch_scc1 L_tab2_tok
  s_sleep 2
  s_sub_u32 s25, s25, 1
  s_cmp_eq_u32 s25, 0
  s_cbranch_scc0 L_tab2_tpoll
  s_mov_b32 s35, 3
  s_branch L_tab2_tw
L_tab2_tok:
  s_getreg_b32 s35, hwreg(HW_REG_XCC_ID)
  s_and_b32 s35, s35, 15
  v_cmp_ne_u32 vcc, s35, v11
  s_cmp_eq_u64 vcc, 0
  s_cselect_b32 s35, 0, 1
L_tab2_tw:
  v_mov_b32 v6, 160016
  v_mov_b32 v7, s35
  ds_write_b32 v6, v7
  s_waitcnt lgkmcnt(0)

L_l1_notab:
  s_barrier

  v_mov_b32 v6, 160016
  ds_read_b64 v[6:7], v6
  s_waitcnt lgkmcnt(0)
  v_readfirstlane_b32 s46, v6
  v_readfirstlane_b32 s101, v7
  s_nop 3
  s_lshr_b32 s97, s46, 1
  s_and_b32 s46, s46, 1

  s_cmp_eq_u32 s21, 15
  s_cbranch_scc1 L_l1_idle
  s_branch L_l1_tail
L_l_layer:
  s_cmp_eq_u32 s21, 15
  s_cbranch_scc1 L_l1_idle
  s_add_u32 m0, s34, 81920
  s_mov_b32 s27, 0
  buffer_load_dwordx4 v10, s[4:7], s27 offen offset:0 sc1 lds
  buffer_load_dwordx4 v10, s[4:7], s27 offen offset:1024 sc1 lds
  buffer_load_dwordx4 v11, s[4:7], s27 offen offset:2048 sc1 lds
  buffer_load_dwordx4 v11, s[4:7], s27 offen offset:3072 sc1 lds
  s_add_u32 m0, s34, 98304
  s_mov_b32 s27, 2048
  buffer_load_dwordx4 v10, s[4:7], s27 offen offset:0 sc1 lds
  buffer_load_dwordx4 v10, s[4:7], s27 offen offset:1024 sc1 lds
  buffer_load_dwordx4 v11, s[4:7], s27 offen offset:2048 sc1 lds
  buffer_load_dwordx4 v11, s[4:7], s27 offen offset:3072 sc1 lds
  s_add_u32 m0, s34, 114688
  s_mov_b32 s27, 4096
  buffer_load_dwordx4 v10, s[4:7], s27 offen offset:0 sc1 lds
  buffer_load_dwordx4 v10, s[4:7], s27 offen offset:1024 sc1 lds
  buffer_load_dwordx4 v11, s[4:7], s27 offen offset:2048 sc1 lds
  buffer_load_dwordx4 v11, s[4:7], s27 offen offset:3072 sc1 lds
  s_add_u32 m0, s34, 49152
  s_mov_b32 s28, 737280
  buffer_load_dwordx4 v14, s[8:11], s28 offen offset:0 lds
  buffer_load_dwordx4 v15, s[8:11], s28 offen offset:1024 lds
  buffer_load_dwordx4 v16, s[8:11], s28 offen offset:2048 lds
  buffer_load_dwordx4 v17, s[8:11], s28 offen offset:3072 lds
  s_add_u32 m0, s34, 65536
  s_mov_b32 s28, 983040
  buffer_load_dwordx4 v14, s[8:11], s28 offen offset:0 lds
  buffer_load_dwordx4 v15, s[8:11], s28 offen offset:1024 lds
  buffer_load_dwordx4 v16, s[8:11], s28 offen offset:2048 lds
  buffer_load_dwordx4 v17, s[8:11], s28 offen offset:3072 lds
  s_waitcnt vmcnt(16)
  s_barrier
  s_mul_i32 s30, s23, 5120
  s_add_u32 m0, s30, 131072
  s_mov_b32 s27, 0
  buffer_load_dwordx4 v18, s[16:19], s27 offen sc1 lds
  s_add_u32 m0, m0, 1024
  s_mov_b32 s27, 16384
  buffer_load_dwordx4 v18, s[16:19], s27 offen sc1 lds
  s_add_u32 m0, m0, 1024
  s_mov_b32 s27, 32768
  buffer_load_dwordx4 v18, s[16:19], s27 offen sc1 lds
  s_add_u32 m0, m0, 1024
  s_mov_b32 s27, 49152
  buffer_load_dwordx4 v18, s[16:19], s27 offen sc1 lds
  s_add_u32 m0, m0, 1024
  s_mov_b32 s27, 65536
  buffer_load_dwordx4 v18, s[16:19], s27 offen sc1 lds
  s_add_u32 m0, m0, 1024
  s_waitcnt vmcnt(17)
  s_barrier
  s_add_u32 m0, s34, 81920
  s_mov_b32 s27, 6144
  buffer_load_dwordx4 v10, s[4:7], s27 offen offset:0 sc1 lds
  buffer_load_dwordx4 v10, s[4:7], s27 offen offset:1024 sc1 lds
  buffer_load_dwordx4 v11, s[4:7], s27 offen offset:2048 sc1 lds
  buffer_load_dwordx4 v11, s[4:7], s27 offen offset:3072 sc1 lds
  s_add_u32 m0, s34, 0
  s_mov_b32 s28, 1228800
  buffer_load_dwordx4 v14, s[8:11], s28 offen offset:0 lds
  buffer_load_dwordx4 v15, s[8:11], s28 offen offset:1024 lds
  buffer_load_dwordx4 v16, s[8:11], s28 offen offset:2048 lds
  buffer_load_dwordx4 v17, s[8:11], s28 offen offset:3072 lds
  s_waitcnt vmcnt(21)
  s_barrier
  s_add_u32 m0, s34, 98304
  s_mov_b32 s27, 8192
  buffer_load_dwordx4 v10, s[4:7], s27 offen offset:0 sc1 lds
  buffer_load_dwordx4 v10, s[4:7], s27 offen offset:1024 sc1 lds
  buffer_load_dwordx4 v11, s[4:7], s27 offen offset:2048 sc1 lds
  buffer_load_dwordx4 v11, s[4:7], s27 offen offset:3072 sc1 lds
  s_add_u32 m0, s34, 16384
  s_mov_b32 s28, 1474560
  buffer_load_dwordx4 v14, s[8:11], s28 offen offset:0 lds
  buffer_load_dwordx4 v15, s[8:11], s28 offen offset:1024 lds
  buffer_load_dwordx4 v16, s[8:11], s28 offen offset:2048 lds
  buffer_load_dwordx4 v17, s[8:11], s28 offen offset:3072 lds
  s_waitcnt vmcnt(12)
  s_barrier
  s_add_u32 m0, s34, 114688
  s_mov_b32 s27, 10240
  buffer_load_dwordx4 v10, s[4:7], s27 offen offset:0 sc1 lds
  buffer_load_dwordx4 v10, s[4:7], s27 offen offset:1024 sc1 lds
  buffer_load_dwordx4 v11, s[4:7], s27 offen offset:2048 sc1 lds
  buffer_load_dwordx4 v11, s[4:7], s27 offen offset:3072 sc1 lds
  s_add_u32 m0, s34, 32768
  s_mov_b32 s28, 1720320
  buffer_load_dwordx4 v14, s[8:11], s28 offen offset:0 lds
  buffer_load_dwordx4 v15, s[8:11], s28 offen offset:1024 lds
  buffer_load_dwordx4 v16, s[8:11], s28 offen offset:2048 lds
  buffer_load_dwordx4 v17, s[8:11], s28 offen offset:3072 lds
  s_waitcnt vmcnt(12)
  s_barrier
  s_add_u32 m0, s34, 81920
  s_mov_b32 s27, 12288
  buffer_load_dwordx4 v10, s[4:7], s27 offen offset:0 sc1 lds
  buffer_load_dwordx4 v10, s[4:7], s27 offen offset:1024 sc1 lds
  buffer_load_dwordx4 v11, s[4:7], s27 offen offset:2048 sc1 lds
  buffer_load_dwordx4 v11, s[4:7], s27 offen offset:3072 sc1 lds
  s_add_u32 m0, s34, 49152
  s_mov_b32 s28, 1966080
  buffer_load_dwordx4 v14, s[8:11], s28 offen offset:0 lds
  buffer_load_dwordx4 v15, s[8:11], s28 offen offset:1024 lds
  buffer_load_dwordx4 v16, s[8:11], s28 offen offset:2048 lds
  buffer_load_dwordx4 v17, s[8:11], s28 offen offset:3072 lds
  s_waitcnt vmcnt(12)
  s_barrier
  s_add_u32 m0, s34, 98304
  s_mov_b32 s27, 14336
  buffer_load_dwordx4 v10, s[4:7], s27 offen offset:0 sc1 lds
  buffer_load_dwordx4 v10, s[4:7], s27 offen offset:1024 sc1 lds
  buffer_load_dwordx4 v11, s[4:7], s27 offen offset:2048 sc1 lds
  buffer_load_dwordx4 v11, s[4:7], s27 offen offset:3072 sc1 lds
  s_add_u32 m0, s34, 65536
  s_mov_b32 s28, 2211840
  buffer_load_dwordx4 v14, s[8:11], s28 offen offset:0 lds
  buffer_load_dwordx4 v15, s[8:11], s28 offen offset:1024 lds
  buffer_load_dwordx4 v16, s[8:11], s28 offen offset:2048 lds
  buffer_load_dwordx4 v17, s[8:11], s28 offen offset:3072 lds
  s_waitcnt vmcnt(12)
  s_barrier
  s_add_u32 m0, s34, 114688
  s_mov_b32 s27, 16384
  buffer_load_dwordx4 v10, s[4:7], s27 offen offset:0 sc1 lds
  buffer_load_dwordx4 v10, s[4:7], s27 offen offset:1024 sc1 lds
  buffer_load_dwordx4 v11, s[4:7], s27 offen offset:2048 sc1 lds
  buffer_load_dwordx4 v11, s[4:7], s27 offen offset:3072 sc1 lds
  s_waitcnt vmcnt(8)
  s_barrier
  s_add_u32 m0, s34, 81920
  s_mov_b32 s27, 18432
  buffer_load_dwordx4 v10, s[4:7], s27 offen offset:0 sc1 lds
  buffer_load_dwordx4 v10, s[4:7], s27 offen offset:1024 sc1 lds
  buffer_load_dwordx4 v11, s[4:7], s27 offen offset:2048 sc1 lds
  buffer_load_dwordx4 v11, s[4:7], s27 offen offset:3072 sc1 lds

  s_lshl_b32 s30, s23, 7
  v_and_b32 v5, 31, v2
  v_lshl_add_u32 v5, v5, 2, s30
  v_lshrrev_b32 v6, 5, v2
  v_lshl_add_u32 v5, v6, 9, v5
  v_add_u32 v5, 131072, v5

  ds_read_b32 v24, v5 offset:0
  ds_read_b32 v25, v5 offset:1024
  ds_read_b32 v26, v5 offset:2048
  ds_read_b32 v27, v5 offset:3072
  ds_read_b32 v28, v5 offset:4096
  ds_read_b32 v29, v5 offset:5120
  ds_read_b32 v30, v5 offset:6144
  ds_read_b32 v31, v5 offset:7168
  ds_read_b32 v32, v5 offset:8192
  ds_read_b32 v33, v5 offset:9216
  ds_read_b32 v34, v5 offset:10240
  ds_read_b32 v35, v5 offset:11264
  ds_read_b32 v36, v5 offset:12288
  ds_read_b32 v37, v5 offset:13312
  ds_read_b32 v38, v5 offset:14336
  ds_read_b32 v39, v5 offset:15360
  ds_read_b32 v40, v5 offset:16384
  ds_read_b32 v41, v5 offset:17408
  ds_read_b32 v42, v5 offset:18432
  ds_read_b32 v43, v5 offset:19456
  s_waitcnt lgkmcnt(0)
  v_add_f32 v24, v24, v25
  v_add_f32 v26, v26, v27
  v_add_f32 v28, v28, v29
  v_add_f32 v30, v30, v31
  v_add_f32 v32, v32, v33
  v_add_f32 v34, v34, v35
  v_add_f32 v36, v36, v37
  v_add_f32 v38, v38, v39
  v_add_f32 v40, v40, v41
  v_add_f32 v42, v42, v43
  v_add_f32 v24, v24, v26
  v_add_f32 v24, v24, v28
  v_add_f32 v24, v24, v30
  v_add_f32 v24, v24, v32
  v_add_f32 v24, v24, v34
  v_add_f32 v24, v24, v36
  v_add_f32 v24, v24, v38
  v_add_f32 v24, v24, v40
  v_add_f32 v24, v24, v42

  v_mov_b32 v25, v24
  s_nop 1
  v_permlane32_swap_b32 v24, v25
  s_mov_b32 s30, 0x3acccccd
  s_mov_b32 s31, 0x3727c5ac
  v_mul_f32 v24, s30, v24
  v_mul_f32 v25, s30, v25
  v_fma_f32 v25, -v24, v24, v25
  v_max_f32 v25, 0, v25
  v_add_f32 v26, s31, v25
  v_rsq_f32 v27, v26
  s_nop 0

  v_mov_b32 v25, v27
  s_lshl_b32 s30, s23, 8
  s_add_u32 s30, s30, 161280
  v_and_b32 v5, 31, v2
  v_lshl_add_u32 v5, v5, 3, s30
  s_mov_b32 exec_hi, 0
  ds_write_b64 v5, v[24:25]
  s_mov_b32 exec_hi, -1
  s_waitcnt lgkmcnt(0)

  s_waitcnt vmcnt(4)
  s_barrier
  s_waitcnt vmcnt(0)
  s_barrier
  s_barrier
  s_branch L_l1_tail
L_l1_idle:
  s_cmp_eq_u32 s96, 0
  s_cbranch_scc0 L_ip1_l
  s_sub_u32 s29, s63, 30
  s_lshl_b32 s29, s29, 3
  s_add_u32 s29, s29, s22
  s_cmp_eq_u32 s46, 0
  s_cbranch_scc0 L_tp1ol_end
  s_mul_i32 s28, s62, 327680
  s_add_u32 s12, s60, 0x00800000
  s_addc_u32 s13, s61, 0
  s_add_u32 s12, s12, s28
  s_addc_u32 s13, s13, 0
  s_mov_b32 s14, 0x00050000
  s_mov_b32 s15, 0x00020000
  v_and_b32 v2, 63, v0
  s_mov_b32 s27, s29
L_tp1ol_loop:
  s_cmp_ge_u32 s27, 40
  s_cbranch_scc1 L_tp1ol_end
  s_lshl_b32 s26, s27, 6
  v_add_u32 v5, s26, v2
  v_lshlrev_b32 v5, 7, v5
  buffer_load_dword v1, v5, s[12:15], 0 offen
  s_add_u32 s27, s27, 16
  s_branch L_tp1ol_loop
L_tp1ol_end:
L_ip1_l:
L_l1_tail:

  v_and_b32 v2, 63, v0
  v_and_b32 v3, 31, v2
  v_lshrrev_b32 v4, 5, v2
  s_and_b32 s23, s63, 1
  s_lshr_b32 s24, s63, 1
  s_mul_i32 s24, s24, 5
  s_mul_i32 s25, s23, 3
  s_add_u32 s25, s25, s24
  s_add_u32 s24, s24, 2
  s_lshl_b32 s25, s25, 15
  s_lshl_b32 s24, s24, 15
  s_lshl_b32 s30, s62, 8
  s_sub_u32 s30, s30, 256
  s_cmp_eq_u32 s62, 0
  s_cselect_b32 s32, 1, 0
  s_cmp_lt_u32 s22, 4
  s_cselect_b32 s32, s32, 0
  s_cmp_eq_u32 s32, 1
  s_cselect_b32 s30, 0, s30
  s_lshl_b32 s32, s22, 6
  s_add_u32 s30, s30, s32
  s_lshl_b32 s30, s30, 4
  v_lshl_add_u32 v22, v2, 4, s30
  s_lshl_b32 s35, s22, 10
  s_lshl_b32 s30, s62, 8
  s_lshl_b32 s32, s22, 5
  s_add_u32 s30, s30, s32
  v_add_u32 v6, s30, v3
  v_lshlrev_b32 v7, 4, v6
  v_lshl_add_u32 v10, v4, 15, v7
  s_lshl_b32 s33, s23, 3
  v_add_u32 v11, s33, v7

  s_add_u32 s4, s60, 0x00000000
  s_addc_u32 s5, s61, 0
  s_mov_b32 s6, 0x00780000
  s_mov_b32 s7, 0x00020000
  s_add_u32 s16, s60, 0x00d80000
  s_addc_u32 s17, s61, 0
  s_add_u32 s16, s16, s47
  s_addc_u32 s17, s17, 0
  s_mov_b32 s18, 0x00780000
  s_mov_b32 s19, 0x00020000
  s_add_u32 s8, s60, 0x00800000
  s_addc_u32 s9, s61, 0
  s_mov_b32 s10, 0x00280000
  s_mov_b32 s11, 0x00020000

  v_mov_b32 v9, 0
  v_cmp_gt_u32 vcc, 256, v0
  s_cmp_eq_u32 s62, 0
  s_cselect_b32 s38, 0xf149, 0
  v_mov_b32 v5, s38
  v_cndmask_b32 v8, 0, v5, vcc
  v_lshlrev_b32 v12, 4, v0
  ds_write_b64 v12, v[8:9] offset:24576
  v_mov_b32 v8, 0x3f803f80
  v_mov_b32 v9, 0x3f803f80
  v_add_u32 v12, 57536, v12
  ds_write_b64 v12, v[8:9]
  s_lshl_b32 s32, s22, 5
  v_add_u32 v12, s32, v3
  v_lshlrev_b32 v12, 4, v12
  v_lshl_add_u32 v13, v4, 13, v12
  s_lshl_b32 s33, s23, 3
  v_mov_b32 v14, s33
  v_cmp_eq_u32 vcc, 1, v4
  v_mov_b32 v9, 8192
  s_nop 0
  v_cndmask_b32 v14, v14, v9, vcc
  v_add_u32 v14, v14, v12
  v_add_u32 v14, 16384, v14
  v_and_b32 v5, 15, v2
  v_lshrrev_b32 v6, 2, v5
  v_and_b32 v7, 3, v5
  v_lshl_add_u32 v8, v4, 2, v6
  v_add_u32 v8, s32, v8
  v_lshlrev_b32 v8, 4, v8
  v_lshrrev_b32 v9, 1, v7
  v_mul_u32_u24 v9, 8256, v9
  v_and_b32 v12, 1, v7
  v_lshl_add_u32 v9, v12, 3, v9
  v_mov_b32 v12, 24768
  s_add_u32 s33, s33, 16512
  v_mov_b32 v5, s33
  v_cmp_eq_u32 vcc, 0, v7
  s_nop 1
  v_cndmask_b32 v12, v12, v5, vcc
  v_and_b32 v5, 16, v2
  v_cmp_ne_u32 vcc, 0, v5
  s_nop 1
  v_cndmask_b32 v9, v9, v12, vcc
  v_add_u32 v15, v8, v9
  v_add_u32 v15, 32768, v15
  s_lshl_b32 s30, s62, 8
  s_add_u32 s30, s30, s32
  v_add_u32 v6, s30, v3
  v_lshrrev_b32 v7, 4, v6
  s_mov_b32 s33, 20480
  v_mul_lo_u32 v7, v7, s33
  v_and_b32 v6, 15, v6
  v_lshl_add_u32 v7, v6, 4, v7
  s_lshr_b32 s34, s25, 15
  v_add_u32 v8, s34, v4
  v_lshrrev_b32 v9, 2, v8
  v_lshl_add_u32 v12, v9, 10, v7
  v_and_b32 v9, 3, v8
  v_lshl_add_u32 v24, v9, 8, v12
  s_lshr_b32 s34, s24, 15
  s_lshr_b32 s36, s34, 2
  s_lshl_b32 s36, s36, 10
  s_and_b32 s34, s34, 3
  s_lshl_b32 s34, s34, 8
  s_add_u32 s34, s34, s36
  s_lshl_b32 s36, s23, 3
  s_add_u32 s34, s34, s36
  v_add_u32 v25, s34, v7

  s_cmp_eq_u32 s96, 0
  s_cbranch_scc0 L_l1_nodrain
  s_waitcnt vmcnt(0)
L_l1_nodrain:
  s_waitcnt lgkmcnt(0)
  s_barrier
  s_barrier
  s_branch L_att
L_l_att_tail:

  s_mul_i32 s30, s63, 43
  s_lshr_b32 s21, s30, 7
  s_mul_i32 s30, s21, 3
  s_sub_u32 s30, s63, s30
  s_mul_i32 s30, s30, 6
  s_lshl_b32 s20, s62, 4
  s_add_u32 s39, s20, 16
  s_add_u32 s20, s20, s30
  s_cmp_ge_u32 s63, 30
  s_cselect_b32 s21, 15, s21

  v_and_b32 v2, 63, v0
  s_sub_u32 s23, s22, 4
  s_mul_i32 s34, s23, 3072
  v_lshlrev_b32 v5, 4, v2

  s_mul_i32 s31, s23, 3
  s_add_u32 s31, s31, 0
  s_lshr_b32 s32, s31, 1
  s_add_u32 s32, s32, s20
  s_mul_i32 s32, s32, 20480
  s_and_b32 s31, s31, 1
  s_lshl_b32 s31, s31, 10
  s_add_u32 s32, s32, s31
  s_sub_u32 s32, s32, 0
  v_add_u32 v10, s32, v5

  s_mul_i32 s31, s23, 3
  s_add_u32 s31, s31, 1
  s_lshr_b32 s32, s31, 1
  s_add_u32 s32, s32, s20
  s_mul_i32 s32, s32, 20480
  s_and_b32 s31, s31, 1
  s_lshl_b32 s31, s31, 10
  s_add_u32 s32, s32, s31
  s_sub_u32 s32, s32, 1024
  v_add_u32 v11, s32, v5

  s_mul_i32 s31, s23, 3
  s_add_u32 s31, s31, 2
  s_lshr_b32 s32, s31, 1
  s_add_u32 s32, s32, s20
  s_mul_i32 s32, s32, 20480
  s_and_b32 s31, s31, 1
  s_lshl_b32 s31, s31, 10
  s_add_u32 s32, s32, s31
  s_sub_u32 s32, s32, 2048
  v_add_u32 v12, s32, v5

  s_add_u32 s4, s60, 0x00800000
  s_addc_u32 s5, s61, 0
  s_mul_i32 s6, s39, 20480
  s_mov_b32 s7, 0x00020000
  s_waitcnt vmcnt(0) lgkmcnt(0)
  s_barrier
  s_barrier
  s_cmp_eq_u32 s21, 15
  s_cbranch_scc1 L_l3_idle
  s_add_u32 m0, s34, 0
  s_mov_b32 s27, 0
  buffer_load_dwordx4 v10, s[4:7], s27 offen offset:0 sc1 lds
  buffer_load_dwordx4 v11, s[4:7], s27 offen offset:1024 sc1 lds
  buffer_load_dwordx4 v12, s[4:7], s27 offen offset:2048 sc1 lds
  s_add_u32 m0, s34, 12288
  s_mov_b32 s27, 2048
  buffer_load_dwordx4 v10, s[4:7], s27 offen offset:0 sc1 lds
  buffer_load_dwordx4 v11, s[4:7], s27 offen offset:1024 sc1 lds
  buffer_load_dwordx4 v12, s[4:7], s27 offen offset:2048 sc1 lds
  s_add_u32 m0, s34, 24576
  s_mov_b32 s27, 4096
  buffer_load_dwordx4 v10, s[4:7], s27 offen offset:0 sc1 lds
  buffer_load_dwordx4 v11, s[4:7], s27 offen offset:1024 sc1 lds
  buffer_load_dwordx4 v12, s[4:7], s27 offen offset:2048 sc1 lds
  s_waitcnt vmcnt(6)
  s_barrier
  s_add_u32 m0, s34, 36864
  s_mov_b32 s27, 6144
  buffer_load_dwordx4 v10, s[4:7], s27 offen offset:0 sc1 lds
  buffer_load_dwordx4 v11, s[4:7], s27 offen offset:1024 sc1 lds
  buffer_load_dwordx4 v12, s[4:7], s27 offen offset:2048 sc1 lds
  s_waitcnt vmcnt(6)
  s_barrier
  s_add_u32 m0, s34, 49152
  s_mov_b32 s27, 8192
  buffer_load_dwordx4 v10, s[4:7], s27 offen offset:0 sc1 lds
  buffer_load_dwordx4 v11, s[4:7], s27 offen offset:1024 sc1 lds
  buffer_load_dwordx4 v12, s[4:7], s27 offen offset:2048 sc1 lds
  s_waitcnt vmcnt(6)
  s_barrier
  s_add_u32 m0, s34, 0
  s_mov_b32 s27, 10240
  buffer_load_dwordx4 v10, s[4:7], s27 offen offset:0 sc1 lds
  buffer_load_dwordx4 v11, s[4:7], s27 offen offset:1024 sc1 lds
  buffer_load_dwordx4 v12, s[4:7], s27 offen offset:2048 sc1 lds
  s_waitcnt vmcnt(6)
  s_barrier
  s_add_u32 m0, s34, 12288
  s_mov_b32 s27, 12288
  buffer_load_dwordx4 v10, s[4:7], s27 offen offset:0 sc1 lds
  buffer_load_dwordx4 v11, s[4:7], s27 offen offset:1024 sc1 lds
  buffer_load_dwordx4 v12, s[4:7], s27 offen offset:2048 sc1 lds
  s_waitcnt vmcnt(6)
  s_barrier
  s_add_u32 m0, s34, 24576
  s_mov_b32 s27, 14336
  buffer_load_dwordx4 v10, s[4:7], s27 offen offset:0 sc1 lds
  buffer_load_dwordx4 v11, s[4:7], s27 offen offset:1024 sc1 lds
  buffer_load_dwordx4 v12, s[4:7], s27 offen offset:2048 sc1 lds
  s_waitcnt vmcnt(6)
  s_barrier
  s_add_u32 m0, s34, 36864
  s_mov_b32 s27, 16384
  buffer_load_dwordx4 v10, s[4:7], s27 offen offset:0 sc1 lds
  buffer_load_dwordx4 v11, s[4:7], s27 offen offset:1024 sc1 lds
  buffer_load_dwordx4 v12, s[4:7], s27 offen offset:2048 sc1 lds
  s_waitcnt vmcnt(6)
  s_barrier
  s_add_u32 m0, s34, 49152
  s_mov_b32 s27, 18432
  buffer_load_dwordx4 v10, s[4:7], s27 offen offset:0 sc1 lds
  buffer_load_dwordx4 v11, s[4:7], s27 offen offset:1024 sc1 lds
  buffer_load_dwordx4 v12, s[4:7], s27 offen offset:2048 sc1 lds
  s_waitcnt vmcnt(6)
  s_barrier
  s_waitcnt vmcnt(3)
  s_barrier
  s_waitcnt vmcnt(0)
  s_barrier
  s_barrier
  s_branch L_l3_tail
L_l3_idle:
L_l3_tail:

  s_and_b32 s30, s63, 1
  s_lshl_b32 s20, s62, 1
  s_add_u32 s20, s20, s30
  s_lshr_b32 s21, s63, 1
  s_cmp_ge_u32 s63, 28
  s_cselect_b32 s21, 15, s21

  v_and_b32 v2, 63, v0
  v_lshrrev_b32 v4, 4, v2
  s_sub_u32 s23, s22, 4
  s_lshl_b32 s34, s23, 12
  s_lshl_b32 s30, s23, 4
  v_add_u32 v5, s30, v4
  v_bfe_u32 v6, v2, 2, 2
  v_xor_b32 v6, v6, v4
  v_and_b32 v7, 3, v2
  v_lshlrev_b32 v7, 4, v7
  v_lshl_add_u32 v7, v6, 6, v7
  s_lshl_b32 s31, s21, 8
  v_add_u32 v7, s31, v7

  v_add_u32 v8, 0, v5
  v_mul_u32_u24 v8, 3456, v8
  v_add_u32 v8, v7, v8
  v_subrev_u32 v14, 0, v8

  v_add_u32 v8, 4, v5
  v_mul_u32_u24 v8, 3456, v8
  v_add_u32 v8, v7, v8
  v_subrev_u32 v15, 1024, v8

  v_add_u32 v8, 8, v5
  v_mul_u32_u24 v8, 3456, v8
  v_add_u32 v8, v7, v8
  v_subrev_u32 v16, 2048, v8

  v_add_u32 v8, 12, v5
  v_mul_u32_u24 v8, 3456, v8
  v_add_u32 v8, v7, v8
  v_subrev_u32 v17, 3072, v8

  s_add_u32 s8, s48, 0x00000000
  s_addc_u32 s9, s49, 0
  s_mov_b32 s10, 0x0021c000
  s_mov_b32 s11, 0x00020000
  s_cmp_eq_u32 s21, 15
  s_cbranch_scc1 L_lt_13
  s_add_u32 m0, s34, 0
  s_mov_b32 s28, 0
  buffer_load_dwordx4 v14, s[8:11], s28 offen offset:0 lds
  buffer_load_dwordx4 v15, s[8:11], s28 offen offset:1024 lds
  buffer_load_dwordx4 v16, s[8:11], s28 offen offset:2048 lds
  buffer_load_dwordx4 v17, s[8:11], s28 offen offset:3072 lds
  s_add_u32 m0, s34, 16384
  s_mov_b32 s28, 221184
  buffer_load_dwordx4 v14, s[8:11], s28 offen offset:0 lds
  buffer_load_dwordx4 v15, s[8:11], s28 offen offset:1024 lds
  buffer_load_dwordx4 v16, s[8:11], s28 offen offset:2048 lds
  buffer_load_dwordx4 v17, s[8:11], s28 offen offset:3072 lds
  s_add_u32 m0, s34, 32768
  s_mov_b32 s28, 442368
  buffer_load_dwordx4 v14, s[8:11], s28 offen offset:0 lds
  buffer_load_dwordx4 v15, s[8:11], s28 offen offset:1024 lds
  buffer_load_dwordx4 v16, s[8:11], s28 offen offset:2048 lds
  buffer_load_dwordx4 v17, s[8:11], s28 offen offset:3072 lds

  s_lshl_b32 s30, s20, 3
  s_lshl_b32 s31, s23, 1
  s_add_u32 s30, s30, s31
  s_mul_i32 s30, s30, 20480
  v_lshlrev_b32 v5, 4, v2
  v_add_u32 v10, s30, v5
  v_add_u32 v11, 18432, v10

  s_add_u32 s4, s60, 0x00b00000
  s_addc_u32 s5, s61, 0
  s_mov_b32 s6, 0x00280000
  s_mov_b32 s7, 0x00020000
  s_add_u32 s16, s60, 0x00e00000
  s_addc_u32 s17, s61, 0
  s_mov_b32 s18, 0x00050000
  s_mov_b32 s19, 0x00020000

  v_and_b32 v5, 31, v2
  v_lshlrev_b32 v5, 4, v5
  v_lshrrev_b32 v6, 5, v2
  v_lshl_add_u32 v5, v6, 13, v5
  s_lshl_b32 s30, s20, 9
  s_mul_i32 s31, s23, 81920
  s_add_u32 s30, s30, s31
  v_add_u32 v18, s30, v5

L_lt_13:
  s_barrier
  s_barrier
  s_cmp_eq_u32 s21, 15
  s_cbranch_scc1 L_l4_idle
  s_add_u32 m0, s34, 81920
  s_mov_b32 s27, 0
  buffer_load_dwordx4 v10, s[4:7], s27 offen offset:0 sc1 lds
  buffer_load_dwordx4 v10, s[4:7], s27 offen offset:1024 sc1 lds
  buffer_load_dwordx4 v11, s[4:7], s27 offen offset:2048 sc1 lds
  buffer_load_dwordx4 v11, s[4:7], s27 offen offset:3072 sc1 lds
  s_add_u32 m0, s34, 98304
  s_mov_b32 s27, 2048
  buffer_load_dwordx4 v10, s[4:7], s27 offen offset:0 sc1 lds
  buffer_load_dwordx4 v10, s[4:7], s27 offen offset:1024 sc1 lds
  buffer_load_dwordx4 v11, s[4:7], s27 offen offset:2048 sc1 lds
  buffer_load_dwordx4 v11, s[4:7], s27 offen offset:3072 sc1 lds
  s_add_u32 m0, s34, 114688
  s_mov_b32 s27, 4096
  buffer_load_dwordx4 v10, s[4:7], s27 offen offset:0 sc1 lds
  buffer_load_dwordx4 v10, s[4:7], s27 offen offset:1024 sc1 lds
  buffer_load_dwordx4 v11, s[4:7], s27 offen offset:2048 sc1 lds
  buffer_load_dwordx4 v11, s[4:7], s27 offen offset:3072 sc1 lds
  s_add_u32 m0, s34, 49152
  s_mov_b32 s28, 663552
  buffer_load_dwordx4 v14, s[8:11], s28 offen offset:0 lds
  buffer_load_dwordx4 v15, s[8:11], s28 offen offset:1024 lds
  buffer_load_dwordx4 v16, s[8:11], s28 offen offset:2048 lds
  buffer_load_dwordx4 v17, s[8:11], s28 offen offset:3072 lds
  s_add_u32 m0, s34, 65536
  s_mov_b32 s28, 884736
  buffer_load_dwordx4 v14, s[8:11], s28 offen offset:0 lds
  buffer_load_dwordx4 v15, s[8:11], s28 offen offset:1024 lds
  buffer_load_dwordx4 v16, s[8:11], s28 offen offset:2048 lds
  buffer_load_dwordx4 v17, s[8:11], s28 offen offset:3072 lds
  s_waitcnt vmcnt(16)
  s_barrier
  s_mul_i32 s30, s23, 5120
  s_add_u32 m0, s30, 131072
  s_mov_b32 s27, 0
  buffer_load_dwordx4 v18, s[16:19], s27 offen sc1 lds
  s_add_u32 m0, m0, 1024
  s_mov_b32 s27, 16384
  buffer_load_dwordx4 v18, s[16:19], s27 offen sc1 lds
  s_add_u32 m0, m0, 1024
  s_mov_b32 s27, 32768
  buffer_load_dwordx4 v18, s[16:19], s27 offen sc1 lds
  s_add_u32 m0, m0, 1024
  s_mov_b32 s27, 49152
  buffer_load_dwordx4 v18, s[16:19], s27 offen sc1 lds
  s_add_u32 m0, m0, 1024
  s_mov_b32 s27, 65536
  buffer_load_dwordx4 v18, s[16:19], s27 offen sc1 lds
  s_add_u32 m0, m0, 1024
  s_waitcnt vmcnt(17)
  s_barrier
  s_add_u32 m0, s34, 81920
  s_mov_b32 s27, 6144
  buffer_load_dwordx4 v10, s[4:7], s27 offen offset:0 sc1 lds
  buffer_load_dwordx4 v10, s[4:7], s27 offen offset:1024 sc1 lds
  buffer_load_dwordx4 v11, s[4:7], s27 offen offset:2048 sc1 lds
  buffer_load_dwordx4 v11, s[4:7], s27 offen offset:3072 sc1 lds
  s_add_u32 m0, s34, 0
  s_mov_b32 s28, 1105920
  buffer_load_dwordx4 v14, s[8:11], s28 offen offset:0 lds
  buffer_load_dwordx4 v15, s[8:11], s28 offen offset:1024 lds
  buffer_load_dwordx4 v16, s[8:11], s28 offen offset:2048 lds
  buffer_load_dwordx4 v17, s[8:11], s28 offen offset:3072 lds
  s_waitcnt vmcnt(21)
  s_barrier
  s_add_u32 m0, s34, 98304
  s_mov_b32 s27, 8192
  buffer_load_dwordx4 v10, s[4:7], s27 offen offset:0 sc1 lds
  buffer_load_dwordx4 v10, s[4:7], s27 offen offset:1024 sc1 lds
  buffer_load_dwordx4 v11, s[4:7], s27 offen offset:2048 sc1 lds
  buffer_load_dwordx4 v11, s[4:7], s27 offen offset:3072 sc1 lds
  s_add_u32 m0, s34, 16384
  s_mov_b32 s28, 1327104
  buffer_load_dwordx4 v14, s[8:11], s28 offen offset:0 lds
  buffer_load_dwordx4 v15, s[8:11], s28 offen offset:1024 lds
  buffer_load_dwordx4 v16, s[8:11], s28 offen offset:2048 lds
  buffer_load_dwordx4 v17, s[8:11], s28 offen offset:3072 lds
  s_waitcnt vmcnt(12)
  s_barrier
  s_add_u32 m0, s34, 114688
  s_mov_b32 s27, 10240
  buffer_load_dwordx4 v10, s[4:7], s27 offen offset:0 sc1 lds
  buffer_load_dwordx4 v10, s[4:7], s27 offen offset:1024 sc1 lds
  buffer_load_dwordx4 v11, s[4:7], s27 offen offset:2048 sc1 lds
  buffer_load_dwordx4 v11, s[4:7], s27 offen offset:3072 sc1 lds
  s_add_u32 m0, s34, 32768
  s_mov_b32 s28, 1548288
  buffer_load_dwordx4 v14, s[8:11], s28 offen offset:0 lds
  buffer_load_dwordx4 v15, s[8:11], s28 offen offset:1024 lds
  buffer_load_dwordx4 v16, s[8:11], s28 offen offset:2048 lds
  buffer_load_dwordx4 v17, s[8:11], s28 offen offset:3072 lds
  s_waitcnt vmcnt(12)
  s_barrier
  s_add_u32 m0, s34, 81920
  s_mov_b32 s27, 12288
  buffer_load_dwordx4 v10, s[4:7], s27 offen offset:0 sc1 lds
  buffer_load_dwordx4 v10, s[4:7], s27 offen offset:1024 sc1 lds
  buffer_load_dwordx4 v11, s[4:7], s27 offen offset:2048 sc1 lds
  buffer_load_dwordx4 v11, s[4:7], s27 offen offset:3072 sc1 lds
  s_add_u32 m0, s34, 49152
  s_mov_b32 s28, 1769472
  buffer_load_dwordx4 v14, s[8:11], s28 offen offset:0 lds
  buffer_load_dwordx4 v15, s[8:11], s28 offen offset:1024 lds
  buffer_load_dwordx4 v16, s[8:11], s28 offen offset:2048 lds
  buffer_load_dwordx4 v17, s[8:11], s28 offen offset:3072 lds
  s_waitcnt vmcnt(12)
  s_barrier
  s_add_u32 m0, s34, 98304
  s_mov_b32 s27, 14336
  buffer_load_dwordx4 v10, s[4:7], s27 offen offset:0 sc1 lds
  buffer_load_dwordx4 v10, s[4:7], s27 offen offset:1024 sc1 lds
  buffer_load_dwordx4 v11, s[4:7], s27 offen offset:2048 sc1 lds
  buffer_load_dwordx4 v11, s[4:7], s27 offen offset:3072 sc1 lds
  s_add_u32 m0, s34, 65536
  s_mov_b32 s28, 1990656
  buffer_load_dwordx4 v14, s[8:11], s28 offen offset:0 lds
  buffer_load_dwordx4 v15, s[8:11], s28 offen offset:1024 lds
  buffer_load_dwordx4 v16, s[8:11], s28 offen offset:2048 lds
  buffer_load_dwordx4 v17, s[8:11], s28 offen offset:3072 lds
  s_waitcnt vmcnt(12)
  s_barrier
  s_add_u32 m0, s34, 114688
  s_mov_b32 s27, 16384
  buffer_load_dwordx4 v10, s[4:7], s27 offen offset:0 sc1 lds
  buffer_load_dwordx4 v10, s[4:7], s27 offen offset:1024 sc1 lds
  buffer_load_dwordx4 v11, s[4:7], s27 offen offset:2048 sc1 lds
  buffer_load_dwordx4 v11, s[4:7], s27 offen offset:3072 sc1 lds
  s_waitcnt vmcnt(8)
  s_barrier
  s_add_u32 m0, s34, 81920
  s_mov_b32 s27, 18432
  buffer_load_dwordx4 v10, s[4:7], s27 offen offset:0 sc1 lds
  buffer_load_dwordx4 v10, s[4:7], s27 offen offset:1024 sc1 lds
  buffer_load_dwordx4 v11, s[4:7], s27 offen offset:2048 sc1 lds
  buffer_load_dwordx4 v11, s[4:7], s27 offen offset:3072 sc1 lds

  s_lshl_b32 s30, s23, 7
  v_and_b32 v5, 31, v2
  v_lshl_add_u32 v5, v5, 2, s30
  v_lshrrev_b32 v6, 5, v2
  v_lshl_add_u32 v5, v6, 9, v5
  v_add_u32 v5, 131072, v5

  ds_read_b32 v24, v5 offset:0
  ds_read_b32 v25, v5 offset:1024
  ds_read_b32 v26, v5 offset:2048
  ds_read_b32 v27, v5 offset:3072
  ds_read_b32 v28, v5 offset:4096
  ds_read_b32 v29, v5 offset:5120
  ds_read_b32 v30, v5 offset:6144
  ds_read_b32 v31, v5 offset:7168
  ds_read_b32 v32, v5 offset:8192
  ds_read_b32 v33, v5 offset:9216
  ds_read_b32 v34, v5 offset:10240
  ds_read_b32 v35, v5 offset:11264
  ds_read_b32 v36, v5 offset:12288
  ds_read_b32 v37, v5 offset:13312
  ds_read_b32 v38, v5 offset:14336
  ds_read_b32 v39, v5 offset:15360
  ds_read_b32 v40, v5 offset:16384
  ds_read_b32 v41, v5 offset:17408
  ds_read_b32 v42, v5 offset:18432
  ds_read_b32 v43, v5 offset:19456
  s_waitcnt lgkmcnt(0)
  v_add_f32 v24, v24, v25
  v_add_f32 v26, v26, v27
  v_add_f32 v28, v28, v29
  v_add_f32 v30, v30, v31
  v_add_f32 v32, v32, v33
  v_add_f32 v34, v34, v35
  v_add_f32 v36, v36, v37
  v_add_f32 v38, v38, v39
  v_add_f32 v40, v40, v41
  v_add_f32 v42, v42, v43
  v_add_f32 v24, v24, v26
  v_add_f32 v24, v24, v28
  v_add_f32 v24, v24, v30
  v_add_f32 v24, v24, v32
  v_add_f32 v24, v24, v34
  v_add_f32 v24, v24, v36
  v_add_f32 v24, v24, v38
  v_add_f32 v24, v24, v40
  v_add_f32 v24, v24, v42

  v_mov_b32 v25, v24
  s_nop 1
  v_permlane32_swap_b32 v24, v25
  s_mov_b32 s30, 0x3acccccd
  s_mov_b32 s31, 0x3727c5ac
  v_mul_f32 v24, s30, v24
  v_mul_f32 v25, s30, v25
  v_fma_f32 v25, -v24, v24, v25
  v_max_f32 v25, 0, v25
  v_add_f32 v26, s31, v25
  v_rsq_f32 v27, v26
  s_nop 0

  v_mul_f32 v25, v25, v27
  v_mul_f32 v25, v25, v27
  v_add_f32 v25, s31, v25
  v_rsq_f32 v25, v25
  s_nop 0
  v_mul_f32 v27, v27, v25

  v_mov_b32 v25, v27
  s_lshl_b32 s30, s23, 8
  s_add_u32 s30, s30, 161280
  v_and_b32 v5, 31, v2
  v_lshl_add_u32 v5, v5, 3, s30
  s_mov_b32 exec_hi, 0
  ds_write_b64 v5, v[24:25]
  s_mov_b32 exec_hi, -1
  s_waitcnt lgkmcnt(0)

  s_waitcnt vmcnt(4)
  s_barrier
  s_waitcnt vmcnt(0)
  s_barrier
  s_barrier
  s_branch L_l4_tail
L_l4_idle:
L_l4_tail:

  s_mul_i32 s30, s63, 43
  s_lshr_b32 s21, s30, 7
  s_mul_i32 s30, s21, 3
  s_sub_u32 s30, s63, s30
  s_mul_i32 s30, s30, 6
  s_lshl_b32 s20, s62, 4
  s_add_u32 s39, s20, 16
  s_add_u32 s20, s20, s30
  s_cmp_ge_u32 s63, 30
  s_cselect_b32 s21, 15, s21

  v_and_b32 v2, 63, v0
  s_sub_u32 s23, s22, 4
  s_lshl_b32 s35, s23, 11
  s_cmp_eq_u32 s21, 15
  s_cbranch_scc1 L_pfs_14
  s_lshl_b32 s30, s23, 4
  v_lshrrev_b32 v5, 3, v2
  v_add_u32 v5, s30, v5
  v_and_b32 v6, 7, v2
  v_lshrrev_b32 v6, 1, v6
  v_and_b32 v7, 1, v2
  v_bfe_u32 v9, v2, 4, 1
  s_lshl_b32 s31, s21, 7

  v_add_u32 v8, 0, v5
  v_mul_u32_u24 v8, 1280, v8
  v_or_b32 v3, 0, v9
  v_xor_b32 v3, v6, v3
  v_lshl_add_u32 v8, v3, 5, v8
  v_lshl_add_u32 v8, v7, 4, v8
  v_add_u32 v8, s31, v8
  v_subrev_u32 v14, 0, v8

  v_add_u32 v8, 8, v5
  v_mul_u32_u24 v8, 1280, v8
  v_or_b32 v3, 2, v9
  v_xor_b32 v3, v6, v3
  v_lshl_add_u32 v8, v3, 5, v8
  v_lshl_add_u32 v8, v7, 4, v8
  v_add_u32 v8, s31, v8
  v_subrev_u32 v15, 1024, v8

  s_add_u32 s8, s52, 0x00000000
  s_addc_u32 s9, s53, 0
  s_mov_b32 s10, 0x0021c000
  s_mov_b32 s11, 0x00020000
  s_add_u32 m0, s35, 65792
  s_mov_b32 s28, 0
  buffer_load_dwordx4 v14, s[8:11], s28 offen offset:0 lds
  buffer_load_dwordx4 v15, s[8:11], s28 offen offset:1024 lds
  s_add_u32 m0, s35, 73984
  s_mov_b32 s28, 81920
  buffer_load_dwordx4 v14, s[8:11], s28 offen offset:0 lds
  buffer_load_dwordx4 v15, s[8:11], s28 offen offset:1024 lds
  s_add_u32 m0, s35, 82176
  s_mov_b32 s28, 163840
  buffer_load_dwordx4 v14, s[8:11], s28 offen offset:0 lds
  buffer_load_dwordx4 v15, s[8:11], s28 offen offset:1024 lds
  s_add_u32 m0, s35, 90368
  s_mov_b32 s28, 245760
  buffer_load_dwordx4 v14, s[8:11], s28 offen offset:0 lds
  buffer_load_dwordx4 v15, s[8:11], s28 offen offset:1024 lds
  s_add_u32 m0, s35, 98560
  s_mov_b32 s28, 327680
  buffer_load_dwordx4 v14, s[8:11], s28 offen offset:0 lds
  buffer_load_dwordx4 v15, s[8:11], s28 offen offset:1024 lds
  s_add_u32 m0, s35, 106752
  s_mov_b32 s28, 409600
  buffer_load_dwordx4 v14, s[8:11], s28 offen offset:0 lds
  buffer_load_dwordx4 v15, s[8:11], s28 offen offset:1024 lds
  s_add_u32 m0, s35, 114944
  s_mov_b32 s28, 491520
  buffer_load_dwordx4 v14, s[8:11], s28 offen offset:0 lds
  buffer_load_dwordx4 v15, s[8:11], s28 offen offset:1024 lds
  s_add_u32 m0, s35, 123136
  s_mov_b32 s28, 573440
  buffer_load_dwordx4 v14, s[8:11], s28 offen offset:0 lds
  buffer_load_dwordx4 v15, s[8:11], s28 offen offset:1024 lds
  s_add_u32 m0, s35, 131328
  s_mov_b32 s28, 655360
  buffer_load_dwordx4 v14, s[8:11], s28 offen offset:0 lds
  buffer_load_dwordx4 v15, s[8:11], s28 offen offset:1024 lds
  s_add_u32 m0, s35, 139520
  s_mov_b32 s28, 737280
  buffer_load_dwordx4 v14, s[8:11], s28 offen offset:0 lds
  buffer_load_dwordx4 v15, s[8:11], s28 offen offset:1024 lds
  s_add_u32 m0, s35, 147712
  s_mov_b32 s28, 819200
  buffer_load_dwordx4 v14, s[8:11], s28 offen offset:0 lds
  buffer_load_dwordx4 v15, s[8:11], s28 offen offset:1024 lds
L_pfs_14:

  s_mul_i32 s30, s63, 43
  s_lshr_b32 s21, s30, 7
  s_mul_i32 s30, s21, 3
  s_sub_u32 s30, s63, s30
  s_mul_i32 s30, s30, 6
  s_lshl_b32 s20, s62, 4
  s_add_u32 s39, s20, 16
  s_add_u32 s20, s20, s30
  s_cmp_ge_u32 s63, 30
  s_cselect_b32 s21, 15, s21

  v_and_b32 v2, 63, v0
  s_sub_u32 s23, s22, 4
  s_mul_i32 s34, s23, 3072
  v_lshlrev_b32 v5, 4, v2

  s_mul_i32 s31, s23, 3
  s_add_u32 s31, s31, 0
  s_lshr_b32 s32, s31, 1
  s_add_u32 s32, s32, s20
  s_lshl_b32 s33, s62, 4
  s_sub_u32 s32, s32, s33
  s_mul_i32 s32, s32, 458752
  s_and_b32 s31, s31, 1
  s_lshl_b32 s31, s31, 10
  s_add_u32 s32, s32, s31
  s_lshl_b32 s33, s62, 12
  s_add_u32 s32, s32, s33
  s_sub_u32 s32, s32, 0
  v_add_u32 v10, s32, v5

  s_mul_i32 s31, s23, 3
  s_add_u32 s31, s31, 1
  s_lshr_b32 s32, s31, 1
  s_add_u32 s32, s32, s20
  s_lshl_b32 s33, s62, 4
  s_sub_u32 s32, s32, s33
  s_mul_i32 s32, s32, 458752
  s_and_b32 s31, s31, 1
  s_lshl_b32 s31, s31, 10
  s_add_u32 s32, s32, s31
  s_lshl_b32 s33, s62, 12
  s_add_u32 s32, s32, s33
  s_sub_u32 s32, s32, 1024
  v_add_u32 v11, s32, v5

  s_mul_i32 s31, s23, 3
  s_add_u32 s31, s31, 2
  s_lshr_b32 s32, s31, 1
  s_add_u32 s32, s32, s20
  s_lshl_b32 s33, s62, 4
  s_sub_u32 s32, s32, s33
  s_mul_i32 s32, s32, 458752
  s_and_b32 s31, s31, 1
  s_lshl_b32 s31, s31, 10
  s_add_u32 s32, s32, s31
  s_lshl_b32 s33, s62, 12
  s_add_u32 s32, s32, s33
  s_sub_u32 s32, s32, 2048
  v_add_u32 v12, s32, v5

  s_add_u32 s4, s60, 0x00000000
  s_addc_u32 s5, s61, 0
  s_mov_b32 s6, 0x00780000
  s_mov_b32 s7, 0x00020000
  s_barrier
  s_barrier
  s_cmp_eq_u32 s21, 15
  s_cbranch_scc1 L_l5_idle
  s_add_u32 m0, s34, 0
  s_mov_b32 s27, 0
  buffer_load_dwordx4 v10, s[4:7], s27 offen offset:0 sc1 lds
  buffer_load_dwordx4 v11, s[4:7], s27 offen offset:1024 sc1 lds
  buffer_load_dwordx4 v12, s[4:7], s27 offen offset:2048 sc1 lds
  s_add_u32 m0, s34, 12288
  s_mov_b32 s27, 2048
  buffer_load_dwordx4 v10, s[4:7], s27 offen offset:0 sc1 lds
  buffer_load_dwordx4 v11, s[4:7], s27 offen offset:1024 sc1 lds
  buffer_load_dwordx4 v12, s[4:7], s27 offen offset:2048 sc1 lds
  s_add_u32 m0, s34, 24576
  s_mov_b32 s27, 32768
  buffer_load_dwordx4 v10, s[4:7], s27 offen offset:0 sc1 lds
  buffer_load_dwordx4 v11, s[4:7], s27 offen offset:1024 sc1 lds
  buffer_load_dwordx4 v12, s[4:7], s27 offen offset:2048 sc1 lds
  s_waitcnt vmcnt(6)
  s_barrier
  s_add_u32 m0, s34, 36864
  s_mov_b32 s27, 34816
  buffer_load_dwordx4 v10, s[4:7], s27 offen offset:0 sc1 lds
  buffer_load_dwordx4 v11, s[4:7], s27 offen offset:1024 sc1 lds
  buffer_load_dwordx4 v12, s[4:7], s27 offen offset:2048 sc1 lds
  s_waitcnt vmcnt(6)
  s_barrier
  s_add_u32 m0, s34, 49152
  s_mov_b32 s27, 65536
  buffer_load_dwordx4 v10, s[4:7], s27 offen offset:0 sc1 lds
  buffer_load_dwordx4 v11, s[4:7], s27 offen offset:1024 sc1 lds
  buffer_load_dwordx4 v12, s[4:7], s27 offen offset:2048 sc1 lds
  s_waitcnt vmcnt(6)
  s_barrier
  s_add_u32 m0, s34, 0
  s_mov_b32 s27, 67584
  buffer_load_dwordx4 v10, s[4:7], s27 offen offset:0 sc1 lds
  buffer_load_dwordx4 v11, s[4:7], s27 offen offset:1024 sc1 lds
  buffer_load_dwordx4 v12, s[4:7], s27 offen offset:2048 sc1 lds
  s_add_u32 m0, s35, 65792
  s_mov_b32 s28, 901120
  buffer_load_dwordx4 v14, s[8:11], s28 offen offset:0 lds
  buffer_load_dwordx4 v15, s[8:11], s28 offen offset:1024 lds
  s_waitcnt vmcnt(8)
  s_barrier
  s_add_u32 m0, s34, 12288
  s_mov_b32 s27, 98304
  buffer_load_dwordx4 v10, s[4:7], s27 offen offset:0 sc1 lds
  buffer_load_dwordx4 v11, s[4:7], s27 offen offset:1024 sc1 lds
  buffer_load_dwordx4 v12, s[4:7], s27 offen offset:2048 sc1 lds
  s_add_u32 m0, s35, 73984
  s_mov_b32 s28, 983040
  buffer_load_dwordx4 v14, s[8:11], s28 offen offset:0 lds
  buffer_load_dwordx4 v15, s[8:11], s28 offen offset:1024 lds
  s_waitcnt vmcnt(10)
  s_barrier
  s_add_u32 m0, s34, 24576
  s_mov_b32 s27, 100352
  buffer_load_dwordx4 v10, s[4:7], s27 offen offset:0 sc1 lds
  buffer_load_dwordx4 v11, s[4:7], s27 offen offset:1024 sc1 lds
  buffer_load_dwordx4 v12, s[4:7], s27 offen offset:2048 sc1 lds
  s_add_u32 m0, s35, 82176
  s_mov_b32 s28, 1064960
  buffer_load_dwordx4 v14, s[8:11], s28 offen offset:0 lds
  buffer_load_dwordx4 v15, s[8:11], s28 offen offset:1024 lds
  s_waitcnt vmcnt(12)
  s_barrier
  s_add_u32 m0, s34, 36864
  s_mov_b32 s27, 131072
  buffer_load_dwordx4 v10, s[4:7], s27 offen offset:0 sc1 lds
  buffer_load_dwordx4 v11, s[4:7], s27 offen offset:1024 sc1 lds
  buffer_load_dwordx4 v12, s[4:7], s27 offen offset:2048 sc1 lds
  s_add_u32 m0, s35, 90368
  s_mov_b32 s28, 1146880
  buffer_load_dwordx4 v14, s[8:11], s28 offen offset:0 lds
  buffer_load_dwordx4 v15, s[8:11], s28 offen offset:1024 lds
  s_waitcnt vmcnt(12)
  s_barrier
  s_add_u32 m0, s34, 49152
  s_mov_b32 s27, 133120
  buffer_load_dwordx4 v10, s[4:7], s27 offen offset:0 sc1 lds
  buffer_load_dwordx4 v11, s[4:7], s27 offen offset:1024 sc1 lds
  buffer_load_dwordx4 v12, s[4:7], s27 offen offset:2048 sc1 lds
  s_add_u32 m0, s35, 98560
  s_mov_b32 s28, 1228800
  buffer_load_dwordx4 v14, s[8:11], s28 offen offset:0 lds
  buffer_load_dwordx4 v15, s[8:11], s28 offen offset:1024 lds
  s_waitcnt vmcnt(12)
  s_barrier
  s_add_u32 m0, s34, 0
  s_mov_b32 s27, 163840
  buffer_load_dwordx4 v10, s[4:7], s27 offen offset:0 sc1 lds
  buffer_load_dwordx4 v11, s[4:7], s27 offen offset:1024 sc1 lds
  buffer_load_dwordx4 v12, s[4:7], s27 offen offset:2048 sc1 lds
  s_waitcnt vmcnt(10)
  s_barrier
  s_add_u32 m0, s34, 12288
  s_mov_b32 s27, 165888
  buffer_load_dwordx4 v10, s[4:7], s27 offen offset:0 sc1 lds
  buffer_load_dwordx4 v11, s[4:7], s27 offen offset:1024 sc1 lds
  buffer_load_dwordx4 v12, s[4:7], s27 offen offset:2048 sc1 lds
  s_add_u32 m0, s35, 106752
  s_mov_b32 s28, 1310720
  buffer_load_dwordx4 v14, s[8:11], s28 offen offset:0 lds
  buffer_load_dwordx4 v15, s[8:11], s28 offen offset:1024 lds
  s_waitcnt vmcnt(10)
  s_barrier
  s_add_u32 m0, s34, 24576
  s_mov_b32 s27, 196608
  buffer_load_dwordx4 v10, s[4:7], s27 offen offset:0 sc1 lds
  buffer_load_dwordx4 v11, s[4:7], s27 offen offset:1024 sc1 lds
  buffer_load_dwordx4 v12, s[4:7], s27 offen offset:2048 sc1 lds
  s_add_u32 m0, s35, 114944
  s_mov_b32 s28, 1392640
  buffer_load_dwordx4 v14, s[8:11], s28 offen offset:0 lds
  buffer_load_dwordx4 v15, s[8:11], s28 offen offset:1024 lds
  s_waitcnt vmcnt(10)
  s_barrier
  s_add_u32 m0, s34, 36864
  s_mov_b32 s27, 198656
  buffer_load_dwordx4 v10, s[4:7], s27 offen offset:0 sc1 lds
  buffer_load_dwordx4 v11, s[4:7], s27 offen offset:1024 sc1 lds
  buffer_load_dwordx4 v12, s[4:7], s27 offen offset:2048 sc1 lds
  s_add_u32 m0, s35, 123136
  s_mov_b32 s28, 1474560
  buffer_load_dwordx4 v14, s[8:11], s28 offen offset:0 lds
  buffer_load_dwordx4 v15, s[8:11], s28 offen offset:1024 lds
  s_waitcnt vmcnt(12)
  s_barrier
  s_add_u32 m0, s34, 49152
  s_mov_b32 s27, 229376
  buffer_load_dwordx4 v10, s[4:7], s27 offen offset:0 sc1 lds
  buffer_load_dwordx4 v11, s[4:7], s27 offen offset:1024 sc1 lds
  buffer_load_dwordx4 v12, s[4:7], s27 offen offset:2048 sc1 lds
  s_waitcnt vmcnt(10)
  s_barrier
  s_add_u32 m0, s34, 0
  s_mov_b32 s27, 231424
  buffer_load_dwordx4 v10, s[4:7], s27 offen offset:0 sc1 lds
  buffer_load_dwordx4 v11, s[4:7], s27 offen offset:1024 sc1 lds
  buffer_load_dwordx4 v12, s[4:7], s27 offen offset:2048 sc1 lds
  s_add_u32 m0, s35, 131328
  s_mov_b32 s28, 1556480
  buffer_load_dwordx4 v14, s[8:11], s28 offen offset:0 lds
  buffer_load_dwordx4 v15, s[8:11], s28 offen offset:1024 lds
  s_waitcnt vmcnt(10)
  s_barrier
  s_add_u32 m0, s34, 12288
  s_mov_b32 s27, 262144
  buffer_load_dwordx4 v10, s[4:7], s27 offen offset:0 sc1 lds
  buffer_load_dwordx4 v11, s[4:7], s27 offen offset:1024 sc1 lds
  buffer_load_dwordx4 v12, s[4:7], s27 offen offset:2048 sc1 lds
  s_add_u32 m0, s35, 139520
  s_mov_b32 s28, 1638400
  buffer_load_dwordx4 v14, s[8:11], s28 offen offset:0 lds
  buffer_load_dwordx4 v15, s[8:11], s28 offen offset:1024 lds
  s_waitcnt vmcnt(10)
  s_barrier
  s_add_u32 m0, s34, 24576
  s_mov_b32 s27, 264192
  buffer_load_dwordx4 v10, s[4:7], s27 offen offset:0 sc1 lds
  buffer_load_dwordx4 v11, s[4:7], s27 offen offset:1024 sc1 lds
  buffer_load_dwordx4 v12, s[4:7], s27 offen offset:2048 sc1 lds
  s_waitcnt vmcnt(10)
  s_barrier
  s_add_u32 m0, s34, 36864
  s_mov_b32 s27, 294912
  buffer_load_dwordx4 v10, s[4:7], s27 offen offset:0 sc1 lds
  buffer_load_dwordx4 v11, s[4:7], s27 offen offset:1024 sc1 lds
  buffer_load_dwordx4 v12, s[4:7], s27 offen offset:2048 sc1 lds
  s_add_u32 m0, s35, 147712
  s_mov_b32 s28, 1720320
  buffer_load_dwordx4 v14, s[8:11], s28 offen offset:0 lds
  buffer_load_dwordx4 v15, s[8:11], s28 offen offset:1024 lds
  s_waitcnt vmcnt(10)
  s_barrier
  s_add_u32 m0, s34, 49152
  s_mov_b32 s27, 296960
  buffer_load_dwordx4 v10, s[4:7], s27 offen offset:0 sc1 lds
  buffer_load_dwordx4 v11, s[4:7], s27 offen offset:1024 sc1 lds
  buffer_load_dwordx4 v12, s[4:7], s27 offen offset:2048 sc1 lds
  s_add_u32 m0, s35, 65792
  s_mov_b32 s28, 1802240
  buffer_load_dwordx4 v14, s[8:11], s28 offen offset:0 lds
  buffer_load_dwordx4 v15, s[8:11], s28 offen offset:1024 lds
  s_waitcnt vmcnt(10)
  s_barrier
  s_add_u32 m0, s34, 0
  s_mov_b32 s27, 327680
  buffer_load_dwordx4 v10, s[4:7], s27 offen offset:0 sc1 lds
  buffer_load_dwordx4 v11, s[4:7], s27 offen offset:1024 sc1 lds
  buffer_load_dwordx4 v12, s[4:7], s27 offen offset:2048 sc1 lds
  s_add_u32 m0, s35, 73984
  s_mov_b32 s28, 1884160
  buffer_load_dwordx4 v14, s[8:11], s28 offen offset:0 lds
  buffer_load_dwordx4 v15, s[8:11], s28 offen offset:1024 lds
  s_waitcnt vmcnt(12)
  s_barrier
  s_add_u32 m0, s34, 12288
  s_mov_b32 s27, 329728
  buffer_load_dwordx4 v10, s[4:7], s27 offen offset:0 sc1 lds
  buffer_load_dwordx4 v11, s[4:7], s27 offen offset:1024 sc1 lds
  buffer_load_dwordx4 v12, s[4:7], s27 offen offset:2048 sc1 lds
  s_waitcnt vmcnt(10)
  s_barrier
  s_add_u32 m0, s34, 24576
  s_mov_b32 s27, 360448
  buffer_load_dwordx4 v10, s[4:7], s27 offen offset:0 sc1 lds
  buffer_load_dwordx4 v11, s[4:7], s27 offen offset:1024 sc1 lds
  buffer_load_dwordx4 v12, s[4:7], s27 offen offset:2048 sc1 lds
  s_add_u32 m0, s35, 82176
  s_mov_b32 s28, 1966080
  buffer_load_dwordx4 v14, s[8:11], s28 offen offset:0 lds
  buffer_load_dwordx4 v15, s[8:11], s28 offen offset:1024 lds
  s_waitcnt vmcnt(10)
  s_barrier
  s_add_u32 m0, s34, 36864
  s_mov_b32 s27, 362496
  buffer_load_dwordx4 v10, s[4:7], s27 offen offset:0 sc1 lds
  buffer_load_dwordx4 v11, s[4:7], s27 offen offset:1024 sc1 lds
  buffer_load_dwordx4 v12, s[4:7], s27 offen offset:2048 sc1 lds
  s_add_u32 m0, s35, 90368
  s_mov_b32 s28, 2048000
  buffer_load_dwordx4 v14, s[8:11], s28 offen offset:0 lds
  buffer_load_dwordx4 v15, s[8:11], s28 offen offset:1024 lds
  s_waitcnt vmcnt(10)
  s_barrier
  s_add_u32 m0, s34, 49152
  s_mov_b32 s27, 393216
  buffer_load_dwordx4 v10, s[4:7], s27 offen offset:0 sc1 lds
  buffer_load_dwordx4 v11, s[4:7], s27 offen offset:1024 sc1 lds
  buffer_load_dwordx4 v12, s[4:7], s27 offen offset:2048 sc1 lds
  s_waitcnt vmcnt(10)
  s_barrier
  s_add_u32 m0, s34, 0
  s_mov_b32 s27, 395264
  buffer_load_dwordx4 v10, s[4:7], s27 offen offset:0 sc1 lds
  buffer_load_dwordx4 v11, s[4:7], s27 offen offset:1024 sc1 lds
  buffer_load_dwordx4 v12, s[4:7], s27 offen offset:2048 sc1 lds
  s_add_u32 m0, s35, 98560
  s_mov_b32 s28, 2129920
  buffer_load_dwordx4 v14, s[8:11], s28 offen offset:0 lds
  buffer_load_dwordx4 v15, s[8:11], s28 offen offset:1024 lds
  s_waitcnt vmcnt(10)
  s_barrier
  s_add_u32 m0, s34, 12288
  s_mov_b32 s27, 425984
  buffer_load_dwordx4 v10, s[4:7], s27 offen offset:0 sc1 lds
  buffer_load_dwordx4 v11, s[4:7], s27 offen offset:1024 sc1 lds
  buffer_load_dwordx4 v12, s[4:7], s27 offen offset:2048 sc1 lds
  s_waitcnt vmcnt(8)
  s_barrier
  s_waitcnt vmcnt(5)
  s_barrier
  s_waitcnt vmcnt(0)
  s_barrier
  s_barrier
  s_cmp_eq_u32 s96, 1
  s_cbranch_scc1 L_end
  s_branch L_l5_tail
L_l5_idle:
  s_cmp_eq_u32 s96, 1
  s_cbranch_scc1 L_end
L_l5_tail:

  s_and_b32 s30, s63, 1
  s_lshl_b32 s20, s62, 1
  s_add_u32 s20, s20, s30
  s_lshr_b32 s21, s63, 1
  s_cmp_ge_u32 s63, 30
  s_cselect_b32 s21, 15, s21

  v_and_b32 v2, 63, v0
  v_lshrrev_b32 v4, 4, v2
  s_sub_u32 s23, s22, 4
  s_lshl_b32 s34, s23, 12
  s_lshl_b32 s30, s23, 4
  v_add_u32 v5, s30, v4
  v_bfe_u32 v6, v2, 2, 2
  v_xor_b32 v6, v6, v4
  v_and_b32 v7, 3, v2
  v_lshlrev_b32 v7, 4, v7
  v_lshl_add_u32 v7, v6, 6, v7
  s_lshl_b32 s31, s21, 8
  v_add_u32 v7, s31, v7

  v_add_u32 v8, 0, v5
  v_mul_u32_u24 v8, 3840, v8
  v_add_u32 v8, v7, v8
  v_subrev_u32 v14, 0, v8

  v_add_u32 v8, 4, v5
  v_mul_u32_u24 v8, 3840, v8
  v_add_u32 v8, v7, v8
  v_subrev_u32 v15, 1024, v8

  v_add_u32 v8, 8, v5
  v_mul_u32_u24 v8, 3840, v8
  v_add_u32 v8, v7, v8
  v_subrev_u32 v16, 2048, v8

  v_add_u32 v8, 12, v5
  v_mul_u32_u24 v8, 3840, v8
  v_add_u32 v8, v7, v8
  v_subrev_u32 v17, 3072, v8

  s_add_u32 s8, s42, 0x00000000
  s_addc_u32 s9, s43, 0
  s_mov_b32 s10, 0x00258000
  s_mov_b32 s11, 0x00020000
  s_cmp_eq_u32 s21, 15
  s_cbranch_scc1 L_lt_15
  s_add_u32 m0, s34, 0
  s_mov_b32 s28, 0
  buffer_load_dwordx4 v14, s[8:11], s28 offen offset:0 lds
  buffer_load_dwordx4 v15, s[8:11], s28 offen offset:1024 lds
  buffer_load_dwordx4 v16, s[8:11], s28 offen offset:2048 lds
  buffer_load_dwordx4 v17, s[8:11], s28 offen offset:3072 lds
  s_add_u32 m0, s34, 16384
  s_mov_b32 s28, 245760
  buffer_load_dwordx4 v14, s[8:11], s28 offen offset:0 lds
  buffer_load_dwordx4 v15, s[8:11], s28 offen offset:1024 lds
  buffer_load_dwordx4 v16, s[8:11], s28 offen offset:2048 lds
  buffer_load_dwordx4 v17, s[8:11], s28 offen offset:3072 lds
  s_add_u32 m0, s34, 32768
  s_mov_b32 s28, 491520
  buffer_load_dwordx4 v14, s[8:11], s28 offen offset:0 lds
  buffer_load_dwordx4 v15, s[8:11], s28 offen offset:1024 lds
  buffer_load_dwordx4 v16, s[8:11], s28 offen offset:2048 lds
  buffer_load_dwordx4 v17, s[8:11], s28 offen offset:3072 lds

  s_lshl_b32 s30, s20, 3
  s_lshl_b32 s31, s23, 1
  s_add_u32 s30, s30, s31
  s_mul_i32 s30, s30, 20480
  v_lshlrev_b32 v5, 4, v2
  v_add_u32 v10, s30, v5
  v_add_u32 v11, 18432, v10

  s_add_u32 s4, s60, 0x00b00000
  s_addc_u32 s5, s61, 0
  s_mov_b32 s6, 0x00280000
  s_mov_b32 s7, 0x00020000
  s_add_u32 s16, s60, 0x00e00000
  s_addc_u32 s17, s61, 0
  s_mov_b32 s18, 0x00050000
  s_mov_b32 s19, 0x00020000

  v_and_b32 v5, 31, v2
  v_lshlrev_b32 v5, 4, v5
  v_lshrrev_b32 v6, 5, v2
  v_lshl_add_u32 v5, v6, 13, v5
  s_lshl_b32 s30, s20, 9
  s_mul_i32 s31, s23, 81920
  s_add_u32 s30, s30, s31
  v_add_u32 v18, s30, v5

L_lt_15:
  s_barrier
  s_barrier

  s_add_u32 s96, s96, 1
  s_add_u32 s47, s47, 0x00600000
  s_branch L_l_layer

L_slow_1:
  buffer_store_dwordx4 v[64:67], v46, s[12:15], s32 offen sc1
  buffer_store_dwordx4 v[68:71], v46, s[12:15], s33 offen sc1
  s_branch L_back_1
L_slow_2:
  buffer_store_dwordx4 v[96:99], v46, s[12:15], s32 offen sc1
  buffer_store_dwordx4 v[100:103], v46, s[12:15], s33 offen sc1
  s_branch L_back_2
L_slow_3:
  buffer_store_dwordx4 v[80:83], v46, s[12:15], s32 offen sc1
  buffer_store_dwordx4 v[84:87], v46, s[12:15], s33 offen sc1
  s_branch L_back_3
L_slow_4:
  buffer_store_dwordx4 v[112:115], v46, s[12:15], s32 offen sc1
  buffer_store_dwordx4 v[116:119], v46, s[12:15], s33 offen sc1
  s_branch L_back_4
L_slow_5:
  buffer_store_dwordx4 v[64:67], v46, s[12:15], s32 offen sc1
  buffer_store_dwordx4 v[68:71], v46, s[12:15], s33 offen sc1
  s_branch L_back_5
L_slow_6:
  buffer_store_dwordx4 v[96:99], v46, s[12:15], s32 offen sc1
  buffer_store_dwordx4 v[100:103], v46, s[12:15], s33 offen sc1
  s_branch L_back_6
L_slow_7:
  buffer_store_dwordx4 v[80:83], v46, s[12:15], s32 offen sc1
  buffer_store_dwordx4 v[84:87], v46, s[12:15], s33 offen sc1
  s_branch L_back_7
L_slow_8:
  buffer_store_dwordx4 v[112:115], v46, s[12:15], s32 offen sc1
  buffer_store_dwordx4 v[116:119], v46, s[12:15], s33 offen sc1
  s_branch L_back_8
L_slow_9:
  buffer_store_dwordx4 v[28:31], v24, s[8:11], 0 offen sc1
  s_branch L_back_9
L_slow_10:
  buffer_store_dwordx2 v[32:33], v25, s[8:11], 0 offen sc1
  s_branch L_back_10
L_slow_11:
  buffer_store_dwordx4 v[224:227], v23, s[12:15], 0 offen sc1
  buffer_store_dwordx4 v[228:231], v23, s[12:15], s32 offen sc1
  buffer_store_dwordx4 v[232:235], v23, s[12:15], s33 offen sc1
  s_branch L_back_11
L_slow_12:
  buffer_store_dword v96, v27, s[16:19], 0 offen sc1
  s_branch L_back_12
L_slow_13:
  buffer_store_dword v104, v27, s[16:19], 0 offen offset:128 sc1
  s_branch L_back_13
L_slow_14:
  buffer_store_dwordx4 v[64:67], v46, s[12:15], s32 offen sc1
  buffer_store_dwordx4 v[68:71], v46, s[12:15], s32 offen offset:512 sc1
  s_branch L_back_14
L_slow_15:
  buffer_store_dwordx4 v[96:99], v46, s[12:15], s32 offen sc1
  buffer_store_dwordx4 v[100:103], v46, s[12:15], s32 offen offset:512 sc1
  s_branch L_back_15
L_slow_16:
  buffer_store_dwordx4 v[80:83], v46, s[12:15], s32 offen sc1
  buffer_store_dwordx4 v[84:87], v46, s[12:15], s32 offen offset:512 sc1
  s_branch L_back_16
L_slow_17:
  buffer_store_dwordx4 v[112:115], v46, s[12:15], s32 offen sc1
  buffer_store_dwordx4 v[116:119], v46, s[12:15], s32 offen offset:512 sc1
  s_branch L_back_17
L_slow_18:
  buffer_store_dwordx4 v[224:227], v23, s[12:15], 0 offen sc1
  buffer_store_dwordx4 v[228:231], v23, s[12:15], s32 offen sc1
  buffer_store_dwordx4 v[232:235], v23, s[12:15], s33 offen sc1
  s_branch L_back_18
L_slow_19:
  buffer_store_dword v96, v27, s[16:19], 0 offen sc1
  s_branch L_back_19
L_slow_20:
  buffer_store_dword v104, v27, s[16:19], 0 offen offset:128 sc1
  s_branch L_back_20
L_end:
  s_endpgm
L_code_end:
.section .rodata,"a"
.p2align 6
.amdhsa_kernel interleave_layers__sliding_block__mixer_channel_mlp__prompt_kernel
  .amdhsa_next_free_vgpr 256
  .amdhsa_next_free_sgpr 102
  .amdhsa_accum_offset 256
  .amdhsa_group_segment_fixed_size 0
  .amdhsa_kernarg_size 88
  .amdhsa_user_sgpr_count 2
  .amdhsa_user_sgpr_kernarg_segment_ptr 1
  .amdhsa_system_sgpr_workgroup_id_x 1
.end_amdhsa_kernel
```
